```python
import torch

def _softmax(x, axis=-1):
    return torch.softmax(x, dim=axis)
def _gelu(x):
    return torch.nn.functional.gelu(x, approximate="tanh")
def _silu(x):
    return torch.nn.functional.silu(x)
def _sigmoid(x):
    return torch.sigmoid(x)
def _layernorm(x, axis=-1, eps=1e-5):
    m = x.mean(dim=axis, keepdim=True)
    v = x.var(dim=axis, keepdim=True, unbiased=False)
    return (x - m) / torch.sqrt(v + eps)
def _scatter_add(tgt, idx, src, axis=0):
    return tgt.clone().index_add_(axis, idx, src)
def _segment_sum(src, seg, n):
    out = torch.zeros((n,) + src.shape[1:], dtype=src.dtype)
    return out.index_add_(0, seg, src)
def _pad(x, pw):
    flat = tuple(v for pair in reversed(pw) for v in pair)
    return torch.nn.functional.pad(x, flat)

kernel_name = 'interleave_layers__ssm_conv_s5__ssm_conv_h3__prompt'

def setup_inputs():

    _w = (lambda a: (lambda t: t.to(torch.bfloat16) if t.is_floating_point() else t)(torch.as_tensor(a)))
    def _A_setup():
        B, S, D = 1, 2048, 576
        P = D
        Lambda_re = -0.5 * (lambda _x: torch.exp(torch.as_tensor(_x)))((lambda *s: torch.randn(*s, dtype=torch.bfloat16) * 0.2)(P))
        Lambda_im = (lambda *s: torch.randn(*s, dtype=torch.bfloat16) * 0.4)(P) * 1.0
        B_re = (lambda *s: torch.randn(*s, dtype=torch.bfloat16) * 0.2)(P, D) * (D ** -0.5)
        B_im = (lambda *s: torch.randn(*s, dtype=torch.bfloat16) * 0.2)(P, D) * (D ** -0.5)
        C_re = (lambda *s: torch.randn(*s, dtype=torch.bfloat16) * 0.2)(D, P) * (P ** -0.5)
        C_im = (lambda *s: torch.randn(*s, dtype=torch.bfloat16) * 0.2)(D, P) * (P ** -0.5)
        log_dt = (lambda *s: torch.randn(*s, dtype=torch.bfloat16) * 0.2)(P) * 0.3 - 2.0
        Dskip = (lambda *s: torch.randn(*s, dtype=torch.bfloat16) * 0.05)(D)
        return {
            "x": _w((lambda *s: torch.randn(*s, dtype=torch.bfloat16) * 0.05)(B, S, D)),
            "Lambda_re": _w(Lambda_re),
            "Lambda_im": _w(Lambda_im),
            "B_re": _w(B_re),
            "B_im": _w(B_im),
            "C_re": _w(C_re),
            "C_im": _w(C_im),
            "log_dt": _w(log_dt),
            "Dskip": _w(Dskip),
        }
    _A_in = _A_setup()

    def _B_setup():
        B, S, D = 1, 2048, 576
        ks = 4
        return {
            "q": _w((lambda *s: torch.randn(*s, dtype=torch.bfloat16) * 0.05)(B, S, D)),
            "k": _w((lambda *s: torch.randn(*s, dtype=torch.bfloat16) * 0.4)(B, S, D)),
            "v": _w((lambda *s: torch.randn(*s, dtype=torch.bfloat16) * 0.4)(B, S, D)),
            "shift_k": _w((lambda *s: torch.randn(*s, dtype=torch.bfloat16) * 0.4)(D, ks) * 0.5),
            "ssm_k": _w((lambda *s: torch.randn(*s, dtype=torch.bfloat16) * 0.4)(D, S) * (1.0 / S ** 0.5)),
            "ssm_D": _w((lambda *s: torch.randn(*s, dtype=torch.bfloat16) * 0.4)(D)),
        }
    _B_in = _B_setup()

    return {
        "A_x": _A_in["x"],
        "A_Lambda_re": _A_in["Lambda_re"],
        "A_Lambda_im": _A_in["Lambda_im"],
        "A_B_re": _A_in["B_re"],
        "A_B_im": _A_in["B_im"],
        "A_C_re": _A_in["C_re"],
        "A_C_im": _A_in["C_im"],
        "A_log_dt": _A_in["log_dt"],
        "A_Dskip": _A_in["Dskip"],
        "B_q": _B_in["q"],
        "B_k": _B_in["k"],
        "B_v": _B_in["v"],
        "B_shift_k": _B_in["shift_k"],
        "B_ssm_k": _B_in["ssm_k"],
        "B_ssm_D": _B_in["ssm_D"],
    }

def reference(A_x, A_Lambda_re, A_Lambda_im, A_B_re, A_B_im, A_C_re, A_C_im, A_log_dt, A_Dskip, B_q, B_k, B_v, B_shift_k, B_ssm_k, B_ssm_D):
    def _A_ref(x, Lambda_re, Lambda_im, B_re, B_im, C_re, C_im, log_dt, Dskip):
        Bsz, L, H = x.shape
        Lam = Lambda_re + 1j * Lambda_im
        Bmat = B_re + 1j * B_im
        Cmat = C_re + 1j * C_im
        dt = torch.exp(log_dt)
        Lam_bar = torch.exp(dt * Lam)
        B_bar = ((Lam_bar - 1.0) / Lam)[:, None] * Bmat
        Bu = torch.einsum("bld,pd->blp", x + 0j, B_bar)
        h = torch.zeros_like(Bu[:, 0, :])
        hs = []
        for t in range(L):
            h = Lam_bar[None, :] * h + Bu[:, t, :]
            hs.append(h)
        hseq = torch.stack(hs, 1)
        y = 2.0 * torch.einsum("blp,dp->bld", hseq, Cmat).real + x * Dskip[None, None, :]
        return y

    def _B_ref(q, k, v, shift_k, ssm_k, ssm_D):
        B, S, D = q.shape
        ks = shift_k.shape[-1]
        k_pad = _pad(k, ((0, 0), (ks - 1, 0), (0, 0)))
        k_shift = torch.zeros_like(k)
        for t in range(ks):
            k_shift = k_shift + k_pad[:, t:t + S, :] * shift_k[:, ks - 1 - t][None, None, :]
        kv = k_shift * v
        L = 2 * S
        kv_pad = _pad(kv, ((0, 0), (0, S), (0, 0)))
        kf_pad = _pad(ssm_k, ((0, 0), (0, S)))
        kv_f = (lambda x, axes=(-2,-1): torch.fft.rfft2(x.float(), dim=axes))(kv_pad[:, None, :, :], axes=(1, 2))
        kf_f = (lambda x, axes=(-2,-1): torch.fft.rfft2(x.float(), dim=axes))(kf_pad[:, None, :], axes=(1, 2))
        kf_f = (lambda x, *d: x.permute(*d))(kf_f, 1, 2, 0)
        y_f = kv_f * kf_f[None, :, :, :]
        y = (lambda x, s, axes=(-2,-1): torch.fft.irfft2(x, s=s, dim=axes).to(torch.bfloat16))(y_f, (1, L), axes=(1, 2))[:, 0, :S, :]
        y = y + kv * ssm_D[None, None, :]
        return q * y

    x = A_x
    x = x + _A_ref(_layernorm(x, axis=-1), A_Lambda_re, A_Lambda_im, A_B_re, A_B_im, A_C_re, A_C_im, A_log_dt, A_Dskip)
    x = x + _B_ref(_layernorm(x, axis=-1), B_k, B_v, B_shift_k, B_ssm_k, B_ssm_D)
    x = x + _A_ref(_layernorm(x, axis=-1), A_Lambda_re, A_Lambda_im, A_B_re, A_B_im, A_C_re, A_C_im, A_log_dt, A_Dskip)
    x = x + _B_ref(_layernorm(x, axis=-1), B_k, B_v, B_shift_k, B_ssm_k, B_ssm_D)
    return x
```

```asm
; @launch grid=(256,1,1) block=(512,1,1) lds=163840
.amdgcn_target "amdgcn-amd-amdhsa--gfx950"
.text
.globl interleave_layers__ssm_conv_s5__ssm_conv_h3__prompt_kernel
.p2align 8
.type interleave_layers__ssm_conv_s5__ssm_conv_h3__prompt_kernel,@function
interleave_layers__ssm_conv_s5__ssm_conv_h3__prompt_kernel:
    s_cmp_ge_u32 s2, 256
    s_cbranch_scc1 L_end
    s_load_dwordx16 s[16:31], s[0:1], 0
    s_load_dwordx16 s[32:47], s[0:1], 64
    s_load_dwordx4 s[48:51], s[0:1], 128
    s_getpc_b64 s[60:61]
L_pc:
    v_lshrrev_b32 v1, 6, v0
    s_nop 0
    v_readfirstlane_b32 s54, v1
    s_andn2_b32 s62, s2, 7
    v_and_b32 v110, 1, v0
    v_lshl_add_u32 v110, v110, 8, v1
    v_add_lshl_u32 v110, v110, s62, 7
    v_min_u32 v110, L_end-L_pc, v110
    global_load_dword v111, v110, s[60:61]
    v_and_b32 v0, 63, v0
    v_and_b32 v1, 15, v0
    v_bfe_u32 v2, v0, 4, 2
    s_and_b32 s60, s2, 7
    s_lshr_b32 s61, s2, 3
    s_lshl_b32 s60, s60, 2
    s_lshr_b32 s62, s61, 3
    s_add_u32 s52, s60, s62
    s_and_b32 s53, s61, 7
    s_mov_b32 s56, 0
    s_mov_b32 s76, s54
    s_and_b32 s54, s54, 3
    s_mul_i32 s59, s54, 28672
    v_lshlrev_b32 v3, 4, v0
    v_mov_b32 v5, 151552
    v_mov_b32 v100, 0
    v_lshl_add_u32 v101, v0, 2, v5
    ds_write_b32 v101, v100
    v_lshrrev_b32 v102, 2, v1
    v_sub_u32 v102, 0, v102
    v_xor_b32 v102, v102, v2
    v_and_b32 v102, 3, v102
    v_lshl_add_u32 v102, v1, 2, v102
    v_lshlrev_b32 v4, 4, v102
    v_lshrrev_b32 v102, 2, v0
    v_sub_u32 v103, 0, v2
    v_xor_b32 v103, v103, v0
    v_and_b32 v103, 3, v103
    v_lshlrev_b32 v103, 4, v103
    s_and_b32 s60, s52, 3
    s_lshl_b32 s60, s60, 1
    s_add_u32 s60, s60, s53
    s_and_b32 s63, s60, 7
    s_lshl_b32 s3, s63, 7
    s_mov_b32 s64, s2
    s_mov_b32 s2, s53
    s_add_u32 s101, s54, 0
    s_and_b32 s101, s101, 3
    s_lshl_b32 s60, s52, 2
    s_add_u32 s60, s60, s101
    s_lshl_b32 s60, s60, 11
    s_add_u32 s58, s60, 20971520
    s_waitcnt lgkmcnt(0)
    s_mov_b32 s48, s76
    s_mov_b32 s49, s63
    s_mov_b32 s4, s50
    s_mov_b32 s5, s51
    s_mov_b32 s6, 268435456
    s_mov_b32 s7, 0x20000
    s_mov_b32 s60, 22069248
    buffer_load_dword v109, v100, s[4:7], s60 offen sc1
    s_cmp_ge_u32 s48, 4
    s_cbranch_scc1 L_X
    s_setprio 1
    s_mul_i32 s62, s53, 72
    s_lshl_b32 s61, s54, 4
    s_add_u32 s61, s61, s62
    v_add_lshl_u32 v105, v1, s61, 1
    global_load_ushort v96, v105, s[18:19]
    global_load_ushort v97, v105, s[20:21]
    global_load_ushort v98, v105, s[30:31]
    s_mul_i32 s61, s61, 1152
    v_mul_u32_u24 v29, 1152, v102
    v_add3_u32 v29, v29, v103, s61
    s_lshl_b32 s61, s52, 6
    s_lshl_b32 s60, s54, 2
    s_add_u32 s61, s61, s60
    s_mul_i32 s61, s61, 1152
    v_and_b32 v104, 3, v102
    v_lshl_add_u32 v104, v2, 4, v104
    v_mul_u32_u24 v30, 1152, v104
    v_add3_u32 v30, v30, v103, s61
    s_add_u32 s61, s62, 64
    s_mul_i32 s61, s61, 1152
    v_and_b32 v104, 7, v102
    v_mul_u32_u24 v104, 1152, v104
    v_add3_u32 v9, v104, v103, s61
    s_lshl_b32 s65, s54, 13
    s_add_u32 s65, s65, 73728
    s_lshl_b32 s66, s54, 10
    s_mov_b32 s8, s16
    s_mov_b32 s9, s17
    s_mov_b32 s10, 2359296
    s_mov_b32 s11, 0x20000
    s_mov_b32 s12, s22
    s_mov_b32 s13, s23
    s_mov_b32 s14, 663552
    s_mov_b32 s15, 0x20000
    s_mov_b32 s68, s24
    s_mov_b32 s69, s25
    s_mov_b32 s70, 663552
    s_mov_b32 s71, 0x20000
    s_mul_i32 s40, s54, 4096
    s_add_u32 s40, s40, 106496
    s_cmp_lt_u32 s54, 2
    s_cselect_b32 s72, s22, s24
    s_cselect_b32 s73, s23, s25
    s_mov_b32 s74, 663552
    s_mov_b32 s75, 0x20000
    s_cselect_b32 s38, -1, 0
    s_cselect_b32 s39, 0, -1
    s_and_b32 s60, s54, 1
    s_lshl_b32 s76, s60, 10
    s_lshl_b32 s67, s60, 6
    s_add_u32 s67, s67, s3
    s_add_u32 s61, s3, 0
    s_sub_u32 s60, s61, 1152
    s_min_u32 s61, s61, s60
    s_add_u32 m0, s66, 0
    s_nop 0
    buffer_load_dwordx4 v30, s[8:11], s61 offen lds
    s_add_u32 s61, s3, 64
    s_sub_u32 s60, s61, 1152
    s_min_u32 s61, s61, s60
    s_add_u32 m0, s66, 4096
    s_nop 0
    buffer_load_dwordx4 v30, s[8:11], s61 offen lds
    s_add_u32 s61, s3, 0
    s_sub_u32 s60, s61, 1152
    s_min_u32 s61, s61, s60
    s_add_u32 m0, s65, 0
    s_nop 0
    buffer_load_dwordx4 v29, s[12:15], s61 offen lds
    s_add_u32 m0, s65, 1984
    s_nop 0
    buffer_load_dwordx4 v29, s[12:15], s61 offen offset:64 lds
    s_add_u32 m0, s65, 1024
    s_nop 0
    buffer_load_dwordx4 v29, s[68:71], s61 offen lds
    s_add_u32 m0, s65, 3008
    s_nop 0
    buffer_load_dwordx4 v29, s[68:71], s61 offen offset:64 lds
    s_barrier
    s_add_u32 s61, s67, 0
    s_sub_u32 s60, s61, 1152
    s_min_u32 s61, s61, s60
    s_mov_b64 exec, s[38:39]
    s_add_u32 m0, s76, 133120
    s_nop 0
    buffer_load_dwordx4 v9, s[72:75], s61 offen lds
    s_mov_b64 exec, -1
    s_add_u32 s61, s67, 128
    s_sub_u32 s60, s61, 1152
    s_min_u32 s61, s61, s60
    s_mov_b64 exec, s[38:39]
    s_add_u32 m0, s76, 135168
    s_nop 0
    buffer_load_dwordx4 v9, s[72:75], s61 offen lds
    s_mov_b64 exec, -1
    s_add_u32 s61, s3, 128
    s_sub_u32 s60, s61, 1152
    s_min_u32 s61, s61, s60
    s_add_u32 m0, s65, 4096
    s_nop 0
    buffer_load_dwordx4 v29, s[12:15], s61 offen lds
    s_add_u32 m0, s65, 6080
    s_nop 0
    buffer_load_dwordx4 v29, s[12:15], s61 offen offset:64 lds
    s_add_u32 m0, s65, 5120
    s_nop 0
    buffer_load_dwordx4 v29, s[68:71], s61 offen lds
    s_add_u32 m0, s65, 7104
    s_nop 0
    buffer_load_dwordx4 v29, s[68:71], s61 offen offset:64 lds
    s_add_u32 s61, s3, 128
    s_sub_u32 s60, s61, 1152
    s_min_u32 s61, s61, s60
    s_add_u32 m0, s66, 8192
    s_nop 0
    buffer_load_dwordx4 v30, s[8:11], s61 offen lds
    s_add_u32 s61, s3, 192
    s_sub_u32 s60, s61, 1152
    s_min_u32 s61, s61, s60
    s_add_u32 m0, s66, 12288
    s_nop 0
    buffer_load_dwordx4 v30, s[8:11], s61 offen lds
    s_add_u32 s61, s3, 256
    s_sub_u32 s60, s61, 1152
    s_min_u32 s61, s61, s60
    s_add_u32 m0, s40, 0
    s_nop 0
    buffer_load_dwordx4 v29, s[12:15], s61 offen lds
    s_add_u32 m0, s40, 1984
    s_nop 0
    buffer_load_dwordx4 v29, s[12:15], s61 offen offset:64 lds
    s_add_u32 m0, s40, 1024
    s_nop 0
    buffer_load_dwordx4 v29, s[68:71], s61 offen lds
    s_add_u32 m0, s40, 3008
    s_nop 0
    buffer_load_dwordx4 v29, s[68:71], s61 offen offset:64 lds
    s_waitcnt vmcnt(18)
    v_readfirstlane_b32 s55, v109
    v_lshlrev_b32 v96, 16, v96
    v_lshlrev_b32 v97, 16, v97
    v_lshlrev_b32 v98, 16, v98
    v_mul_f32 v98, 0x3fb8aa3b, v98
    v_exp_f32 v98, v98
    s_nop 0
    v_cvt_pk_bf16_f32 v98, v98, 0
    v_lshlrev_b32 v98, 16, v98
    v_mul_f32 v32, v98, v96
    v_mul_f32 v33, v98, v97
    v_mul_f32 v32, 0x3fb8aa3b, v32
    v_exp_f32 v32, v32
    v_mul_f32 v33, 0.15915494, v33
    v_rndne_f32 v34, v33
    v_sub_f32 v33, v33, v34
    v_cos_f32 v6, v33
    v_sin_f32 v7, v33
    v_mul_f32 v6, v6, v32
    v_mul_f32 v7, v7, v32
    v_subrev_f32 v32, 1.0, v6
    v_mul_f32 v33, v96, v96
    v_fmac_f32 v33, v97, v97
    v_rcp_f32 v33, v33
    s_nop 0
    v_add_f32 v33, v33, v33
    v_mul_f32 v12, v32, v96
    v_fmac_f32 v12, v7, v97
    v_mul_f32 v12, v12, v33
    v_mul_f32 v13, v7, v96
    v_fma_f32 v13, -v32, v97, v13
    v_mul_f32 v13, v13, v33
    v_pk_mul_f32 v[34:35], v[6:7], v[6:7] op_sel:[0,0] op_sel_hi:[1,0]
    v_pk_fma_f32 v[34:35], v[6:7], v[6:7], v[34:35] op_sel:[1,1,0] op_sel_hi:[0,1,1] neg_lo:[1,0,0]
    v_pk_mul_f32 v[36:37], v[34:35], v[34:35] op_sel:[0,0] op_sel_hi:[1,0]
    v_pk_fma_f32 v[36:37], v[34:35], v[34:35], v[36:37] op_sel:[1,1,0] op_sel_hi:[0,1,1] neg_lo:[1,0,0]
    v_pk_mul_f32 v[38:39], v[36:37], v[36:37] op_sel:[0,0] op_sel_hi:[1,0]
    v_pk_fma_f32 v[38:39], v[36:37], v[36:37], v[38:39] op_sel:[1,1,0] op_sel_hi:[0,1,1] neg_lo:[1,0,0]
    v_pk_mul_f32 v[40:41], v[38:39], v[38:39] op_sel:[0,0] op_sel_hi:[1,0]
    v_pk_fma_f32 v[40:41], v[38:39], v[38:39], v[40:41] op_sel:[1,1,0] op_sel_hi:[0,1,1] neg_lo:[1,0,0]
    v_pk_mul_f32 v[42:43], v[40:41], v[40:41] op_sel:[0,0] op_sel_hi:[1,0]
    v_pk_fma_f32 v[42:43], v[40:41], v[40:41], v[42:43] op_sel:[1,1,0] op_sel_hi:[0,1,1] neg_lo:[1,0,0]
    v_pk_mul_f32 v[44:45], v[42:43], v[42:43] op_sel:[0,0] op_sel_hi:[1,0]
    v_pk_fma_f32 v[44:45], v[42:43], v[42:43], v[44:45] op_sel:[1,1,0] op_sel_hi:[0,1,1] neg_lo:[1,0,0]
    v_pk_mul_f32 v[46:47], v[44:45], v[44:45] op_sel:[0,0] op_sel_hi:[1,0]
    v_pk_fma_f32 v[46:47], v[44:45], v[44:45], v[46:47] op_sel:[1,1,0] op_sel_hi:[0,1,1] neg_lo:[1,0,0]
    v_pk_mul_f32 v[48:49], v[46:47], v[46:47] op_sel:[0,0] op_sel_hi:[1,0]
    v_pk_fma_f32 v[48:49], v[46:47], v[46:47], v[48:49] op_sel:[1,1,0] op_sel_hi:[0,1,1] neg_lo:[1,0,0]
    v_pk_mul_f32 v[50:51], v[48:49], v[48:49] op_sel:[0,0] op_sel_hi:[1,0]
    v_pk_fma_f32 v[50:51], v[48:49], v[48:49], v[50:51] op_sel:[1,1,0] op_sel_hi:[0,1,1] neg_lo:[1,0,0]
    v_pk_mul_f32 v[52:53], v[50:51], v[50:51] op_sel:[0,0] op_sel_hi:[1,0]
    v_pk_fma_f32 v[52:53], v[50:51], v[50:51], v[52:53] op_sel:[1,1,0] op_sel_hi:[0,1,1] neg_lo:[1,0,0]
    v_mov_b64 v[14:15], v[40:41]
    v_mov_b64 v[18:19], v[44:45]
    v_mov_b32 v10, 1.0
    v_mov_b32 v11, 0
    v_and_b32 v58, 1, v2
    v_cmp_eq_u32 vcc, 0, v58
    v_pk_mul_f32 v[56:57], v[10:11], v[40:41] op_sel:[0,0] op_sel_hi:[1,0]
    v_pk_fma_f32 v[56:57], v[10:11], v[40:41], v[56:57] op_sel:[1,1,0] op_sel_hi:[0,1,1] neg_lo:[1,0,0]
    v_cndmask_b32 v10, v10, v56, vcc
    v_cndmask_b32 v11, v11, v57, vcc
    v_and_b32 v58, 2, v2
    v_cmp_eq_u32 vcc, 0, v58
    v_pk_mul_f32 v[56:57], v[10:11], v[42:43] op_sel:[0,0] op_sel_hi:[1,0]
    v_pk_fma_f32 v[56:57], v[10:11], v[42:43], v[56:57] op_sel:[1,1,0] op_sel_hi:[0,1,1] neg_lo:[1,0,0]
    v_cndmask_b32 v10, v10, v56, vcc
    v_cndmask_b32 v11, v11, v57, vcc
    v_mov_b32 v16, 1.0
    v_mov_b32 v17, 0
    v_and_b32 v58, 1, v2
    v_cmp_ne_u32 vcc, 0, v58
    v_pk_mul_f32 v[56:57], v[16:17], v[40:41] op_sel:[0,0] op_sel_hi:[1,0]
    v_pk_fma_f32 v[56:57], v[16:17], v[40:41], v[56:57] op_sel:[1,1,0] op_sel_hi:[0,1,1] neg_lo:[1,0,0]
    v_cndmask_b32 v16, v16, v56, vcc
    v_cndmask_b32 v17, v17, v57, vcc
    v_and_b32 v58, 2, v2
    v_cmp_ne_u32 vcc, 0, v58
    v_pk_mul_f32 v[56:57], v[16:17], v[42:43] op_sel:[0,0] op_sel_hi:[1,0]
    v_pk_fma_f32 v[56:57], v[16:17], v[42:43], v[56:57] op_sel:[1,1,0] op_sel_hi:[0,1,1] neg_lo:[1,0,0]
    v_cndmask_b32 v16, v16, v56, vcc
    v_cndmask_b32 v17, v17, v57, vcc
    v_mov_b32 v20, 1.0
    v_mov_b32 v21, 0
    v_and_b32 v58, 1, v2
    v_cmp_ne_u32 vcc, 0, v58
    v_pk_mul_f32 v[56:57], v[20:21], v[50:51] op_sel:[0,0] op_sel_hi:[1,0]
    v_pk_fma_f32 v[56:57], v[20:21], v[50:51], v[56:57] op_sel:[1,1,0] op_sel_hi:[0,1,1] neg_lo:[1,0,0]
    v_cndmask_b32 v20, v20, v56, vcc
    v_cndmask_b32 v21, v21, v57, vcc
    v_and_b32 v58, 2, v2
    v_cmp_ne_u32 vcc, 0, v58
    v_pk_mul_f32 v[56:57], v[20:21], v[52:53] op_sel:[0,0] op_sel_hi:[1,0]
    v_pk_fma_f32 v[56:57], v[20:21], v[52:53], v[56:57] op_sel:[1,1,0] op_sel_hi:[0,1,1] neg_lo:[1,0,0]
    v_cndmask_b32 v20, v20, v56, vcc
    v_cndmask_b32 v21, v21, v57, vcc
    s_add_u32 s55, s55, 1
    v_mov_b32 v8, 1
    v_add_u32 v22, 0, v4
    v_add_u32 v23, 1024, v4
    v_add_u32 v24, 2048, v4
    v_add_u32 v25, 3072, v4
    v_add_u32 v26, s66, v22
    v_add_u32 v27, 133120, v4
    v_mov_b32 v80, 0x3f803f80
    v_mov_b32 v81, 0x3f803f80
    v_mov_b32 v82, 0x3f803f80
    v_mov_b32 v83, 0x3f803f80
    v_add_u32 v28, s65, v4
    v_add_u32 v31, s40, v4
    s_waitcnt vmcnt(4)
    v_mov_b32 v100, 1
    s_mov_b64 exec, 1
    ds_add_u32 v5, v100 offset:0
    s_mov_b64 exec, -1
    s_waitcnt vmcnt(12)
    ds_read_b128 a[0:3], v28 offset:0
    ds_read_b128 a[72:75], v28 offset:1024
    s_add_u32 s61, s67, 256
    s_sub_u32 s60, s61, 1152
    s_min_u32 s61, s61, s60
    s_mov_b64 exec, s[38:39]
    s_add_u32 m0, s76, 137216
    s_nop 0
    buffer_load_dwordx4 v9, s[72:75], s61 offen lds
    s_mov_b64 exec, -1
    s_add_u32 s61, s67, 384
    s_sub_u32 s60, s61, 1152
    s_min_u32 s61, s61, s60
    s_mov_b64 exec, s[38:39]
    s_add_u32 m0, s76, 139264
    s_nop 0
    buffer_load_dwordx4 v9, s[72:75], s61 offen lds
    s_mov_b64 exec, -1
    s_add_u32 s61, s3, 256
    s_sub_u32 s60, s61, 1152
    s_min_u32 s61, s61, s60
    s_add_u32 m0, s66, 16384
    s_nop 0
    buffer_load_dwordx4 v30, s[8:11], s61 offen lds
    s_add_u32 s61, s3, 320
    s_sub_u32 s60, s61, 1152
    s_min_u32 s61, s61, s60
    s_add_u32 m0, s66, 20480
    s_nop 0
    buffer_load_dwordx4 v30, s[8:11], s61 offen lds
    s_add_u32 s61, s3, 384
    s_sub_u32 s60, s61, 1152
    s_min_u32 s61, s61, s60
    s_add_u32 m0, s66, 24576
    s_nop 0
    buffer_load_dwordx4 v30, s[8:11], s61 offen lds
    s_add_u32 s61, s3, 448
    s_sub_u32 s60, s61, 1152
    s_min_u32 s61, s61, s60
    s_add_u32 m0, s66, 28672
    s_nop 0
    buffer_load_dwordx4 v30, s[8:11], s61 offen lds
    s_mov_b32 s77, 3200000
cw_1:
    ds_read_b32 v100, v5 offset:0
    s_waitcnt lgkmcnt(0)
    v_cmp_gt_u32 vcc, 4, v100
    s_cbranch_vccz cwo_2
    s_sub_u32 s77, s77, 1
    s_cmp_lg_u32 s77, 0
    s_cbranch_scc1 cw_1
cwo_2:
    ds_read_b128 v[84:87], v26 offset:0
    ds_read_b128 v[88:91], v27 offset:0
    ds_read_b128 v[92:95], v22 offset:0
    ds_read_b128 v[96:99], v23 offset:0
    ds_read_b128 v[100:103], v24 offset:0
    ds_read_b128 v[104:107], v25 offset:0
    ds_read_b128 v[108:111], v26 offset:4096
    s_waitcnt lgkmcnt(5)
    v_mfma_f32_16x16x32_bf16 v[64:67], v[84:87], v[88:91], 0
    v_mfma_f32_16x16x32_bf16 v[76:79], v[80:83], v[88:91], 0
    ds_read_b128 v[84:87], v27 offset:1024
    s_waitcnt lgkmcnt(5)
    v_mfma_f32_16x16x32_bf16 v[32:35], v[92:95], a[0:3], 0
    ds_read_b128 v[88:91], v22 offset:4096
    v_mfma_f32_16x16x32_bf16 v[36:39], v[92:95], a[72:75], 0
    s_waitcnt vmcnt(18)
    ds_read_b128 a[4:7], v28 offset:2048
    s_waitcnt lgkmcnt(6)
    v_mfma_f32_16x16x32_bf16 v[40:43], v[96:99], a[0:3], 0
    ds_read_b128 v[92:95], v23 offset:4096
    v_mfma_f32_16x16x32_bf16 v[44:47], v[96:99], a[72:75], 0
    ds_read_b128 a[76:79], v28 offset:3072
    s_waitcnt lgkmcnt(7)
    v_mfma_f32_16x16x32_bf16 v[48:51], v[100:103], a[0:3], 0
    ds_read_b128 v[96:99], v24 offset:4096
    v_mfma_f32_16x16x32_bf16 v[52:55], v[100:103], a[72:75], 0
    s_waitcnt lgkmcnt(7)
    v_mfma_f32_16x16x32_bf16 v[56:59], v[104:107], a[0:3], 0
    ds_read_b128 v[100:103], v25 offset:4096
    v_mfma_f32_16x16x32_bf16 v[60:63], v[104:107], a[72:75], 0
    v_mfma_f32_16x16x32_bf16 v[68:71], v[80:83], a[0:3], 0
    ds_read_b128 v[104:107], v26 offset:8192
    v_mfma_f32_16x16x32_bf16 v[72:75], v[80:83], a[72:75], 0
    s_waitcnt lgkmcnt(7)
    v_mfma_f32_16x16x32_bf16 v[64:67], v[108:111], v[84:87], v[64:67]
    v_mfma_f32_16x16x32_bf16 v[76:79], v[80:83], v[84:87], v[76:79]
    ds_read_b128 v[108:111], v27 offset:2048
    s_waitcnt lgkmcnt(4)
    v_mfma_f32_16x16x32_bf16 v[32:35], v[88:91], a[4:7], v[32:35]
    s_add_u32 s61, s3, 384
    s_sub_u32 s60, s61, 1152
    s_min_u32 s61, s61, s60
    s_add_u32 m0, s65, 0
    s_nop 0
    buffer_load_dwordx4 v29, s[12:15], s61 offen lds
    s_add_u32 m0, s65, 1984
    s_nop 0
    buffer_load_dwordx4 v29, s[12:15], s61 offen offset:64 lds
    s_add_u32 m0, s65, 1024
    s_nop 0
    buffer_load_dwordx4 v29, s[68:71], s61 offen lds
    s_add_u32 m0, s65, 3008
    s_nop 0
    buffer_load_dwordx4 v29, s[68:71], s61 offen offset:64 lds
    ds_read_b128 v[84:87], v22 offset:8192
    v_mfma_f32_16x16x32_bf16 v[36:39], v[88:91], a[76:79], v[36:39]
    s_waitcnt vmcnt(16)
    ds_read_b128 a[8:11], v28 offset:4096
    s_waitcnt lgkmcnt(7)
    v_mfma_f32_16x16x32_bf16 v[40:43], v[92:95], a[4:7], v[40:43]
    ds_read_b128 v[88:91], v23 offset:8192
    v_mfma_f32_16x16x32_bf16 v[44:47], v[92:95], a[76:79], v[44:47]
    ds_read_b128 a[80:83], v28 offset:5120
    s_waitcnt lgkmcnt(7)
    v_mfma_f32_16x16x32_bf16 v[48:51], v[96:99], a[4:7], v[48:51]
    ds_read_b128 v[92:95], v24 offset:8192
    v_mfma_f32_16x16x32_bf16 v[52:55], v[96:99], a[76:79], v[52:55]
    s_waitcnt lgkmcnt(7)
    v_mfma_f32_16x16x32_bf16 v[56:59], v[100:103], a[4:7], v[56:59]
    ds_read_b128 v[96:99], v25 offset:8192
    v_mfma_f32_16x16x32_bf16 v[60:63], v[100:103], a[76:79], v[60:63]
    v_mfma_f32_16x16x32_bf16 v[68:71], v[80:83], a[4:7], v[68:71]
    ds_read_b128 v[100:103], v26 offset:12288
    v_mfma_f32_16x16x32_bf16 v[72:75], v[80:83], a[76:79], v[72:75]
    s_waitcnt lgkmcnt(7)
    v_mfma_f32_16x16x32_bf16 v[64:67], v[104:107], v[108:111], v[64:67]
    v_mfma_f32_16x16x32_bf16 v[76:79], v[80:83], v[108:111], v[76:79]
    ds_read_b128 v[104:107], v27 offset:3072
    s_waitcnt lgkmcnt(4)
    v_mfma_f32_16x16x32_bf16 v[32:35], v[84:87], a[8:11], v[32:35]
    ds_read_b128 v[108:111], v22 offset:12288
    v_mfma_f32_16x16x32_bf16 v[36:39], v[84:87], a[80:83], v[36:39]
    s_waitcnt vmcnt(4)
    s_mov_b64 exec, 1
    ds_add_u32 v5, v8 offset:4
    s_mov_b64 exec, -1
    s_waitcnt vmcnt(16)
    ds_read_b128 a[12:15], v28 offset:6144
    s_waitcnt lgkmcnt(8)
    v_mfma_f32_16x16x32_bf16 v[40:43], v[88:91], a[8:11], v[40:43]
    ds_read_b128 v[84:87], v23 offset:12288
    v_mfma_f32_16x16x32_bf16 v[44:47], v[88:91], a[80:83], v[44:47]
    ds_read_b128 a[84:87], v28 offset:7168
    s_waitcnt lgkmcnt(8)
    v_mfma_f32_16x16x32_bf16 v[48:51], v[92:95], a[8:11], v[48:51]
    ds_read_b128 v[88:91], v24 offset:12288
    v_mfma_f32_16x16x32_bf16 v[52:55], v[92:95], a[80:83], v[52:55]
    s_waitcnt lgkmcnt(8)
    v_mfma_f32_16x16x32_bf16 v[56:59], v[96:99], a[8:11], v[56:59]
    ds_read_b128 v[92:95], v25 offset:12288
    v_mfma_f32_16x16x32_bf16 v[60:63], v[96:99], a[80:83], v[60:63]
    v_mfma_f32_16x16x32_bf16 v[68:71], v[80:83], a[8:11], v[68:71]
    s_mov_b32 s77, 3200000
cw_3:
    ds_read_b32 v96, v5 offset:4
    s_waitcnt lgkmcnt(0)
    v_cmp_gt_u32 vcc, 4, v96
    s_cbranch_vccz cwo_4
    s_sub_u32 s77, s77, 1
    s_cmp_lg_u32 s77, 0
    s_cbranch_scc1 cw_3
cwo_4:
    ds_read_b128 v[96:99], v26 offset:16384
    v_mfma_f32_16x16x32_bf16 v[72:75], v[80:83], a[80:83], v[72:75]
    s_waitcnt lgkmcnt(8)
    v_mfma_f32_16x16x32_bf16 v[64:67], v[100:103], v[104:107], v[64:67]
    v_mfma_f32_16x16x32_bf16 v[76:79], v[80:83], v[104:107], v[76:79]
    ds_read_b128 v[100:103], v27 offset:4096
    s_waitcnt lgkmcnt(4)
    v_mfma_f32_16x16x32_bf16 v[32:35], v[108:111], a[12:15], v[32:35]
    s_add_u32 s61, s3, 512
    s_sub_u32 s60, s61, 1152
    s_min_u32 s61, s61, s60
    s_add_u32 m0, s65, 4096
    s_nop 0
    buffer_load_dwordx4 v29, s[12:15], s61 offen lds
    s_add_u32 m0, s65, 6080
    s_nop 0
    buffer_load_dwordx4 v29, s[12:15], s61 offen offset:64 lds
    s_add_u32 m0, s65, 5120
    s_nop 0
    buffer_load_dwordx4 v29, s[68:71], s61 offen lds
    s_add_u32 m0, s65, 7104
    s_nop 0
    buffer_load_dwordx4 v29, s[68:71], s61 offen offset:64 lds
    ds_read_b128 v[104:107], v22 offset:16384
    v_mfma_f32_16x16x32_bf16 v[36:39], v[108:111], a[84:87], v[36:39]
    s_waitcnt vmcnt(14)
    ds_read_b128 a[16:19], v31 offset:0
    s_waitcnt lgkmcnt(7)
    v_mfma_f32_16x16x32_bf16 v[40:43], v[84:87], a[12:15], v[40:43]
    ds_read_b128 v[108:111], v23 offset:16384
    v_mfma_f32_16x16x32_bf16 v[44:47], v[84:87], a[84:87], v[44:47]
    ds_read_b128 a[88:91], v31 offset:1024
    s_waitcnt lgkmcnt(7)
    v_mfma_f32_16x16x32_bf16 v[48:51], v[88:91], a[12:15], v[48:51]
    ds_read_b128 v[84:87], v24 offset:16384
    v_mfma_f32_16x16x32_bf16 v[52:55], v[88:91], a[84:87], v[52:55]
    s_waitcnt lgkmcnt(7)
    v_mfma_f32_16x16x32_bf16 v[56:59], v[92:95], a[12:15], v[56:59]
    ds_read_b128 v[88:91], v25 offset:16384
    v_mfma_f32_16x16x32_bf16 v[60:63], v[92:95], a[84:87], v[60:63]
    v_mfma_f32_16x16x32_bf16 v[68:71], v[80:83], a[12:15], v[68:71]
    ds_read_b128 v[92:95], v26 offset:20480
    v_mfma_f32_16x16x32_bf16 v[72:75], v[80:83], a[84:87], v[72:75]
    s_waitcnt lgkmcnt(7)
    v_mfma_f32_16x16x32_bf16 v[64:67], v[96:99], v[100:103], v[64:67]
    v_mfma_f32_16x16x32_bf16 v[76:79], v[80:83], v[100:103], v[76:79]
    ds_read_b128 v[96:99], v27 offset:5120
    s_waitcnt lgkmcnt(4)
    v_mfma_f32_16x16x32_bf16 v[32:35], v[104:107], a[16:19], v[32:35]
    ds_read_b128 v[100:103], v22 offset:20480
    v_mfma_f32_16x16x32_bf16 v[36:39], v[104:107], a[88:91], v[36:39]
    s_waitcnt vmcnt(14)
    ds_read_b128 a[20:23], v31 offset:2048
    s_waitcnt lgkmcnt(7)
    v_mfma_f32_16x16x32_bf16 v[40:43], v[108:111], a[16:19], v[40:43]
    ds_read_b128 v[104:107], v23 offset:20480
    v_mfma_f32_16x16x32_bf16 v[44:47], v[108:111], a[88:91], v[44:47]
    ds_read_b128 a[92:95], v31 offset:3072
    s_waitcnt lgkmcnt(7)
    v_mfma_f32_16x16x32_bf16 v[48:51], v[84:87], a[16:19], v[48:51]
    ds_read_b128 v[108:111], v24 offset:20480
    v_mfma_f32_16x16x32_bf16 v[52:55], v[84:87], a[88:91], v[52:55]
    s_waitcnt lgkmcnt(7)
    v_mfma_f32_16x16x32_bf16 v[56:59], v[88:91], a[16:19], v[56:59]
    ds_read_b128 v[84:87], v25 offset:20480
    v_mfma_f32_16x16x32_bf16 v[60:63], v[88:91], a[88:91], v[60:63]
    v_mfma_f32_16x16x32_bf16 v[68:71], v[80:83], a[16:19], v[68:71]
    ds_read_b128 v[88:91], v26 offset:24576
    v_mfma_f32_16x16x32_bf16 v[72:75], v[80:83], a[88:91], v[72:75]
    s_waitcnt lgkmcnt(7)
    v_mfma_f32_16x16x32_bf16 v[64:67], v[92:95], v[96:99], v[64:67]
    v_mfma_f32_16x16x32_bf16 v[76:79], v[80:83], v[96:99], v[76:79]
    ds_read_b128 v[92:95], v27 offset:6144
    s_waitcnt lgkmcnt(4)
    v_mfma_f32_16x16x32_bf16 v[32:35], v[100:103], a[20:23], v[32:35]
    s_add_u32 s61, s3, 640
    s_sub_u32 s60, s61, 1152
    s_min_u32 s61, s61, s60
    s_add_u32 m0, s40, 0
    s_nop 0
    buffer_load_dwordx4 v29, s[12:15], s61 offen lds
    s_add_u32 m0, s40, 1984
    s_nop 0
    buffer_load_dwordx4 v29, s[12:15], s61 offen offset:64 lds
    s_add_u32 m0, s40, 1024
    s_nop 0
    buffer_load_dwordx4 v29, s[68:71], s61 offen lds
    s_add_u32 m0, s40, 3008
    s_nop 0
    buffer_load_dwordx4 v29, s[68:71], s61 offen offset:64 lds
    ds_read_b128 v[96:99], v22 offset:24576
    v_mfma_f32_16x16x32_bf16 v[36:39], v[100:103], a[92:95], v[36:39]
    s_waitcnt vmcnt(8)
    ds_read_b128 a[24:27], v28 offset:0
    s_waitcnt lgkmcnt(7)
    v_mfma_f32_16x16x32_bf16 v[40:43], v[104:107], a[20:23], v[40:43]
    ds_read_b128 v[100:103], v23 offset:24576
    v_mfma_f32_16x16x32_bf16 v[44:47], v[104:107], a[92:95], v[44:47]
    ds_read_b128 a[96:99], v28 offset:1024
    s_waitcnt lgkmcnt(7)
    v_mfma_f32_16x16x32_bf16 v[48:51], v[108:111], a[20:23], v[48:51]
    ds_read_b128 v[104:107], v24 offset:24576
    v_mfma_f32_16x16x32_bf16 v[52:55], v[108:111], a[92:95], v[52:55]
    s_waitcnt lgkmcnt(7)
    v_mfma_f32_16x16x32_bf16 v[56:59], v[84:87], a[20:23], v[56:59]
    ds_read_b128 v[108:111], v25 offset:24576
    v_mfma_f32_16x16x32_bf16 v[60:63], v[84:87], a[92:95], v[60:63]
    v_mfma_f32_16x16x32_bf16 v[68:71], v[80:83], a[20:23], v[68:71]
    ds_read_b128 v[84:87], v26 offset:28672
    v_mfma_f32_16x16x32_bf16 v[72:75], v[80:83], a[92:95], v[72:75]
    s_waitcnt lgkmcnt(7)
    v_mfma_f32_16x16x32_bf16 v[64:67], v[88:91], v[92:95], v[64:67]
    v_mfma_f32_16x16x32_bf16 v[76:79], v[80:83], v[92:95], v[76:79]
    ds_read_b128 v[88:91], v27 offset:7168
    s_waitcnt lgkmcnt(4)
    v_mfma_f32_16x16x32_bf16 v[32:35], v[96:99], a[24:27], v[32:35]
    ds_read_b128 v[92:95], v22 offset:28672
    v_mfma_f32_16x16x32_bf16 v[36:39], v[96:99], a[96:99], v[36:39]
    s_waitcnt vmcnt(8)
    ds_read_b128 a[28:31], v28 offset:2048
    s_waitcnt lgkmcnt(7)
    v_mfma_f32_16x16x32_bf16 v[40:43], v[100:103], a[24:27], v[40:43]
    ds_read_b128 v[96:99], v23 offset:28672
    v_mfma_f32_16x16x32_bf16 v[44:47], v[100:103], a[96:99], v[44:47]
    ds_read_b128 a[100:103], v28 offset:3072
    s_waitcnt lgkmcnt(7)
    v_mfma_f32_16x16x32_bf16 v[48:51], v[104:107], a[24:27], v[48:51]
    ds_read_b128 v[100:103], v24 offset:28672
    v_mfma_f32_16x16x32_bf16 v[52:55], v[104:107], a[96:99], v[52:55]
    s_waitcnt lgkmcnt(7)
    v_mfma_f32_16x16x32_bf16 v[56:59], v[108:111], a[24:27], v[56:59]
    ds_read_b128 v[104:107], v25 offset:28672
    v_mfma_f32_16x16x32_bf16 v[60:63], v[108:111], a[96:99], v[60:63]
    v_mfma_f32_16x16x32_bf16 v[68:71], v[80:83], a[24:27], v[68:71]
    s_mov_b32 s77, 3200000
cw_5:
    ds_read_b32 v108, v5 offset:8
    s_waitcnt lgkmcnt(0)
    v_cmp_gt_u32 vcc, 4, v108
    s_cbranch_vccz cwo_6
    s_sub_u32 s77, s77, 1
    s_cmp_lg_u32 s77, 0
    s_cbranch_scc1 cw_5
cwo_6:
    ds_read_b128 v[108:111], v26 offset:32768
    v_mfma_f32_16x16x32_bf16 v[72:75], v[80:83], a[96:99], v[72:75]
    s_waitcnt lgkmcnt(7)
    v_mfma_f32_16x16x32_bf16 v[64:67], v[84:87], v[88:91], v[64:67]
    v_mfma_f32_16x16x32_bf16 v[76:79], v[80:83], v[88:91], v[76:79]
    ds_read_b128 v[84:87], v27 offset:8192
    s_waitcnt lgkmcnt(4)
    v_mfma_f32_16x16x32_bf16 v[32:35], v[92:95], a[28:31], v[32:35]
    s_add_u32 s61, s3, 768
    s_sub_u32 s60, s61, 1152
    s_min_u32 s61, s61, s60
    s_add_u32 m0, s65, 0
    s_nop 0
    buffer_load_dwordx4 v29, s[12:15], s61 offen lds
    s_add_u32 m0, s65, 1984
    s_nop 0
    buffer_load_dwordx4 v29, s[12:15], s61 offen offset:64 lds
    s_add_u32 m0, s65, 1024
    s_nop 0
    buffer_load_dwordx4 v29, s[68:71], s61 offen lds
    s_add_u32 m0, s65, 3008
    s_nop 0
    buffer_load_dwordx4 v29, s[68:71], s61 offen offset:64 lds
    ds_read_b128 v[88:91], v22 offset:32768
    v_mfma_f32_16x16x32_bf16 v[36:39], v[92:95], a[100:103], v[36:39]
    s_mov_b64 exec, 1
    ds_add_u32 v5, v8 offset:12
    s_mov_b64 exec, -1
    s_waitcnt vmcnt(8)
    ds_read_b128 a[32:35], v28 offset:4096
    s_waitcnt lgkmcnt(8)
    v_mfma_f32_16x16x32_bf16 v[40:43], v[96:99], a[28:31], v[40:43]
    ds_read_b128 v[92:95], v23 offset:32768
    v_mfma_f32_16x16x32_bf16 v[44:47], v[96:99], a[100:103], v[44:47]
    ds_read_b128 a[104:107], v28 offset:5120
    s_waitcnt lgkmcnt(8)
    v_mfma_f32_16x16x32_bf16 v[48:51], v[100:103], a[28:31], v[48:51]
    ds_read_b128 v[96:99], v24 offset:32768
    v_mfma_f32_16x16x32_bf16 v[52:55], v[100:103], a[100:103], v[52:55]
    s_waitcnt lgkmcnt(8)
    v_mfma_f32_16x16x32_bf16 v[56:59], v[104:107], a[28:31], v[56:59]
    ds_read_b128 v[100:103], v25 offset:32768
    v_mfma_f32_16x16x32_bf16 v[60:63], v[104:107], a[100:103], v[60:63]
    v_mfma_f32_16x16x32_bf16 v[68:71], v[80:83], a[28:31], v[68:71]
    ds_read_b128 v[104:107], v26 offset:36864
    v_mfma_f32_16x16x32_bf16 v[72:75], v[80:83], a[100:103], v[72:75]
    s_waitcnt lgkmcnt(8)
    v_mfma_f32_16x16x32_bf16 v[64:67], v[108:111], v[84:87], v[64:67]
    v_mfma_f32_16x16x32_bf16 v[76:79], v[80:83], v[84:87], v[76:79]
    ds_read_b128 v[108:111], v27 offset:9216
    s_waitcnt lgkmcnt(4)
    v_mfma_f32_16x16x32_bf16 v[32:35], v[88:91], a[32:35], v[32:35]
    ds_read_b128 v[84:87], v22 offset:36864
    v_mfma_f32_16x16x32_bf16 v[36:39], v[88:91], a[104:107], v[36:39]
    s_waitcnt vmcnt(8)
    ds_read_b128 a[36:39], v28 offset:6144
    s_waitcnt lgkmcnt(7)
    v_mfma_f32_16x16x32_bf16 v[40:43], v[92:95], a[32:35], v[40:43]
    ds_read_b128 v[88:91], v23 offset:36864
    v_mfma_f32_16x16x32_bf16 v[44:47], v[92:95], a[104:107], v[44:47]
    ds_read_b128 a[108:111], v28 offset:7168
    s_waitcnt lgkmcnt(7)
    v_mfma_f32_16x16x32_bf16 v[48:51], v[96:99], a[32:35], v[48:51]
    ds_read_b128 v[92:95], v24 offset:36864
    v_mfma_f32_16x16x32_bf16 v[52:55], v[96:99], a[104:107], v[52:55]
    s_waitcnt lgkmcnt(7)
    v_mfma_f32_16x16x32_bf16 v[56:59], v[100:103], a[32:35], v[56:59]
    ds_read_b128 v[96:99], v25 offset:36864
    v_mfma_f32_16x16x32_bf16 v[60:63], v[100:103], a[104:107], v[60:63]
    v_mfma_f32_16x16x32_bf16 v[68:71], v[80:83], a[32:35], v[68:71]
    ds_read_b128 v[100:103], v26 offset:40960
    v_mfma_f32_16x16x32_bf16 v[72:75], v[80:83], a[104:107], v[72:75]
    s_waitcnt lgkmcnt(7)
    v_mfma_f32_16x16x32_bf16 v[64:67], v[104:107], v[108:111], v[64:67]
    v_mfma_f32_16x16x32_bf16 v[76:79], v[80:83], v[108:111], v[76:79]
    ds_read_b128 v[104:107], v27 offset:10240
    s_waitcnt lgkmcnt(4)
    v_mfma_f32_16x16x32_bf16 v[32:35], v[84:87], a[36:39], v[32:35]
    s_add_u32 s61, s3, 896
    s_sub_u32 s60, s61, 1152
    s_min_u32 s61, s61, s60
    s_add_u32 m0, s65, 4096
    s_nop 0
    buffer_load_dwordx4 v29, s[12:15], s61 offen lds
    s_add_u32 m0, s65, 6080
    s_nop 0
    buffer_load_dwordx4 v29, s[12:15], s61 offen offset:64 lds
    s_add_u32 m0, s65, 5120
    s_nop 0
    buffer_load_dwordx4 v29, s[68:71], s61 offen lds
    s_add_u32 m0, s65, 7104
    s_nop 0
    buffer_load_dwordx4 v29, s[68:71], s61 offen offset:64 lds
    ds_read_b128 v[108:111], v22 offset:40960
    v_mfma_f32_16x16x32_bf16 v[36:39], v[84:87], a[108:111], v[36:39]
    s_mov_b64 exec, 1
    ds_add_u32 v5, v8 offset:80
    s_mov_b64 exec, -1
    s_waitcnt vmcnt(8)
    ds_read_b128 a[40:43], v31 offset:0
    s_waitcnt lgkmcnt(8)
    v_mfma_f32_16x16x32_bf16 v[40:43], v[88:91], a[36:39], v[40:43]
    ds_read_b128 v[84:87], v23 offset:40960
    v_mfma_f32_16x16x32_bf16 v[44:47], v[88:91], a[108:111], v[44:47]
    ds_read_b128 a[112:115], v31 offset:1024
    s_waitcnt lgkmcnt(8)
    v_mfma_f32_16x16x32_bf16 v[48:51], v[92:95], a[36:39], v[48:51]
    ds_read_b128 v[88:91], v24 offset:40960
    v_mfma_f32_16x16x32_bf16 v[52:55], v[92:95], a[108:111], v[52:55]
    s_waitcnt lgkmcnt(8)
    v_mfma_f32_16x16x32_bf16 v[56:59], v[96:99], a[36:39], v[56:59]
    ds_read_b128 v[92:95], v25 offset:40960
    v_mfma_f32_16x16x32_bf16 v[60:63], v[96:99], a[108:111], v[60:63]
    v_mfma_f32_16x16x32_bf16 v[68:71], v[80:83], a[36:39], v[68:71]
    ds_read_b128 v[96:99], v26 offset:45056
    v_mfma_f32_16x16x32_bf16 v[72:75], v[80:83], a[108:111], v[72:75]
    s_waitcnt lgkmcnt(8)
    v_mfma_f32_16x16x32_bf16 v[64:67], v[100:103], v[104:107], v[64:67]
    v_mfma_f32_16x16x32_bf16 v[76:79], v[80:83], v[104:107], v[76:79]
    ds_read_b128 v[100:103], v27 offset:11264
    s_waitcnt lgkmcnt(4)
    v_mfma_f32_16x16x32_bf16 v[32:35], v[108:111], a[40:43], v[32:35]
    ds_read_b128 v[104:107], v22 offset:45056
    v_mfma_f32_16x16x32_bf16 v[36:39], v[108:111], a[112:115], v[36:39]
    s_waitcnt vmcnt(8)
    ds_read_b128 a[44:47], v31 offset:2048
    s_waitcnt lgkmcnt(7)
    v_mfma_f32_16x16x32_bf16 v[40:43], v[84:87], a[40:43], v[40:43]
    ds_read_b128 v[108:111], v23 offset:45056
    v_mfma_f32_16x16x32_bf16 v[44:47], v[84:87], a[112:115], v[44:47]
    ds_read_b128 a[116:119], v31 offset:3072
    s_waitcnt lgkmcnt(7)
    v_mfma_f32_16x16x32_bf16 v[48:51], v[88:91], a[40:43], v[48:51]
    ds_read_b128 v[84:87], v24 offset:45056
    v_mfma_f32_16x16x32_bf16 v[52:55], v[88:91], a[112:115], v[52:55]
    s_waitcnt lgkmcnt(7)
    v_mfma_f32_16x16x32_bf16 v[56:59], v[92:95], a[40:43], v[56:59]
    ds_read_b128 v[88:91], v25 offset:45056
    v_mfma_f32_16x16x32_bf16 v[60:63], v[92:95], a[112:115], v[60:63]
    v_mfma_f32_16x16x32_bf16 v[68:71], v[80:83], a[40:43], v[68:71]
    ds_read_b128 v[92:95], v26 offset:49152
    v_mfma_f32_16x16x32_bf16 v[72:75], v[80:83], a[112:115], v[72:75]
    s_waitcnt lgkmcnt(7)
    v_mfma_f32_16x16x32_bf16 v[64:67], v[96:99], v[100:103], v[64:67]
    v_mfma_f32_16x16x32_bf16 v[76:79], v[80:83], v[100:103], v[76:79]
    ds_read_b128 v[96:99], v27 offset:12288
    s_waitcnt lgkmcnt(4)
    v_mfma_f32_16x16x32_bf16 v[32:35], v[104:107], a[44:47], v[32:35]
    s_add_u32 s61, s3, 1024
    s_sub_u32 s60, s61, 1152
    s_min_u32 s61, s61, s60
    s_add_u32 m0, s40, 0
    s_nop 0
    buffer_load_dwordx4 v29, s[12:15], s61 offen lds
    s_add_u32 m0, s40, 1984
    s_nop 0
    buffer_load_dwordx4 v29, s[12:15], s61 offen offset:64 lds
    s_add_u32 m0, s40, 1024
    s_nop 0
    buffer_load_dwordx4 v29, s[68:71], s61 offen lds
    s_add_u32 m0, s40, 3008
    s_nop 0
    buffer_load_dwordx4 v29, s[68:71], s61 offen offset:64 lds
    ds_read_b128 v[100:103], v22 offset:49152
    v_mfma_f32_16x16x32_bf16 v[36:39], v[104:107], a[116:119], v[36:39]
    s_mov_b64 exec, 1
    ds_add_u32 v5, v8 offset:88
    s_mov_b64 exec, -1
    s_waitcnt vmcnt(8)
    ds_read_b128 a[48:51], v28 offset:0
    s_waitcnt lgkmcnt(8)
    v_mfma_f32_16x16x32_bf16 v[40:43], v[108:111], a[44:47], v[40:43]
    ds_read_b128 v[104:107], v23 offset:49152
    v_mfma_f32_16x16x32_bf16 v[44:47], v[108:111], a[116:119], v[44:47]
    ds_read_b128 a[120:123], v28 offset:1024
    s_waitcnt lgkmcnt(8)
    v_mfma_f32_16x16x32_bf16 v[48:51], v[84:87], a[44:47], v[48:51]
    ds_read_b128 v[108:111], v24 offset:49152
    v_mfma_f32_16x16x32_bf16 v[52:55], v[84:87], a[116:119], v[52:55]
    s_waitcnt lgkmcnt(8)
    v_mfma_f32_16x16x32_bf16 v[56:59], v[88:91], a[44:47], v[56:59]
    ds_read_b128 v[84:87], v25 offset:49152
    v_mfma_f32_16x16x32_bf16 v[60:63], v[88:91], a[116:119], v[60:63]
    v_mfma_f32_16x16x32_bf16 v[68:71], v[80:83], a[44:47], v[68:71]
    s_mov_b32 s77, 3200000
cw_7:
    ds_read_b32 v88, v5 offset:60
    s_waitcnt lgkmcnt(0)
    v_cmp_gt_u32 vcc, 4, v88
    s_cbranch_vccz cwo_8
    s_sub_u32 s77, s77, 1
    s_cmp_lg_u32 s77, 0
    s_cbranch_scc1 cw_7
cwo_8:
    ds_read_b128 v[88:91], v26 offset:53248
    v_mfma_f32_16x16x32_bf16 v[72:75], v[80:83], a[116:119], v[72:75]
    s_waitcnt lgkmcnt(8)
    v_mfma_f32_16x16x32_bf16 v[64:67], v[92:95], v[96:99], v[64:67]
    v_mfma_f32_16x16x32_bf16 v[76:79], v[80:83], v[96:99], v[76:79]
    ds_read_b128 v[92:95], v27 offset:13312
    s_waitcnt lgkmcnt(4)
    v_mfma_f32_16x16x32_bf16 v[32:35], v[100:103], a[48:51], v[32:35]
    ds_read_b128 v[96:99], v22 offset:53248
    v_mfma_f32_16x16x32_bf16 v[36:39], v[100:103], a[120:123], v[36:39]
    s_waitcnt vmcnt(8)
    ds_read_b128 a[52:55], v28 offset:2048
    s_waitcnt lgkmcnt(7)
    v_mfma_f32_16x16x32_bf16 v[40:43], v[104:107], a[48:51], v[40:43]
    ds_read_b128 v[100:103], v23 offset:53248
    v_mfma_f32_16x16x32_bf16 v[44:47], v[104:107], a[120:123], v[44:47]
    ds_read_b128 a[124:127], v28 offset:3072
    s_waitcnt lgkmcnt(7)
    v_mfma_f32_16x16x32_bf16 v[48:51], v[108:111], a[48:51], v[48:51]
    ds_read_b128 v[104:107], v24 offset:53248
    v_mfma_f32_16x16x32_bf16 v[52:55], v[108:111], a[120:123], v[52:55]
    s_waitcnt lgkmcnt(7)
    v_mfma_f32_16x16x32_bf16 v[56:59], v[84:87], a[48:51], v[56:59]
    ds_read_b128 v[108:111], v25 offset:53248
    v_mfma_f32_16x16x32_bf16 v[60:63], v[84:87], a[120:123], v[60:63]
    v_mfma_f32_16x16x32_bf16 v[68:71], v[80:83], a[48:51], v[68:71]
    ds_read_b128 v[84:87], v26 offset:57344
    v_mfma_f32_16x16x32_bf16 v[72:75], v[80:83], a[120:123], v[72:75]
    s_waitcnt lgkmcnt(7)
    v_mfma_f32_16x16x32_bf16 v[64:67], v[88:91], v[92:95], v[64:67]
    v_mfma_f32_16x16x32_bf16 v[76:79], v[80:83], v[92:95], v[76:79]
    ds_read_b128 v[88:91], v27 offset:14336
    s_waitcnt lgkmcnt(4)
    v_mfma_f32_16x16x32_bf16 v[32:35], v[96:99], a[52:55], v[32:35]
    ds_read_b128 v[92:95], v22 offset:57344
    v_mfma_f32_16x16x32_bf16 v[36:39], v[96:99], a[124:127], v[36:39]
    s_waitcnt vmcnt(4)
    ds_read_b128 a[56:59], v28 offset:4096
    s_waitcnt lgkmcnt(7)
    v_mfma_f32_16x16x32_bf16 v[40:43], v[100:103], a[52:55], v[40:43]
    ds_read_b128 v[96:99], v23 offset:57344
    v_mfma_f32_16x16x32_bf16 v[44:47], v[100:103], a[124:127], v[44:47]
    ds_read_b128 a[128:131], v28 offset:5120
    s_waitcnt lgkmcnt(7)
    v_mfma_f32_16x16x32_bf16 v[48:51], v[104:107], a[52:55], v[48:51]
    ds_read_b128 v[100:103], v24 offset:57344
    v_mfma_f32_16x16x32_bf16 v[52:55], v[104:107], a[124:127], v[52:55]
    s_waitcnt lgkmcnt(7)
    v_mfma_f32_16x16x32_bf16 v[56:59], v[108:111], a[52:55], v[56:59]
    ds_read_b128 v[104:107], v25 offset:57344
    v_mfma_f32_16x16x32_bf16 v[60:63], v[108:111], a[124:127], v[60:63]
    v_mfma_f32_16x16x32_bf16 v[68:71], v[80:83], a[52:55], v[68:71]
    ds_read_b128 v[108:111], v26 offset:61440
    v_mfma_f32_16x16x32_bf16 v[72:75], v[80:83], a[124:127], v[72:75]
    s_lshl_b32 s60, s56, 3
    s_add_u32 s60, s60, s2
    s_mul_i32 s60, s60, 36864
    s_add_u32 s60, s60, 19922944
    s_add_u32 s8, s50, s60
    s_addc_u32 s9, s51, 0
    s_mov_b32 s10, 36864
    s_mov_b32 s11, 0x20000
    s_sub_u32 s60, 31, s52
    s_mul_i32 s34, s60, 1152
    s_lshl_b32 s60, s56, 5
    s_add_u32 s60, s60, s52
    s_mul_i32 s57, s60, 147456
    s_lshl_b32 s60, s60, 7
    s_add_u32 s35, s60, 22020096
    s_lshl_b32 s1, s2, 2
    s_add_u32 s1, s1, s35
    s_lshr_b32 s60, s2, 2
    s_mul_i32 s62, s60, 36864
    s_add_u32 s62, s62, s57
    s_add_u32 s63, s62, 73728
    s_and_b32 s64, s2, 3
    s_mul_i32 s64, s64, 9
    s_waitcnt lgkmcnt(7)
    v_mfma_f32_16x16x32_bf16 v[64:67], v[84:87], v[88:91], v[64:67]
    v_mfma_f32_16x16x32_bf16 v[76:79], v[80:83], v[88:91], v[76:79]
    ds_read_b128 v[84:87], v27 offset:15360
    s_waitcnt lgkmcnt(4)
    v_mfma_f32_16x16x32_bf16 v[32:35], v[92:95], a[56:59], v[32:35]
    ds_read_b128 v[88:91], v22 offset:61440
    v_mfma_f32_16x16x32_bf16 v[36:39], v[92:95], a[128:131], v[36:39]
    s_waitcnt vmcnt(4)
    ds_read_b128 a[60:63], v28 offset:6144
    s_waitcnt lgkmcnt(7)
    v_mfma_f32_16x16x32_bf16 v[40:43], v[96:99], a[56:59], v[40:43]
    ds_read_b128 v[92:95], v23 offset:61440
    v_mfma_f32_16x16x32_bf16 v[44:47], v[96:99], a[128:131], v[44:47]
    ds_read_b128 a[132:135], v28 offset:7168
    s_waitcnt lgkmcnt(7)
    v_mfma_f32_16x16x32_bf16 v[48:51], v[100:103], a[56:59], v[48:51]
    ds_read_b128 v[96:99], v24 offset:61440
    v_mfma_f32_16x16x32_bf16 v[52:55], v[100:103], a[128:131], v[52:55]
    s_waitcnt lgkmcnt(7)
    v_mfma_f32_16x16x32_bf16 v[56:59], v[104:107], a[56:59], v[56:59]
    ds_read_b128 v[100:103], v25 offset:61440
    v_mfma_f32_16x16x32_bf16 v[60:63], v[104:107], a[128:131], v[60:63]
    v_mfma_f32_16x16x32_bf16 v[68:71], v[80:83], a[56:59], v[68:71]
    v_add_u32 v22, 32768, v22
    v_add_u32 v23, 32768, v23
    v_add_u32 v24, 32768, v24
    v_add_u32 v25, 32768, v25
    v_add_u32 v26, 32768, v26
    ds_read_b128 v[104:107], v26 offset:32768
    v_mfma_f32_16x16x32_bf16 v[72:75], v[80:83], a[128:131], v[72:75]
    s_waitcnt lgkmcnt(7)
    v_mfma_f32_16x16x32_bf16 v[64:67], v[108:111], v[84:87], v[64:67]
    ds_read_b32 v29, v5 offset:24
    v_mfma_f32_16x16x32_bf16 v[76:79], v[80:83], v[84:87], v[76:79]
    ds_read_b128 v[108:111], v27 offset:16384
    s_waitcnt lgkmcnt(5)
    v_mfma_f32_16x16x32_bf16 v[32:35], v[88:91], a[60:63], v[32:35]
    ds_read_b128 v[84:87], v22 offset:32768
    v_mfma_f32_16x16x32_bf16 v[36:39], v[88:91], a[132:135], v[36:39]
    s_waitcnt vmcnt(0)
    ds_read_b128 a[64:67], v31 offset:0
    s_waitcnt lgkmcnt(8)
    v_mfma_f32_16x16x32_bf16 v[40:43], v[92:95], a[60:63], v[40:43]
    ds_read_b128 v[88:91], v23 offset:32768
    v_mfma_f32_16x16x32_bf16 v[44:47], v[92:95], a[132:135], v[44:47]
    ds_read_b128 a[136:139], v31 offset:1024
    s_waitcnt lgkmcnt(8)
    v_mfma_f32_16x16x32_bf16 v[48:51], v[96:99], a[60:63], v[48:51]
    ds_read_b128 v[92:95], v24 offset:32768
    v_mfma_f32_16x16x32_bf16 v[52:55], v[96:99], a[132:135], v[52:55]
    s_waitcnt lgkmcnt(8)
    v_mfma_f32_16x16x32_bf16 v[56:59], v[100:103], a[60:63], v[56:59]
    ds_read_b128 v[96:99], v25 offset:32768
    v_mfma_f32_16x16x32_bf16 v[60:63], v[100:103], a[132:135], v[60:63]
    v_mfma_f32_16x16x32_bf16 v[68:71], v[80:83], a[60:63], v[68:71]
    ds_read_b128 v[100:103], v26 offset:36864
    v_mfma_f32_16x16x32_bf16 v[72:75], v[80:83], a[132:135], v[72:75]
    s_waitcnt lgkmcnt(8)
    v_cmp_gt_u32 vcc, 1, v29
    s_cbranch_vccz scok_9
    s_mov_b32 s77, 3200000
cw_10:
    ds_read_b32 v29, v5 offset:24
    s_waitcnt lgkmcnt(0)
    v_cmp_gt_u32 vcc, 1, v29
    s_cbranch_vccz cwo_11
    s_sub_u32 s77, s77, 1
    s_cmp_lg_u32 s77, 0
    s_cbranch_scc1 cw_10
cwo_11:
scok_9:
    v_lshlrev_b32 v30, 7, v2
    v_add_u32 v30, 151808, v30
    s_waitcnt lgkmcnt(7)
    v_mfma_f32_16x16x32_bf16 v[64:67], v[104:107], v[108:111], v[64:67]
    v_mfma_f32_16x16x32_bf16 v[76:79], v[80:83], v[108:111], v[76:79]
    ds_read_b128 v[104:107], v27 offset:17408
    s_waitcnt lgkmcnt(4)
    v_mfma_f32_16x16x32_bf16 v[32:35], v[84:87], a[64:67], v[32:35]
    ds_read_b128 v[108:111], v22 offset:36864
    v_mfma_f32_16x16x32_bf16 v[36:39], v[84:87], a[136:139], v[36:39]
    s_waitcnt vmcnt(0)
    ds_read_b128 a[68:71], v31 offset:2048
    s_waitcnt lgkmcnt(7)
    v_mfma_f32_16x16x32_bf16 v[40:43], v[88:91], a[64:67], v[40:43]
    ds_read_b128 v[84:87], v23 offset:36864
    v_mfma_f32_16x16x32_bf16 v[44:47], v[88:91], a[136:139], v[44:47]
    ds_read_b128 a[140:143], v31 offset:3072
    s_waitcnt lgkmcnt(7)
    v_mfma_f32_16x16x32_bf16 v[48:51], v[92:95], a[64:67], v[48:51]
    ds_read_b128 v[88:91], v24 offset:36864
    v_mfma_f32_16x16x32_bf16 v[52:55], v[92:95], a[136:139], v[52:55]
    s_waitcnt lgkmcnt(7)
    v_mfma_f32_16x16x32_bf16 v[56:59], v[96:99], a[64:67], v[56:59]
    ds_read_b128 v[92:95], v25 offset:36864
    v_mfma_f32_16x16x32_bf16 v[60:63], v[96:99], a[136:139], v[60:63]
    ds_read_b128 v[96:99], v30 offset:0
    v_mfma_f32_16x16x32_bf16 v[68:71], v[80:83], a[64:67], v[68:71]
    v_mfma_f32_16x16x32_bf16 v[72:75], v[80:83], a[136:139], v[72:75]
    s_waitcnt lgkmcnt(7)
    v_mfma_f32_16x16x32_bf16 v[64:67], v[100:103], v[104:107], v[64:67]
    ds_read_b128 v[100:103], v30 offset:16
    v_mfma_f32_16x16x32_bf16 v[76:79], v[80:83], v[104:107], v[76:79]
    ds_read_b128 v[104:107], v30 offset:32
    s_waitcnt lgkmcnt(5)
    v_mfma_f32_16x16x32_bf16 v[32:35], v[108:111], a[68:71], v[32:35]
    v_mfma_f32_16x16x32_bf16 v[36:39], v[108:111], a[140:143], v[36:39]
    ds_read_b128 v[108:111], v30 offset:48
    s_waitcnt lgkmcnt(7)
    v_mfma_f32_16x16x32_bf16 v[40:43], v[84:87], a[68:71], v[40:43]
    v_mfma_f32_16x16x32_bf16 v[44:47], v[84:87], a[140:143], v[44:47]
    ds_read_b128 v[84:87], v30 offset:64
    s_waitcnt lgkmcnt(6)
    v_mfma_f32_16x16x32_bf16 v[48:51], v[88:91], a[68:71], v[48:51]
    v_mfma_f32_16x16x32_bf16 v[52:55], v[88:91], a[140:143], v[52:55]
    ds_read_b128 v[88:91], v30 offset:80
    s_waitcnt lgkmcnt(6)
    v_mfma_f32_16x16x32_bf16 v[56:59], v[92:95], a[68:71], v[56:59]
    v_mfma_f32_16x16x32_bf16 v[60:63], v[92:95], a[140:143], v[60:63]
    ds_read_b128 v[92:95], v30 offset:96
    v_mfma_f32_16x16x32_bf16 v[68:71], v[80:83], a[68:71], v[68:71]
    v_mfma_f32_16x16x32_bf16 v[72:75], v[80:83], a[140:143], v[72:75]
    v_and_b32 v31, 7, v1
    v_mul_u32_u24 v31, 528, v31
    v_lshl_add_u32 v31, v2, 7, v31
    v_lshrrev_b32 v29, 3, v1
    v_lshl_add_u32 v31, v29, 2, v31
    s_lshl_b32 s60, s54, 5
    s_add_u32 s60, s60, 152576
    v_add_u32 v31, s60, v31
    ds_read_b128 v[80:83], v30 offset:112
    s_setprio 3
    ds_write2_b32 v31, v64, v65 offset0:0 offset1:2
    ds_write2_b32 v31, v66, v67 offset0:4 offset1:6
    v_and_b32 v77, 7, v1
    v_lshrrev_b32 v78, 3, v1
    v_lshlrev_b32 v77, 3, v77
    v_lshl_add_u32 v77, v78, 2, v77
    v_add_u32 v77, 152320, v77
    ds_write_b32 v77, v76
    v_mov_b32 v8, v68
    v_mov_b32 v9, v72
    v_mov_b32 v64, 1
    s_mov_b64 exec, 1
    ds_add_u32 v5, v64 offset:32
    s_mov_b64 exec, -1
    s_waitcnt lgkmcnt(11)
    v_mul_f32 v22, v97, v8
    v_mul_f32 v23, v97, v9
    v_fma_f32 v22, v96, v32, -v22
    v_fma_f32 v23, v96, v36, -v23
    v_mul_f32 v24, v99, v8
    v_mul_f32 v25, v99, v9
    v_fma_f32 v24, v98, v33, -v24
    v_fma_f32 v25, v98, v37, -v25
    v_fmac_f32 v24, v22, v6
    v_fmac_f32 v25, v23, v6
    v_fma_f32 v24, -v23, v7, v24
    v_fmac_f32 v25, v22, v7
    s_waitcnt lgkmcnt(10)
    v_mul_f32 v26, v101, v8
    v_mul_f32 v27, v101, v9
    v_fma_f32 v26, v100, v34, -v26
    v_fma_f32 v27, v100, v38, -v27
    v_fmac_f32 v26, v24, v6
    v_fmac_f32 v27, v25, v6
    v_fma_f32 v26, -v25, v7, v26
    v_fmac_f32 v27, v24, v7
    v_mul_f32 v28, v103, v8
    v_mul_f32 v29, v103, v9
    v_fma_f32 v28, v102, v35, -v28
    v_fma_f32 v29, v102, v39, -v29
    v_fmac_f32 v28, v26, v6
    v_fmac_f32 v29, v27, v6
    v_fma_f32 v28, -v27, v7, v28
    v_fmac_f32 v29, v26, v7
    s_waitcnt lgkmcnt(9)
    v_mul_f32 v32, v105, v8
    v_mul_f32 v33, v105, v9
    v_fma_f32 v32, v104, v40, -v32
    v_fma_f32 v33, v104, v44, -v33
    v_fmac_f32 v32, v28, v6
    v_fmac_f32 v33, v29, v6
    v_fma_f32 v32, -v29, v7, v32
    v_fmac_f32 v33, v28, v7
    v_mul_f32 v34, v107, v8
    v_mul_f32 v35, v107, v9
    v_fma_f32 v34, v106, v41, -v34
    v_fma_f32 v35, v106, v45, -v35
    v_fmac_f32 v34, v32, v6
    v_fmac_f32 v35, v33, v6
    v_fma_f32 v34, -v33, v7, v34
    v_fmac_f32 v35, v32, v7
    s_waitcnt lgkmcnt(8)
    v_mul_f32 v36, v109, v8
    v_mul_f32 v37, v109, v9
    v_fma_f32 v36, v108, v42, -v36
    v_fma_f32 v37, v108, v46, -v37
    v_fmac_f32 v36, v34, v6
    v_fmac_f32 v37, v35, v6
    v_fma_f32 v36, -v35, v7, v36
    v_fmac_f32 v37, v34, v7
    v_mul_f32 v38, v111, v8
    v_mul_f32 v39, v111, v9
    v_fma_f32 v38, v110, v43, -v38
    v_fma_f32 v39, v110, v47, -v39
    v_fmac_f32 v38, v36, v6
    v_fmac_f32 v39, v37, v6
    v_fma_f32 v38, -v37, v7, v38
    v_fmac_f32 v39, v36, v7
    s_waitcnt lgkmcnt(7)
    v_mul_f32 v40, v85, v8
    v_mul_f32 v41, v85, v9
    v_fma_f32 v40, v84, v48, -v40
    v_fma_f32 v41, v84, v52, -v41
    v_fmac_f32 v40, v38, v6
    v_fmac_f32 v41, v39, v6
    v_fma_f32 v40, -v39, v7, v40
    v_fmac_f32 v41, v38, v7
    v_mul_f32 v42, v87, v8
    v_mul_f32 v43, v87, v9
    v_fma_f32 v42, v86, v49, -v42
    v_fma_f32 v43, v86, v53, -v43
    v_fmac_f32 v42, v40, v6
    v_fmac_f32 v43, v41, v6
    v_fma_f32 v42, -v41, v7, v42
    v_fmac_f32 v43, v40, v7
    s_waitcnt lgkmcnt(6)
    v_mul_f32 v44, v89, v8
    v_mul_f32 v45, v89, v9
    v_fma_f32 v44, v88, v50, -v44
    v_fma_f32 v45, v88, v54, -v45
    v_fmac_f32 v44, v42, v6
    v_fmac_f32 v45, v43, v6
    v_fma_f32 v44, -v43, v7, v44
    v_fmac_f32 v45, v42, v7
    v_mul_f32 v46, v91, v8
    v_mul_f32 v47, v91, v9
    v_fma_f32 v46, v90, v51, -v46
    v_fma_f32 v47, v90, v55, -v47
    v_fmac_f32 v46, v44, v6
    v_fmac_f32 v47, v45, v6
    v_fma_f32 v46, -v45, v7, v46
    v_fmac_f32 v47, v44, v7
    s_waitcnt lgkmcnt(5)
    v_mul_f32 v48, v93, v8
    v_mul_f32 v49, v93, v9
    v_fma_f32 v48, v92, v56, -v48
    v_fma_f32 v49, v92, v60, -v49
    v_fmac_f32 v48, v46, v6
    v_fmac_f32 v49, v47, v6
    v_fma_f32 v48, -v47, v7, v48
    v_fmac_f32 v49, v46, v7
    v_mul_f32 v50, v95, v8
    v_mul_f32 v51, v95, v9
    v_fma_f32 v50, v94, v57, -v50
    v_fma_f32 v51, v94, v61, -v51
    v_fmac_f32 v50, v48, v6
    v_fmac_f32 v51, v49, v6
    v_fma_f32 v50, -v49, v7, v50
    v_fmac_f32 v51, v48, v7
    s_waitcnt lgkmcnt(4)
    v_mul_f32 v52, v81, v8
    v_mul_f32 v53, v81, v9
    v_fma_f32 v52, v80, v58, -v52
    v_fma_f32 v53, v80, v62, -v53
    v_fmac_f32 v52, v50, v6
    v_fmac_f32 v53, v51, v6
    v_fma_f32 v52, -v51, v7, v52
    v_fmac_f32 v53, v50, v7
    v_mul_f32 v54, v83, v8
    v_mul_f32 v55, v83, v9
    v_fma_f32 v54, v82, v59, -v54
    v_fma_f32 v55, v82, v63, -v55
    v_fmac_f32 v54, v52, v6
    v_fmac_f32 v55, v53, v6
    v_fma_f32 v54, -v53, v7, v54
    v_fmac_f32 v55, v52, v7
    s_lshl_b32 s60, s54, 8
    s_add_u32 s60, s60, s34
    v_mul_f32 v56, v54, v10
    v_mul_f32 v57, v55, v10
    v_fma_f32 v56, -v55, v11, v56
    v_fmac_f32 v57, v54, v11
    v_mov_b32 v61, s55
    v_mov_b32 v63, s55
    v_mov_b32 v58, v56
    v_mov_b32 v59, v57
    s_nop 0
    v_permlane32_swap_b32 v56, v58
    v_permlane32_swap_b32 v57, v59
    v_add_f32 v56, v56, v58
    v_add_f32 v57, v57, v59
    v_mov_b32 v58, v56
    v_mov_b32 v59, v57
    s_nop 0
    v_permlane16_swap_b32 v56, v58
    v_permlane16_swap_b32 v57, v59
    v_add_f32 v60, v56, v58
    v_add_f32 v62, v57, v59
    s_mov_b64 exec, 0xffff
    buffer_store_dwordx4 v[60:63], v3, s[8:11], s60 offen sc1
    s_mov_b64 exec, -1
    s_cmp_lt_u32 s54, 2
    s_cselect_b32 s72, s26, s28
    s_cselect_b32 s73, s27, s29
    s_and_b32 s60, s54, 1
    s_mul_i32 s60, s60, 576
    s_mul_i32 s39, s49, 82944
    s_add_u32 s39, s39, s60
    s_mul_i32 s36, s54, 4608
    s_add_u32 s36, s36, 114688
    s_lshl_b32 s37, s54, 11
    s_add_u32 s37, s37, 106496
    s_lshl_b32 s38, s54, 13
    s_add_u32 s38, s38, 40960
    v_lshrrev_b32 v31, 2, v0
    v_mul_u32_u24 v31, 1152, v31
    v_sub_u32 v109, 0, v2
    v_xor_b32 v109, v109, v0
    v_and_b32 v109, 3, v109
    v_lshl_add_u32 v31, v109, 4, v31
    s_mov_b32 s77, 3200000
cw_12:
    ds_read_b32 v109, v5 offset:108
    s_waitcnt lgkmcnt(0)
    v_cmp_gt_u32 vcc, 1, v109
    s_cbranch_vccz cwo_13
    s_sub_u32 s77, s77, 1
    s_cmp_lg_u32 s77, 0
    s_cbranch_scc1 cw_12
cwo_13:
    s_and_b32 s41, s52, 3
    s_xor_b32 s41, s41, 0
    s_mul_i32 s41, s41, 18432
    s_add_u32 s41, s41, s39
    s_add_u32 m0, s36, 0x0
    s_nop 0
    buffer_load_dwordx4 v31, s[72:75], s41 offen offset:0 lds
    s_add_u32 m0, s36, 0x3c0
    s_nop 0
    buffer_load_dwordx4 v31, s[72:75], s41 offen offset:64 lds
    s_add_u32 m0, s36, 0x780
    s_nop 0
    buffer_load_dwordx4 v31, s[72:75], s41 offen offset:128 lds
    s_add_u32 m0, s36, 0xb40
    s_nop 0
    buffer_load_dwordx4 v31, s[72:75], s41 offen offset:192 lds
    s_add_u32 m0, s37, 0xffffff00
    s_nop 0
    buffer_load_dwordx4 v31, s[72:75], s41 offen offset:256 lds
    s_add_u32 m0, s37, 0x2c0
    s_nop 0
    buffer_load_dwordx4 v31, s[72:75], s41 offen offset:320 lds
    s_add_u32 m0, s38, 0xfffffe80
    s_nop 0
    buffer_load_dwordx4 v31, s[72:75], s41 offen offset:384 lds
    s_add_u32 m0, s38, 0x240
    s_nop 0
    buffer_load_dwordx4 v31, s[72:75], s41 offen offset:448 lds
    s_add_u32 m0, s38, 0x600
    s_nop 0
    buffer_load_dwordx4 v31, s[72:75], s41 offen offset:512 lds
    s_and_b32 s41, s52, 3
    s_xor_b32 s41, s41, 1
    s_mul_i32 s41, s41, 18432
    s_add_u32 s41, s41, s39
    s_add_u32 m0, s38, 0xc00
    s_nop 0
    buffer_load_dwordx4 v31, s[72:75], s41 offen offset:0 lds
    s_lshl_b32 s60, s54, 9
    s_add_u32 s60, s60, 156800
    v_and_b32 v64, 15, v0
    v_lshlrev_b32 v64, 5, v64
    v_add_u32 v64, s60, v64
    v_lshl_add_u32 v65, v2, 3, v64
    ds_write_b64 v65, v[54:55]
    ds_read_b128 v[68:71], v64 offset:0
    ds_read_b128 v[72:75], v64 offset:16
    v_mul_f32 v66, v22, v13
    v_mul_f32 v22, v22, v12
    v_fma_f32 v22, -v23, v13, v22
    v_fma_f32 v23, v23, v12, v66
    v_mul_f32 v66, v24, v13
    v_mul_f32 v24, v24, v12
    v_fma_f32 v24, -v25, v13, v24
    v_fma_f32 v25, v25, v12, v66
    v_mul_f32 v66, v26, v13
    v_mul_f32 v26, v26, v12
    v_fma_f32 v26, -v27, v13, v26
    v_fma_f32 v27, v27, v12, v66
    v_mul_f32 v66, v28, v13
    v_mul_f32 v28, v28, v12
    v_fma_f32 v28, -v29, v13, v28
    v_fma_f32 v29, v29, v12, v66
    v_mul_f32 v66, v32, v13
    v_mul_f32 v32, v32, v12
    v_fma_f32 v32, -v33, v13, v32
    v_fma_f32 v33, v33, v12, v66
    v_mul_f32 v66, v34, v13
    v_mul_f32 v34, v34, v12
    v_fma_f32 v34, -v35, v13, v34
    v_fma_f32 v35, v35, v12, v66
    v_mul_f32 v66, v36, v13
    v_mul_f32 v36, v36, v12
    v_fma_f32 v36, -v37, v13, v36
    v_fma_f32 v37, v37, v12, v66
    v_mul_f32 v66, v38, v13
    v_mul_f32 v38, v38, v12
    v_fma_f32 v38, -v39, v13, v38
    v_fma_f32 v39, v39, v12, v66
    v_mul_f32 v66, v40, v13
    v_mul_f32 v40, v40, v12
    v_fma_f32 v40, -v41, v13, v40
    v_fma_f32 v41, v41, v12, v66
    v_mul_f32 v66, v42, v13
    v_mul_f32 v42, v42, v12
    v_fma_f32 v42, -v43, v13, v42
    v_fma_f32 v43, v43, v12, v66
    v_mul_f32 v66, v44, v13
    v_mul_f32 v44, v44, v12
    v_fma_f32 v44, -v45, v13, v44
    v_fma_f32 v45, v45, v12, v66
    v_mul_f32 v66, v46, v13
    v_mul_f32 v46, v46, v12
    v_fma_f32 v46, -v47, v13, v46
    v_fma_f32 v47, v47, v12, v66
    v_mul_f32 v66, v48, v13
    v_mul_f32 v48, v48, v12
    v_fma_f32 v48, -v49, v13, v48
    v_fma_f32 v49, v49, v12, v66
    v_mul_f32 v66, v50, v13
    v_mul_f32 v50, v50, v12
    v_fma_f32 v50, -v51, v13, v50
    v_fma_f32 v51, v51, v12, v66
    v_mul_f32 v66, v52, v13
    v_mul_f32 v52, v52, v12
    v_fma_f32 v52, -v53, v13, v52
    v_fma_f32 v53, v53, v12, v66
    s_waitcnt lgkmcnt(0)
    v_mul_f32 v66, v54, v13
    v_mul_f32 v54, v54, v12
    v_fma_f32 v54, -v55, v13, v54
    v_fma_f32 v55, v55, v12, v66
    v_mov_b32 v110, 0
    v_mov_b32 v111, 0
    s_mov_b32 exec_lo, 0xffff0000
    s_mov_b32 exec_hi, 0xffffffff
    v_mov_b32 v110, v68
    v_mov_b32 v111, v69
    s_mov_b64 exec, -1
    v_fmac_f32 v70, v110, v14
    v_fmac_f32 v71, v111, v14
    v_fma_f32 v70, -v111, v15, v70
    v_fmac_f32 v71, v110, v15
    s_mov_b32 exec_lo, 0x0
    s_mov_b32 exec_hi, 0xffffffff
    v_mov_b32 v110, v70
    v_mov_b32 v111, v71
    s_mov_b64 exec, -1
    v_fmac_f32 v72, v110, v14
    v_fmac_f32 v73, v111, v14
    v_fma_f32 v72, -v111, v15, v72
    v_fmac_f32 v73, v110, v15
    s_mov_b32 exec_lo, 0x0
    s_mov_b32 exec_hi, 0xffff0000
    v_mov_b32 v110, v72
    v_mov_b32 v111, v73
    s_mov_b64 exec, -1
    s_add_u32 m0, s38, 0xfc0
    s_nop 0
    buffer_load_dwordx4 v31, s[72:75], s41 offen offset:64 lds
    s_add_u32 m0, s38, 0x1380
    s_nop 0
    buffer_load_dwordx4 v31, s[72:75], s41 offen offset:128 lds
    s_add_u32 m0, s38, 0x1740
    s_nop 0
    buffer_load_dwordx4 v31, s[72:75], s41 offen offset:192 lds
    s_add_u32 m0, s38, 0x1b00
    s_nop 0
    buffer_load_dwordx4 v31, s[72:75], s41 offen offset:256 lds
    s_add_u32 m0, s65, 0xfffffec0
    s_nop 0
    buffer_load_dwordx4 v31, s[72:75], s41 offen offset:320 lds
    s_add_u32 m0, s65, 0x280
    s_nop 0
    buffer_load_dwordx4 v31, s[72:75], s41 offen offset:384 lds
    s_add_u32 m0, s65, 0x640
    s_nop 0
    buffer_load_dwordx4 v31, s[72:75], s41 offen offset:448 lds
    s_add_u32 m0, s65, 0xa00
    s_nop 0
    buffer_load_dwordx4 v31, s[72:75], s41 offen offset:512 lds
    s_and_b32 s41, s52, 3
    s_xor_b32 s41, s41, 2
    s_mul_i32 s41, s41, 18432
    s_add_u32 s41, s41, s39
    s_add_u32 m0, s65, 0x1000
    s_nop 0
    buffer_load_dwordx4 v31, s[72:75], s41 offen offset:0 lds
    s_add_u32 m0, s65, 0x13c0
    s_nop 0
    buffer_load_dwordx4 v31, s[72:75], s41 offen offset:64 lds
    s_add_u32 m0, s65, 0x1780
    s_nop 0
    buffer_load_dwordx4 v31, s[72:75], s41 offen offset:128 lds
    s_add_u32 m0, s65, 0x1b40
    s_nop 0
    buffer_load_dwordx4 v31, s[72:75], s41 offen offset:192 lds
    s_lshl_b32 s60, s54, 8
    s_sub_u32 s61, 32, s52
    v_mul_u32_u24 v106, 8, v2
    v_sub_u32 v108, s52, v106
    v_add_u32 v106, s61, v106
    v_mul_u32_u24 v106, 1152, v106
    v_lshl_add_u32 v106, v1, 4, v106
    v_add_u32 v106, s60, v106
    v_med3_i32 v108, v108, 0, 8
    v_lshlrev_b32 v108, 1, v108
    v_mul_lo_u32 v108, v108, s55
    v_add_u32 v107, 4608, v106
    buffer_load_dwordx4 v[56:59], v106, s[8:11], 0 offen offset:0 sc1
    buffer_load_dwordx4 v[60:63], v106, s[8:11], 0 offen offset:1152 sc1
    buffer_load_dwordx4 v[64:67], v106, s[8:11], 0 offen offset:2304 sc1
    buffer_load_dwordx4 v[68:71], v106, s[8:11], 0 offen offset:3456 sc1
    buffer_load_dwordx4 v[72:75], v107, s[8:11], 0 offen offset:0 sc1
    buffer_load_dwordx4 v[76:79], v107, s[8:11], 0 offen offset:1152 sc1
    buffer_load_dwordx4 v[80:83], v107, s[8:11], 0 offen offset:2304 sc1
    buffer_load_dwordx4 v[84:87], v107, s[8:11], 0 offen offset:3456 sc1
    v_mul_f32 v88, v12, v6
    v_mul_f32 v89, v13, v6
    v_fma_f32 v88, -v13, v7, v88
    v_fmac_f32 v89, v12, v7
    v_mul_f32 v90, v88, v6
    v_mul_f32 v91, v89, v6
    v_fma_f32 v90, -v89, v7, v90
    v_fmac_f32 v91, v88, v7
    v_mul_f32 v92, v90, v6
    v_mul_f32 v93, v91, v6
    v_fma_f32 v92, -v91, v7, v92
    v_fmac_f32 v93, v90, v7
    v_mul_f32 v94, v92, v6
    v_mul_f32 v95, v93, v6
    v_fma_f32 v94, -v93, v7, v94
    v_fmac_f32 v95, v92, v7
    v_mul_f32 v96, v94, v6
    v_mul_f32 v97, v95, v6
    v_fma_f32 v96, -v95, v7, v96
    v_fmac_f32 v97, v94, v7
    v_mul_f32 v98, v96, v6
    v_mul_f32 v99, v97, v6
    v_fma_f32 v98, -v97, v7, v98
    v_fmac_f32 v99, v96, v7
    v_mul_f32 v100, v98, v6
    v_mul_f32 v101, v99, v6
    v_fma_f32 v100, -v99, v7, v100
    v_fmac_f32 v101, v98, v7
    v_mul_f32 v102, v100, v6
    v_mul_f32 v103, v101, v6
    v_fma_f32 v102, -v101, v7, v102
    v_fmac_f32 v103, v100, v7
    v_mul_f32 v104, v6, v6
    v_mul_f32 v105, v7, v6
    v_fma_f32 v104, -v7, v7, v104
    v_fmac_f32 v105, v6, v7
    s_lshl_b32 s60, s54, 1
    s_add_u32 s60, s60, s64
    v_lshrrev_b32 v30, 3, v1
    v_add_u32 v30, s60, v30
    v_and_b32 v109, 1, v30
    v_lshlrev_b32 v109, 2, v109
    v_lshlrev_b32 v30, 8, v30
    v_xor_b32 v109, v109, v1
    v_and_b32 v109, 7, v109
    v_lshl_add_u32 v30, v109, 4, v30
    v_mul_u32_u24 v109, 9216, v2
    v_add_u32 v30, v30, v109
    v_mul_f32 v109, v104, v105
    v_mul_f32 v104, v104, v104
    v_fma_f32 v104, -v105, v105, v104
    v_add_f32 v105, v109, v109
    v_mul_f32 v109, v104, v105
    v_mul_f32 v104, v104, v104
    v_fma_f32 v104, -v105, v105, v104
    v_add_f32 v105, v109, v109
    ds_read_b32 v109, v5 offset:128
    s_waitcnt lgkmcnt(0)
    v_readfirstlane_b32 s30, v109
    s_waitcnt vmcnt(8)
    v_mov_b32 v109, 1
    s_mov_b64 exec, 1
    ds_add_u32 v5, v109 offset:64
    s_mov_b64 exec, -1
    s_mov_b32 s77, 400000
    s_branch pchk_lbm_16
poll_lbm_14:
    buffer_load_dwordx4 v[56:59], v106, s[8:11], 0 offen offset:0 sc1
    buffer_load_dwordx4 v[60:63], v106, s[8:11], 0 offen offset:1152 sc1
    buffer_load_dwordx4 v[64:67], v106, s[8:11], 0 offen offset:2304 sc1
    buffer_load_dwordx4 v[68:71], v106, s[8:11], 0 offen offset:3456 sc1
    buffer_load_dwordx4 v[72:75], v107, s[8:11], 0 offen offset:0 sc1
    buffer_load_dwordx4 v[76:79], v107, s[8:11], 0 offen offset:1152 sc1
    buffer_load_dwordx4 v[80:83], v107, s[8:11], 0 offen offset:2304 sc1
    buffer_load_dwordx4 v[84:87], v107, s[8:11], 0 offen offset:3456 sc1
pchk_lbm_16:
    s_waitcnt vmcnt(0)
    v_add_u32 v109, v57, v59
    v_add3_u32 v109, v61, v63, v109
    v_add3_u32 v109, v65, v67, v109
    v_add3_u32 v109, v69, v71, v109
    v_add3_u32 v109, v73, v75, v109
    v_add3_u32 v109, v77, v79, v109
    v_add3_u32 v109, v81, v83, v109
    v_add3_u32 v109, v85, v87, v109
    v_cmp_ne_u32 vcc, v109, v108
    s_cbranch_vccz pout_lbm_15
    s_mov_b64 exec, vcc
    s_sleep 3
    s_sub_u32 s77, s77, 1
    s_cmp_lg_u32 s77, 0
    s_cbranch_scc1 poll_lbm_14
pout_lbm_15:
    s_mov_b64 exec, -1
    v_fmac_f32 v80, v84, v18
    v_fmac_f32 v82, v86, v18
    v_fma_f32 v80, -v86, v19, v80
    v_fmac_f32 v82, v84, v19
    v_fmac_f32 v76, v80, v18
    v_fmac_f32 v78, v82, v18
    v_fma_f32 v76, -v82, v19, v76
    v_fmac_f32 v78, v80, v19
    v_fmac_f32 v72, v76, v18
    v_fmac_f32 v74, v78, v18
    v_fma_f32 v72, -v78, v19, v72
    v_fmac_f32 v74, v76, v19
    v_fmac_f32 v68, v72, v18
    v_fmac_f32 v70, v74, v18
    v_fma_f32 v68, -v74, v19, v68
    v_fmac_f32 v70, v72, v19
    v_fmac_f32 v64, v68, v18
    v_fmac_f32 v66, v70, v18
    v_fma_f32 v64, -v70, v19, v64
    v_fmac_f32 v66, v68, v19
    v_fmac_f32 v60, v64, v18
    v_fmac_f32 v62, v66, v18
    v_fma_f32 v60, -v66, v19, v60
    v_fmac_f32 v62, v64, v19
    v_fmac_f32 v56, v60, v18
    v_fmac_f32 v58, v62, v18
    v_fma_f32 v56, -v62, v19, v56
    v_fmac_f32 v58, v60, v19
    v_mul_f32 v60, v56, v20
    v_mul_f32 v61, v58, v20
    v_fma_f32 v60, -v58, v21, v60
    v_fmac_f32 v61, v56, v21
    v_mov_b32 v62, v60
    v_mov_b32 v63, v61
    s_nop 0
    v_permlane32_swap_b32 v60, v62
    v_permlane32_swap_b32 v61, v63
    v_add_f32 v60, v60, v62
    v_add_f32 v61, v61, v63
    v_mov_b32 v62, v60
    v_mov_b32 v63, v61
    s_nop 0
    v_permlane16_swap_b32 v60, v62
    v_permlane16_swap_b32 v61, v63
    v_add_f32 v60, v60, v62
    v_add_f32 v61, v61, v63
    v_fmac_f32 v110, v60, v16
    v_fmac_f32 v111, v61, v16
    v_fma_f32 v110, -v61, v17, v110
    v_fmac_f32 v111, v60, v17
    v_mul_f32 v72, v110, v104
    v_mul_f32 v73, v111, v104
    v_fma_f32 v72, -v111, v105, v72
    v_fmac_f32 v73, v110, v105
    v_fmac_f32 v22, v88, v110
    v_fmac_f32 v23, v89, v110
    v_fma_f32 v22, -v89, v111, v22
    v_fmac_f32 v23, v88, v111
    v_fmac_f32 v24, v90, v110
    v_fmac_f32 v25, v91, v110
    v_fma_f32 v24, -v91, v111, v24
    v_fmac_f32 v25, v90, v111
    v_fmac_f32 v26, v92, v110
    v_fmac_f32 v27, v93, v110
    v_fma_f32 v26, -v93, v111, v26
    v_fmac_f32 v27, v92, v111
    v_fmac_f32 v28, v94, v110
    v_fmac_f32 v29, v95, v110
    v_fma_f32 v28, -v95, v111, v28
    v_fmac_f32 v29, v94, v111
    v_fmac_f32 v32, v96, v110
    v_fmac_f32 v33, v97, v110
    v_fma_f32 v32, -v97, v111, v32
    v_fmac_f32 v33, v96, v111
    v_fmac_f32 v34, v98, v110
    v_fmac_f32 v35, v99, v110
    v_fma_f32 v34, -v99, v111, v34
    v_fmac_f32 v35, v98, v111
    v_fmac_f32 v36, v100, v110
    v_fmac_f32 v37, v101, v110
    v_fma_f32 v36, -v101, v111, v36
    v_fmac_f32 v37, v100, v111
    v_fmac_f32 v38, v102, v110
    v_fmac_f32 v39, v103, v110
    v_fma_f32 v38, -v103, v111, v38
    v_fmac_f32 v39, v102, v111
    v_cvt_pk_bf16_f32 v56, v22, v24
    v_cvt_pk_bf16_f32 v57, v26, v28
    v_cvt_pk_bf16_f32 v58, v32, v34
    v_cvt_pk_bf16_f32 v59, v36, v38
    v_cvt_pk_bf16_f32 v60, -v23, -v25
    v_cvt_pk_bf16_f32 v61, -v27, -v29
    v_cvt_pk_bf16_f32 v62, -v33, -v35
    v_cvt_pk_bf16_f32 v63, -v37, -v39
    buffer_store_dwordx4 v[56:59], v30, s[4:7], s62 offen offset:0 sc1
    buffer_store_dwordx4 v[60:63], v30, s[4:7], s63 offen offset:0 sc1
    v_fmac_f32 v40, v88, v72
    v_fmac_f32 v41, v89, v72
    v_fma_f32 v40, -v89, v73, v40
    v_fmac_f32 v41, v88, v73
    v_fmac_f32 v42, v90, v72
    v_fmac_f32 v43, v91, v72
    v_fma_f32 v42, -v91, v73, v42
    v_fmac_f32 v43, v90, v73
    v_fmac_f32 v44, v92, v72
    v_fmac_f32 v45, v93, v72
    v_fma_f32 v44, -v93, v73, v44
    v_fmac_f32 v45, v92, v73
    v_fmac_f32 v46, v94, v72
    v_fmac_f32 v47, v95, v72
    v_fma_f32 v46, -v95, v73, v46
    v_fmac_f32 v47, v94, v73
    v_fmac_f32 v48, v96, v72
    v_fmac_f32 v49, v97, v72
    v_fma_f32 v48, -v97, v73, v48
    v_fmac_f32 v49, v96, v73
    v_fmac_f32 v50, v98, v72
    v_fmac_f32 v51, v99, v72
    v_fma_f32 v50, -v99, v73, v50
    v_fmac_f32 v51, v98, v73
    v_fmac_f32 v52, v100, v72
    v_fmac_f32 v53, v101, v72
    v_fma_f32 v52, -v101, v73, v52
    v_fmac_f32 v53, v100, v73
    v_fmac_f32 v54, v102, v72
    v_fmac_f32 v55, v103, v72
    v_fma_f32 v54, -v103, v73, v54
    v_fmac_f32 v55, v102, v73
    v_cvt_pk_bf16_f32 v64, v40, v42
    v_cvt_pk_bf16_f32 v65, v44, v46
    v_cvt_pk_bf16_f32 v66, v48, v50
    v_cvt_pk_bf16_f32 v67, v52, v54
    v_cvt_pk_bf16_f32 v68, -v41, -v43
    v_cvt_pk_bf16_f32 v69, -v45, -v47
    v_cvt_pk_bf16_f32 v70, -v49, -v51
    v_cvt_pk_bf16_f32 v71, -v53, -v55
    buffer_store_dwordx4 v[64:67], v30, s[4:7], s62 offen offset:128 sc1
    buffer_store_dwordx4 v[68:71], v30, s[4:7], s63 offen offset:128 sc1
    ds_read_b32 v100, v5 offset:100
    s_waitcnt lgkmcnt(0)
    v_cmp_gt_u32 vcc, 4, v100
    s_cbranch_vccnz c2s_17
    s_and_b32 s41, s52, 3
    s_xor_b32 s41, s41, 2
    s_mul_i32 s41, s41, 18432
    s_add_u32 s41, s41, s39
    s_add_u32 m0, s38, 0xffffff00
    s_nop 0
    buffer_load_dwordx4 v31, s[72:75], s41 offen offset:256 lds
    s_add_u32 m0, s38, 0x2c0
    s_nop 0
    buffer_load_dwordx4 v31, s[72:75], s41 offen offset:320 lds
    s_add_u32 m0, s38, 0x680
    s_nop 0
    buffer_load_dwordx4 v31, s[72:75], s41 offen offset:384 lds
    s_add_u32 m0, s38, 0xa40
    s_nop 0
    buffer_load_dwordx4 v31, s[72:75], s41 offen offset:448 lds
    s_add_u32 m0, s38, 0xe00
    s_nop 0
    buffer_load_dwordx4 v31, s[72:75], s41 offen offset:512 lds
    s_and_b32 s41, s52, 3
    s_xor_b32 s41, s41, 3
    s_mul_i32 s41, s41, 18432
    s_add_u32 s41, s41, s39
    s_add_u32 m0, s38, 0x1400
    s_nop 0
    buffer_load_dwordx4 v31, s[72:75], s41 offen offset:0 lds
    s_add_u32 m0, s65, 0xffffffc0
    s_nop 0
    buffer_load_dwordx4 v31, s[72:75], s41 offen offset:64 lds
    s_add_u32 m0, s65, 0x380
    s_nop 0
    buffer_load_dwordx4 v31, s[72:75], s41 offen offset:128 lds
    s_waitcnt vmcnt(8)
    v_mov_b32 v100, 1
    s_mov_b64 exec, 1
    ds_add_rtn_u32 v100, v5, v100 offset:40
    v_mov_b32 v102, s55
    v_mov_b32 v103, 0
    s_waitcnt lgkmcnt(0)
    v_cmp_eq_u32 vcc, 4, v100
    s_cbranch_vccz nf_19
    s_cmp_eq_u32 s30, 0
    s_cbranch_scc1 ssl_20
    buffer_store_dword v102, v103, s[4:7], s1 offen
    s_branch ssj_21
ssl_20:
    buffer_store_dword v102, v103, s[4:7], s1 offen sc1
ssj_21:
nf_19:
    s_mov_b64 exec, -1
    s_branch c2j_18
c2s_17:
    s_waitcnt vmcnt(0)
    v_mov_b32 v100, 1
    s_mov_b64 exec, 1
    ds_add_rtn_u32 v100, v5, v100 offset:40
    v_mov_b32 v102, s55
    v_mov_b32 v103, 0
    s_waitcnt lgkmcnt(0)
    v_cmp_eq_u32 vcc, 4, v100
    s_cbranch_vccz nf_22
    s_cmp_eq_u32 s30, 0
    s_cbranch_scc1 ssl_23
    buffer_store_dword v102, v103, s[4:7], s1 offen
    s_branch ssj_24
ssl_23:
    buffer_store_dword v102, v103, s[4:7], s1 offen sc1
ssj_24:
nf_22:
    s_mov_b64 exec, -1
    s_mov_b32 s77, 3200000
cw_25:
    ds_read_b32 v100, v5 offset:100
    s_waitcnt lgkmcnt(0)
    v_cmp_gt_u32 vcc, 4, v100
    s_cbranch_vccz cwo_26
    s_sleep 1
    s_sub_u32 s77, s77, 1
    s_cmp_lg_u32 s77, 0
    s_cbranch_scc1 cw_25
cwo_26:
    s_and_b32 s41, s52, 3
    s_xor_b32 s41, s41, 2
    s_mul_i32 s41, s41, 18432
    s_add_u32 s41, s41, s39
    s_add_u32 m0, s38, 0xffffff00
    s_nop 0
    buffer_load_dwordx4 v31, s[72:75], s41 offen offset:256 lds
    s_add_u32 m0, s38, 0x2c0
    s_nop 0
    buffer_load_dwordx4 v31, s[72:75], s41 offen offset:320 lds
    s_add_u32 m0, s38, 0x680
    s_nop 0
    buffer_load_dwordx4 v31, s[72:75], s41 offen offset:384 lds
    s_add_u32 m0, s38, 0xa40
    s_nop 0
    buffer_load_dwordx4 v31, s[72:75], s41 offen offset:448 lds
    s_add_u32 m0, s38, 0xe00
    s_nop 0
    buffer_load_dwordx4 v31, s[72:75], s41 offen offset:512 lds
    s_and_b32 s41, s52, 3
    s_xor_b32 s41, s41, 3
    s_mul_i32 s41, s41, 18432
    s_add_u32 s41, s41, s39
    s_add_u32 m0, s38, 0x1400
    s_nop 0
    buffer_load_dwordx4 v31, s[72:75], s41 offen offset:0 lds
    s_add_u32 m0, s65, 0xffffffc0
    s_nop 0
    buffer_load_dwordx4 v31, s[72:75], s41 offen offset:64 lds
    s_add_u32 m0, s65, 0x380
    s_nop 0
    buffer_load_dwordx4 v31, s[72:75], s41 offen offset:128 lds
c2j_18:
    s_add_u32 m0, s65, 0x740
    s_nop 0
    buffer_load_dwordx4 v31, s[72:75], s41 offen offset:192 lds
    s_add_u32 m0, s65, 0xb00
    s_nop 0
    buffer_load_dwordx4 v31, s[72:75], s41 offen offset:256 lds
    s_add_u32 m0, s65, 0xec0
    s_nop 0
    buffer_load_dwordx4 v31, s[72:75], s41 offen offset:320 lds
    s_add_u32 m0, s65, 0x1280
    s_nop 0
    buffer_load_dwordx4 v31, s[72:75], s41 offen offset:384 lds
    s_add_u32 m0, s65, 0x1640
    s_nop 0
    buffer_load_dwordx4 v31, s[72:75], s41 offen offset:448 lds
    s_add_u32 m0, s65, 0x1a00
    s_nop 0
    buffer_load_dwordx4 v31, s[72:75], s41 offen offset:512 lds
    s_add_u32 s61, s39, 73728
    s_mov_b32 exec_hi, 0
    s_add_u32 m0, s36, 0
    s_nop 0
    buffer_load_dwordx4 v31, s[72:75], s61 offen offset:0 lds
    s_add_u32 m0, s36, 448
    s_nop 0
    buffer_load_dwordx4 v31, s[72:75], s61 offen offset:64 lds
    s_add_u32 m0, s36, 896
    s_nop 0
    buffer_load_dwordx4 v31, s[72:75], s61 offen offset:128 lds
    s_add_u32 m0, s36, 1344
    s_nop 0
    buffer_load_dwordx4 v31, s[72:75], s61 offen offset:192 lds
    s_add_u32 m0, s36, 1792
    s_nop 0
    buffer_load_dwordx4 v31, s[72:75], s61 offen offset:256 lds
    s_add_u32 m0, s36, 2240
    s_nop 0
    buffer_load_dwordx4 v31, s[72:75], s61 offen offset:320 lds
    s_add_u32 m0, s36, 2688
    s_nop 0
    buffer_load_dwordx4 v31, s[72:75], s61 offen offset:384 lds
    s_add_u32 m0, s36, 3136
    s_nop 0
    buffer_load_dwordx4 v31, s[72:75], s61 offen offset:448 lds
    s_add_u32 m0, s36, 3584
    s_nop 0
    buffer_load_dwordx4 v31, s[72:75], s61 offen offset:512 lds
    s_mov_b32 exec_hi, -1
    s_waitcnt vmcnt(0)
    v_mov_b32 v100, 1
    s_mov_b64 exec, 1
    ds_add_u32 v5, v100 offset:104
    s_mov_b64 exec, -1
    s_branch L_mpost
L_mg1b:
    v_lshrrev_b32 v100, 2, v1
    v_and_b32 v101, 3, v1
    v_lshlrev_b32 v101, 4, v101
    v_lshl_add_u32 v101, v100, 8, v101
    v_lshl_add_u32 v101, v2, 10, v101
    v_xor_b32 v102, 0, v100
    v_lshl_add_u32 v22, v102, 6, v101
    v_xor_b32 v102, 1, v100
    v_lshl_add_u32 v23, v102, 6, v101
    v_xor_b32 v102, 2, v100
    v_lshl_add_u32 v24, v102, 6, v101
    v_xor_b32 v102, 3, v100
    v_lshl_add_u32 v25, v102, 6, v101
    v_xor_b32 v102, s54, v100
    v_lshl_add_u32 v26, v102, 6, v101
    s_lshl_b32 s60, s56, 3
    s_add_u32 s60, s60, s2
    s_mul_i32 s60, s60, 36864
    s_add_u32 s60, s60, 19922944
    s_add_u32 s8, s50, s60
    s_addc_u32 s9, s51, 0
    s_mov_b32 s10, 36864
    s_mov_b32 s11, 0x20000
    s_sub_u32 s60, 31, s52
    s_mul_i32 s34, s60, 1152
    s_lshl_b32 s60, s56, 5
    s_add_u32 s60, s60, s52
    s_mul_i32 s57, s60, 147456
    s_lshl_b32 s60, s60, 7
    s_add_u32 s35, s60, 22020096
    s_lshl_b32 s1, s2, 2
    s_add_u32 s1, s1, s35
    s_lshr_b32 s60, s2, 2
    s_mul_i32 s62, s60, 36864
    s_add_u32 s62, s62, s57
    s_add_u32 s63, s62, 73728
    s_and_b32 s64, s2, 3
    s_mul_i32 s64, s64, 9
    v_and_b32 v31, 7, v1
    v_mul_u32_u24 v31, 528, v31
    v_lshl_add_u32 v31, v2, 7, v31
    v_lshrrev_b32 v100, 3, v1
    v_lshl_add_u32 v31, v100, 2, v31
    s_lshl_b32 s60, s54, 5
    s_add_u32 s60, s60, 152576
    v_add_u32 v31, s60, v31
    s_mul_i32 s67, s52, 73728
    s_add_u32 s67, s67, s66
    s_add_u32 s67, s67, 10485760
    s_lshl_b32 s76, s52, 7
    s_add_u32 s76, s76, 22036480
    s_cmp_lg_u32 s54, 0
    s_cbranch_scc1 fw_27
    v_and_b32 v100, 7, v0
    v_lshlrev_b32 v100, 2, v100
    s_mov_b32 s77, 400000
poll_zf_28:
    buffer_load_dword v101, v100, s[4:7], s76 offen sc1
pchk_zf_30:
    s_waitcnt vmcnt(0)
    v_cmp_ne_u32 vcc, s55, v101
    s_cbranch_vccz pout_zf_29
    s_sub_u32 s77, s77, 1
    s_cmp_lg_u32 s77, 0
    s_cbranch_scc1 poll_zf_28
pout_zf_29:
fw_27:
    s_barrier
    s_add_u32 s61, s3, 0
    s_sub_u32 s60, s61, 1152
    s_min_u32 s61, s61, s60
    s_lshl_b32 s61, s61, 6
    s_add_u32 m0, s66, 0
    s_add_u32 s61, s61, s67
    buffer_load_dwordx4 v3, s[4:7], s61 offen sc1 lds
    s_add_u32 s61, s3, 64
    s_sub_u32 s60, s61, 1152
    s_min_u32 s61, s61, s60
    s_lshl_b32 s61, s61, 6
    s_add_u32 m0, s66, 4096
    s_add_u32 s61, s61, s67
    buffer_load_dwordx4 v3, s[4:7], s61 offen sc1 lds
    s_add_u32 s61, s3, 128
    s_sub_u32 s60, s61, 1152
    s_min_u32 s61, s61, s60
    s_lshl_b32 s61, s61, 6
    s_add_u32 m0, s66, 8192
    s_add_u32 s61, s61, s67
    buffer_load_dwordx4 v3, s[4:7], s61 offen sc1 lds
    s_add_u32 s61, s3, 192
    s_sub_u32 s60, s61, 1152
    s_min_u32 s61, s61, s60
    s_lshl_b32 s61, s61, 6
    s_add_u32 m0, s66, 12288
    s_add_u32 s61, s61, s67
    buffer_load_dwordx4 v3, s[4:7], s61 offen sc1 lds
    s_add_u32 s61, s3, 256
    s_sub_u32 s60, s61, 1152
    s_min_u32 s61, s61, s60
    s_lshl_b32 s61, s61, 6
    s_add_u32 m0, s66, 16384
    s_add_u32 s61, s61, s67
    buffer_load_dwordx4 v3, s[4:7], s61 offen sc1 lds
    s_add_u32 s61, s3, 320
    s_sub_u32 s60, s61, 1152
    s_min_u32 s61, s61, s60
    s_lshl_b32 s61, s61, 6
    s_add_u32 m0, s66, 20480
    s_add_u32 s61, s61, s67
    buffer_load_dwordx4 v3, s[4:7], s61 offen sc1 lds
    s_add_u32 s61, s3, 384
    s_sub_u32 s60, s61, 1152
    s_min_u32 s61, s61, s60
    s_lshl_b32 s61, s61, 6
    s_add_u32 m0, s66, 24576
    s_add_u32 s61, s61, s67
    buffer_load_dwordx4 v3, s[4:7], s61 offen sc1 lds
    s_add_u32 s61, s3, 448
    s_sub_u32 s60, s61, 1152
    s_min_u32 s61, s61, s60
    s_lshl_b32 s61, s61, 6
    s_add_u32 m0, s66, 28672
    s_add_u32 s61, s61, s67
    buffer_load_dwordx4 v3, s[4:7], s61 offen sc1 lds
    s_add_u32 s61, s3, 512
    s_sub_u32 s60, s61, 1152
    s_min_u32 s61, s61, s60
    s_lshl_b32 s61, s61, 6
    s_add_u32 m0, s66, 32768
    s_add_u32 s61, s61, s67
    buffer_load_dwordx4 v3, s[4:7], s61 offen sc1 lds
    s_add_u32 s61, s3, 576
    s_sub_u32 s60, s61, 1152
    s_min_u32 s61, s61, s60
    s_lshl_b32 s61, s61, 6
    s_add_u32 m0, s66, 36864
    s_add_u32 s61, s61, s67
    buffer_load_dwordx4 v3, s[4:7], s61 offen sc1 lds
    s_add_u32 s61, s3, 640
    s_sub_u32 s60, s61, 1152
    s_min_u32 s61, s61, s60
    s_lshl_b32 s61, s61, 6
    s_add_u32 m0, s66, 40960
    s_add_u32 s61, s61, s67
    buffer_load_dwordx4 v3, s[4:7], s61 offen sc1 lds
    s_add_u32 s61, s3, 704
    s_sub_u32 s60, s61, 1152
    s_min_u32 s61, s61, s60
    s_lshl_b32 s61, s61, 6
    s_add_u32 m0, s66, 45056
    s_add_u32 s61, s61, s67
    buffer_load_dwordx4 v3, s[4:7], s61 offen sc1 lds
    s_add_u32 s61, s3, 768
    s_sub_u32 s60, s61, 1152
    s_min_u32 s61, s61, s60
    s_lshl_b32 s61, s61, 6
    s_add_u32 m0, s66, 49152
    s_add_u32 s61, s61, s67
    buffer_load_dwordx4 v3, s[4:7], s61 offen sc1 lds
    s_add_u32 s61, s3, 832
    s_sub_u32 s60, s61, 1152
    s_min_u32 s61, s61, s60
    s_lshl_b32 s61, s61, 6
    s_add_u32 m0, s66, 53248
    s_add_u32 s61, s61, s67
    buffer_load_dwordx4 v3, s[4:7], s61 offen sc1 lds
    s_add_u32 s61, s3, 896
    s_sub_u32 s60, s61, 1152
    s_min_u32 s61, s61, s60
    s_lshl_b32 s61, s61, 6
    s_add_u32 m0, s66, 57344
    s_add_u32 s61, s61, s67
    buffer_load_dwordx4 v3, s[4:7], s61 offen sc1 lds
    s_add_u32 s61, s3, 960
    s_sub_u32 s60, s61, 1152
    s_min_u32 s61, s61, s60
    s_lshl_b32 s61, s61, 6
    s_add_u32 m0, s66, 61440
    s_add_u32 s61, s61, s67
    buffer_load_dwordx4 v3, s[4:7], s61 offen sc1 lds
    s_add_u32 s61, s3, 1024
    s_sub_u32 s60, s61, 1152
    s_min_u32 s61, s61, s60
    s_lshl_b32 s61, s61, 6
    s_add_u32 m0, s66, 65536
    s_add_u32 s61, s61, s67
    buffer_load_dwordx4 v3, s[4:7], s61 offen sc1 lds
    s_add_u32 s61, s3, 1088
    s_sub_u32 s60, s61, 1152
    s_min_u32 s61, s61, s60
    s_lshl_b32 s61, s61, 6
    s_add_u32 m0, s66, 69632
    s_add_u32 s61, s61, s67
    buffer_load_dwordx4 v3, s[4:7], s61 offen sc1 lds
    s_waitcnt vmcnt(14)
    s_barrier
    v_add_u32 v27, 133120, v4
    ds_read_b128 v[68:71], v26 offset:0
    ds_read_b128 v[72:75], v27 offset:0
    ds_read_b128 v[76:79], v22 offset:0
    ds_read_b128 v[80:83], v23 offset:0
    ds_read_b128 v[84:87], v24 offset:0
    ds_read_b128 v[88:91], v25 offset:0
    ds_read_b128 v[92:95], v26 offset:4096
    ds_read_b128 v[96:99], v27 offset:1024
    ds_read_b128 v[100:103], v22 offset:4096
    ds_read_b128 v[104:107], v23 offset:4096
    ds_read_b128 v[108:111], v24 offset:4096
    s_waitcnt lgkmcnt(9)
    v_mfma_f32_16x16x32_bf16 v[64:67], v[68:71], v[72:75], 0
    s_waitcnt lgkmcnt(8)
    v_mfma_f32_16x16x32_bf16 v[32:35], v[76:79], a[0:3], 0
    ds_read_b128 v[68:71], v25 offset:4096
    v_mfma_f32_16x16x32_bf16 v[36:39], v[76:79], a[72:75], 0
    ds_read_b128 v[72:75], v26 offset:8192
    s_waitcnt lgkmcnt(9)
    v_mfma_f32_16x16x32_bf16 v[40:43], v[80:83], a[0:3], 0
    ds_read_b128 v[76:79], v27 offset:2048
    v_mfma_f32_16x16x32_bf16 v[44:47], v[80:83], a[72:75], 0
    s_waitcnt lgkmcnt(9)
    v_mfma_f32_16x16x32_bf16 v[48:51], v[84:87], a[0:3], 0
    ds_read_b128 v[80:83], v22 offset:8192
    v_mfma_f32_16x16x32_bf16 v[52:55], v[84:87], a[72:75], 0
    s_waitcnt lgkmcnt(9)
    v_mfma_f32_16x16x32_bf16 v[56:59], v[88:91], a[0:3], 0
    ds_read_b128 v[84:87], v23 offset:8192
    v_mfma_f32_16x16x32_bf16 v[60:63], v[88:91], a[72:75], 0
    s_waitcnt lgkmcnt(8)
    v_mfma_f32_16x16x32_bf16 v[64:67], v[92:95], v[96:99], v[64:67]
    ds_read_b128 v[88:91], v24 offset:8192
    s_waitcnt lgkmcnt(8)
    v_mfma_f32_16x16x32_bf16 v[32:35], v[100:103], a[4:7], v[32:35]
    ds_read_b128 v[92:95], v25 offset:8192
    v_mfma_f32_16x16x32_bf16 v[36:39], v[100:103], a[76:79], v[36:39]
    ds_read_b128 v[96:99], v26 offset:12288
    s_waitcnt lgkmcnt(9)
    v_mfma_f32_16x16x32_bf16 v[40:43], v[104:107], a[4:7], v[40:43]
    ds_read_b128 v[100:103], v27 offset:3072
    v_mfma_f32_16x16x32_bf16 v[44:47], v[104:107], a[76:79], v[44:47]
    s_waitcnt lgkmcnt(9)
    v_mfma_f32_16x16x32_bf16 v[48:51], v[108:111], a[4:7], v[48:51]
    ds_read_b128 v[104:107], v22 offset:12288
    v_mfma_f32_16x16x32_bf16 v[52:55], v[108:111], a[76:79], v[52:55]
    s_waitcnt lgkmcnt(9)
    v_mfma_f32_16x16x32_bf16 v[56:59], v[68:71], a[4:7], v[56:59]
    ds_read_b128 v[108:111], v23 offset:12288
    v_mfma_f32_16x16x32_bf16 v[60:63], v[68:71], a[76:79], v[60:63]
    s_waitcnt lgkmcnt(8)
    v_mfma_f32_16x16x32_bf16 v[64:67], v[72:75], v[76:79], v[64:67]
    ds_read_b128 v[68:71], v24 offset:12288
    s_waitcnt lgkmcnt(8)
    v_mfma_f32_16x16x32_bf16 v[32:35], v[80:83], a[8:11], v[32:35]
    ds_read_b128 v[72:75], v25 offset:12288
    v_mfma_f32_16x16x32_bf16 v[36:39], v[80:83], a[80:83], v[36:39]
    s_waitcnt vmcnt(8)
    s_barrier
    ds_read_b128 v[76:79], v26 offset:16384
    s_waitcnt lgkmcnt(9)
    v_mfma_f32_16x16x32_bf16 v[40:43], v[84:87], a[8:11], v[40:43]
    ds_read_b128 v[80:83], v27 offset:4096
    v_mfma_f32_16x16x32_bf16 v[44:47], v[84:87], a[80:83], v[44:47]
    s_waitcnt lgkmcnt(9)
    v_mfma_f32_16x16x32_bf16 v[48:51], v[88:91], a[8:11], v[48:51]
    ds_read_b128 v[84:87], v22 offset:16384
    v_mfma_f32_16x16x32_bf16 v[52:55], v[88:91], a[80:83], v[52:55]
    s_waitcnt lgkmcnt(9)
    v_mfma_f32_16x16x32_bf16 v[56:59], v[92:95], a[8:11], v[56:59]
    ds_read_b128 v[88:91], v23 offset:16384
    v_mfma_f32_16x16x32_bf16 v[60:63], v[92:95], a[80:83], v[60:63]
    s_waitcnt lgkmcnt(8)
    v_mfma_f32_16x16x32_bf16 v[64:67], v[96:99], v[100:103], v[64:67]
    ds_read_b128 v[92:95], v24 offset:16384
    s_waitcnt lgkmcnt(8)
    v_mfma_f32_16x16x32_bf16 v[32:35], v[104:107], a[12:15], v[32:35]
    ds_read_b128 v[96:99], v25 offset:16384
    v_mfma_f32_16x16x32_bf16 v[36:39], v[104:107], a[84:87], v[36:39]
    ds_read_b128 v[100:103], v26 offset:20480
    s_waitcnt lgkmcnt(9)
    v_mfma_f32_16x16x32_bf16 v[40:43], v[108:111], a[12:15], v[40:43]
    ds_read_b128 v[104:107], v27 offset:5120
    v_mfma_f32_16x16x32_bf16 v[44:47], v[108:111], a[84:87], v[44:47]
    s_waitcnt lgkmcnt(9)
    v_mfma_f32_16x16x32_bf16 v[48:51], v[68:71], a[12:15], v[48:51]
    ds_read_b128 v[108:111], v22 offset:20480
    v_mfma_f32_16x16x32_bf16 v[52:55], v[68:71], a[84:87], v[52:55]
    s_waitcnt lgkmcnt(9)
    v_mfma_f32_16x16x32_bf16 v[56:59], v[72:75], a[12:15], v[56:59]
    ds_read_b128 v[68:71], v23 offset:20480
    v_mfma_f32_16x16x32_bf16 v[60:63], v[72:75], a[84:87], v[60:63]
    s_waitcnt lgkmcnt(8)
    v_mfma_f32_16x16x32_bf16 v[64:67], v[76:79], v[80:83], v[64:67]
    ds_read_b128 v[72:75], v24 offset:20480
    s_waitcnt lgkmcnt(8)
    v_mfma_f32_16x16x32_bf16 v[32:35], v[84:87], a[16:19], v[32:35]
    ds_read_b128 v[76:79], v25 offset:20480
    v_mfma_f32_16x16x32_bf16 v[36:39], v[84:87], a[88:91], v[36:39]
    ds_read_b128 v[80:83], v26 offset:24576
    s_waitcnt lgkmcnt(9)
    v_mfma_f32_16x16x32_bf16 v[40:43], v[88:91], a[16:19], v[40:43]
    ds_read_b128 v[84:87], v27 offset:6144
    v_mfma_f32_16x16x32_bf16 v[44:47], v[88:91], a[88:91], v[44:47]
    s_waitcnt lgkmcnt(9)
    v_mfma_f32_16x16x32_bf16 v[48:51], v[92:95], a[16:19], v[48:51]
    ds_read_b128 v[88:91], v22 offset:24576
    v_mfma_f32_16x16x32_bf16 v[52:55], v[92:95], a[88:91], v[52:55]
    s_waitcnt lgkmcnt(9)
    v_mfma_f32_16x16x32_bf16 v[56:59], v[96:99], a[16:19], v[56:59]
    ds_read_b128 v[92:95], v23 offset:24576
    v_mfma_f32_16x16x32_bf16 v[60:63], v[96:99], a[88:91], v[60:63]
    s_waitcnt lgkmcnt(8)
    v_mfma_f32_16x16x32_bf16 v[64:67], v[100:103], v[104:107], v[64:67]
    ds_read_b128 v[96:99], v24 offset:24576
    s_waitcnt lgkmcnt(8)
    v_mfma_f32_16x16x32_bf16 v[32:35], v[108:111], a[20:23], v[32:35]
    ds_read_b128 v[100:103], v25 offset:24576
    v_mfma_f32_16x16x32_bf16 v[36:39], v[108:111], a[92:95], v[36:39]
    ds_read_b128 v[104:107], v26 offset:28672
    s_waitcnt lgkmcnt(9)
    v_mfma_f32_16x16x32_bf16 v[40:43], v[68:71], a[20:23], v[40:43]
    ds_read_b128 v[108:111], v27 offset:7168
    v_mfma_f32_16x16x32_bf16 v[44:47], v[68:71], a[92:95], v[44:47]
    s_waitcnt lgkmcnt(9)
    v_mfma_f32_16x16x32_bf16 v[48:51], v[72:75], a[20:23], v[48:51]
    ds_read_b128 v[68:71], v22 offset:28672
    v_mfma_f32_16x16x32_bf16 v[52:55], v[72:75], a[92:95], v[52:55]
    s_waitcnt lgkmcnt(9)
    v_mfma_f32_16x16x32_bf16 v[56:59], v[76:79], a[20:23], v[56:59]
    ds_read_b128 v[72:75], v23 offset:28672
    v_mfma_f32_16x16x32_bf16 v[60:63], v[76:79], a[92:95], v[60:63]
    s_waitcnt lgkmcnt(8)
    v_mfma_f32_16x16x32_bf16 v[64:67], v[80:83], v[84:87], v[64:67]
    ds_read_b128 v[76:79], v24 offset:28672
    s_waitcnt lgkmcnt(8)
    v_mfma_f32_16x16x32_bf16 v[32:35], v[88:91], a[24:27], v[32:35]
    ds_read_b128 v[80:83], v25 offset:28672
    v_mfma_f32_16x16x32_bf16 v[36:39], v[88:91], a[96:99], v[36:39]
    ds_read_b128 v[84:87], v26 offset:32768
    s_waitcnt lgkmcnt(9)
    v_mfma_f32_16x16x32_bf16 v[40:43], v[92:95], a[24:27], v[40:43]
    ds_read_b128 v[88:91], v27 offset:8192
    v_mfma_f32_16x16x32_bf16 v[44:47], v[92:95], a[96:99], v[44:47]
    s_waitcnt lgkmcnt(9)
    v_mfma_f32_16x16x32_bf16 v[48:51], v[96:99], a[24:27], v[48:51]
    ds_read_b128 v[92:95], v22 offset:32768
    v_mfma_f32_16x16x32_bf16 v[52:55], v[96:99], a[96:99], v[52:55]
    s_waitcnt lgkmcnt(9)
    v_mfma_f32_16x16x32_bf16 v[56:59], v[100:103], a[24:27], v[56:59]
    ds_read_b128 v[96:99], v23 offset:32768
    v_mfma_f32_16x16x32_bf16 v[60:63], v[100:103], a[96:99], v[60:63]
    s_waitcnt lgkmcnt(8)
    v_mfma_f32_16x16x32_bf16 v[64:67], v[104:107], v[108:111], v[64:67]
    ds_read_b128 v[100:103], v24 offset:32768
    s_waitcnt lgkmcnt(8)
    v_mfma_f32_16x16x32_bf16 v[32:35], v[68:71], a[28:31], v[32:35]
    ds_read_b128 v[104:107], v25 offset:32768
    v_mfma_f32_16x16x32_bf16 v[36:39], v[68:71], a[100:103], v[36:39]
    ds_read_b128 v[108:111], v26 offset:36864
    s_waitcnt lgkmcnt(9)
    v_mfma_f32_16x16x32_bf16 v[40:43], v[72:75], a[28:31], v[40:43]
    ds_read_b128 v[68:71], v27 offset:9216
    v_mfma_f32_16x16x32_bf16 v[44:47], v[72:75], a[100:103], v[44:47]
    s_waitcnt lgkmcnt(9)
    v_mfma_f32_16x16x32_bf16 v[48:51], v[76:79], a[28:31], v[48:51]
    ds_read_b128 v[72:75], v22 offset:36864
    v_mfma_f32_16x16x32_bf16 v[52:55], v[76:79], a[100:103], v[52:55]
    s_waitcnt lgkmcnt(9)
    v_mfma_f32_16x16x32_bf16 v[56:59], v[80:83], a[28:31], v[56:59]
    ds_read_b128 v[76:79], v23 offset:36864
    v_mfma_f32_16x16x32_bf16 v[60:63], v[80:83], a[100:103], v[60:63]
    s_waitcnt lgkmcnt(8)
    v_mfma_f32_16x16x32_bf16 v[64:67], v[84:87], v[88:91], v[64:67]
    ds_read_b128 v[80:83], v24 offset:36864
    s_waitcnt lgkmcnt(8)
    v_mfma_f32_16x16x32_bf16 v[32:35], v[92:95], a[32:35], v[32:35]
    ds_read_b128 v[84:87], v25 offset:36864
    v_mfma_f32_16x16x32_bf16 v[36:39], v[92:95], a[104:107], v[36:39]
    s_waitcnt vmcnt(0)
    s_barrier
    ds_read_b128 v[88:91], v26 offset:40960
    s_waitcnt lgkmcnt(9)
    v_mfma_f32_16x16x32_bf16 v[40:43], v[96:99], a[32:35], v[40:43]
    ds_read_b128 v[92:95], v27 offset:10240
    v_mfma_f32_16x16x32_bf16 v[44:47], v[96:99], a[104:107], v[44:47]
    s_waitcnt lgkmcnt(9)
    v_mfma_f32_16x16x32_bf16 v[48:51], v[100:103], a[32:35], v[48:51]
    ds_read_b128 v[96:99], v22 offset:40960
    v_mfma_f32_16x16x32_bf16 v[52:55], v[100:103], a[104:107], v[52:55]
    s_waitcnt lgkmcnt(9)
    v_mfma_f32_16x16x32_bf16 v[56:59], v[104:107], a[32:35], v[56:59]
    ds_read_b128 v[100:103], v23 offset:40960
    v_mfma_f32_16x16x32_bf16 v[60:63], v[104:107], a[104:107], v[60:63]
    s_waitcnt lgkmcnt(8)
    v_mfma_f32_16x16x32_bf16 v[64:67], v[108:111], v[68:71], v[64:67]
    ds_read_b128 v[104:107], v24 offset:40960
    s_waitcnt lgkmcnt(8)
    v_mfma_f32_16x16x32_bf16 v[32:35], v[72:75], a[36:39], v[32:35]
    ds_read_b128 v[108:111], v25 offset:40960
    v_mfma_f32_16x16x32_bf16 v[36:39], v[72:75], a[108:111], v[36:39]
    ds_read_b128 v[68:71], v26 offset:45056
    s_waitcnt lgkmcnt(9)
    v_mfma_f32_16x16x32_bf16 v[40:43], v[76:79], a[36:39], v[40:43]
    ds_read_b128 v[72:75], v27 offset:11264
    v_mfma_f32_16x16x32_bf16 v[44:47], v[76:79], a[108:111], v[44:47]
    s_waitcnt lgkmcnt(9)
    v_mfma_f32_16x16x32_bf16 v[48:51], v[80:83], a[36:39], v[48:51]
    ds_read_b128 v[76:79], v22 offset:45056
    v_mfma_f32_16x16x32_bf16 v[52:55], v[80:83], a[108:111], v[52:55]
    s_waitcnt lgkmcnt(9)
    v_mfma_f32_16x16x32_bf16 v[56:59], v[84:87], a[36:39], v[56:59]
    ds_read_b128 v[80:83], v23 offset:45056
    v_mfma_f32_16x16x32_bf16 v[60:63], v[84:87], a[108:111], v[60:63]
    s_waitcnt lgkmcnt(8)
    v_mfma_f32_16x16x32_bf16 v[64:67], v[88:91], v[92:95], v[64:67]
    ds_read_b128 v[84:87], v24 offset:45056
    s_waitcnt lgkmcnt(8)
    v_mfma_f32_16x16x32_bf16 v[32:35], v[96:99], a[40:43], v[32:35]
    ds_read_b128 v[88:91], v25 offset:45056
    v_mfma_f32_16x16x32_bf16 v[36:39], v[96:99], a[112:115], v[36:39]
    ds_read_b128 v[92:95], v26 offset:49152
    s_waitcnt lgkmcnt(9)
    v_mfma_f32_16x16x32_bf16 v[40:43], v[100:103], a[40:43], v[40:43]
    ds_read_b128 v[96:99], v27 offset:12288
    v_mfma_f32_16x16x32_bf16 v[44:47], v[100:103], a[112:115], v[44:47]
    s_waitcnt lgkmcnt(9)
    v_mfma_f32_16x16x32_bf16 v[48:51], v[104:107], a[40:43], v[48:51]
    ds_read_b128 v[100:103], v22 offset:49152
    v_mfma_f32_16x16x32_bf16 v[52:55], v[104:107], a[112:115], v[52:55]
    s_waitcnt lgkmcnt(9)
    v_mfma_f32_16x16x32_bf16 v[56:59], v[108:111], a[40:43], v[56:59]
    ds_read_b128 v[104:107], v23 offset:49152
    v_mfma_f32_16x16x32_bf16 v[60:63], v[108:111], a[112:115], v[60:63]
    s_waitcnt lgkmcnt(8)
    v_mfma_f32_16x16x32_bf16 v[64:67], v[68:71], v[72:75], v[64:67]
    ds_read_b128 v[108:111], v24 offset:49152
    s_waitcnt lgkmcnt(8)
    v_mfma_f32_16x16x32_bf16 v[32:35], v[76:79], a[44:47], v[32:35]
    ds_read_b128 v[68:71], v25 offset:49152
    v_mfma_f32_16x16x32_bf16 v[36:39], v[76:79], a[116:119], v[36:39]
    ds_read_b128 v[72:75], v26 offset:53248
    s_waitcnt lgkmcnt(9)
    v_mfma_f32_16x16x32_bf16 v[40:43], v[80:83], a[44:47], v[40:43]
    ds_read_b128 v[76:79], v27 offset:13312
    v_mfma_f32_16x16x32_bf16 v[44:47], v[80:83], a[116:119], v[44:47]
    s_waitcnt lgkmcnt(9)
    v_mfma_f32_16x16x32_bf16 v[48:51], v[84:87], a[44:47], v[48:51]
    ds_read_b128 v[80:83], v22 offset:53248
    v_mfma_f32_16x16x32_bf16 v[52:55], v[84:87], a[116:119], v[52:55]
    s_waitcnt lgkmcnt(9)
    v_mfma_f32_16x16x32_bf16 v[56:59], v[88:91], a[44:47], v[56:59]
    ds_read_b128 v[84:87], v23 offset:53248
    v_mfma_f32_16x16x32_bf16 v[60:63], v[88:91], a[116:119], v[60:63]
    s_waitcnt lgkmcnt(8)
    v_mfma_f32_16x16x32_bf16 v[64:67], v[92:95], v[96:99], v[64:67]
    ds_read_b128 v[88:91], v24 offset:53248
    s_waitcnt lgkmcnt(8)
    v_mfma_f32_16x16x32_bf16 v[32:35], v[100:103], a[48:51], v[32:35]
    ds_read_b128 v[92:95], v25 offset:53248
    v_mfma_f32_16x16x32_bf16 v[36:39], v[100:103], a[120:123], v[36:39]
    ds_read_b128 v[96:99], v26 offset:57344
    s_waitcnt lgkmcnt(9)
    v_mfma_f32_16x16x32_bf16 v[40:43], v[104:107], a[48:51], v[40:43]
    ds_read_b128 v[100:103], v27 offset:14336
    v_mfma_f32_16x16x32_bf16 v[44:47], v[104:107], a[120:123], v[44:47]
    s_waitcnt lgkmcnt(9)
    v_mfma_f32_16x16x32_bf16 v[48:51], v[108:111], a[48:51], v[48:51]
    ds_read_b128 v[104:107], v22 offset:57344
    v_mfma_f32_16x16x32_bf16 v[52:55], v[108:111], a[120:123], v[52:55]
    s_waitcnt lgkmcnt(9)
    v_mfma_f32_16x16x32_bf16 v[56:59], v[68:71], a[48:51], v[56:59]
    ds_read_b128 v[108:111], v23 offset:57344
    v_mfma_f32_16x16x32_bf16 v[60:63], v[68:71], a[120:123], v[60:63]
    s_waitcnt lgkmcnt(8)
    v_mfma_f32_16x16x32_bf16 v[64:67], v[72:75], v[76:79], v[64:67]
    ds_read_b128 v[68:71], v24 offset:57344
    s_waitcnt lgkmcnt(8)
    v_mfma_f32_16x16x32_bf16 v[32:35], v[80:83], a[52:55], v[32:35]
    ds_read_b128 v[72:75], v25 offset:57344
    v_mfma_f32_16x16x32_bf16 v[36:39], v[80:83], a[124:127], v[36:39]
    ds_read_b128 v[76:79], v26 offset:61440
    s_waitcnt lgkmcnt(9)
    v_mfma_f32_16x16x32_bf16 v[40:43], v[84:87], a[52:55], v[40:43]
    ds_read_b128 v[80:83], v27 offset:15360
    v_mfma_f32_16x16x32_bf16 v[44:47], v[84:87], a[124:127], v[44:47]
    s_waitcnt lgkmcnt(9)
    v_mfma_f32_16x16x32_bf16 v[48:51], v[88:91], a[52:55], v[48:51]
    ds_read_b128 v[84:87], v22 offset:61440
    v_mfma_f32_16x16x32_bf16 v[52:55], v[88:91], a[124:127], v[52:55]
    s_waitcnt lgkmcnt(9)
    v_mfma_f32_16x16x32_bf16 v[56:59], v[92:95], a[52:55], v[56:59]
    ds_read_b128 v[88:91], v23 offset:61440
    v_mfma_f32_16x16x32_bf16 v[60:63], v[92:95], a[124:127], v[60:63]
    s_waitcnt lgkmcnt(8)
    v_mfma_f32_16x16x32_bf16 v[64:67], v[96:99], v[100:103], v[64:67]
    ds_read_b128 v[92:95], v24 offset:61440
    s_waitcnt lgkmcnt(8)
    v_mfma_f32_16x16x32_bf16 v[32:35], v[104:107], a[56:59], v[32:35]
    ds_read_b128 v[96:99], v25 offset:61440
    v_mfma_f32_16x16x32_bf16 v[36:39], v[104:107], a[128:131], v[36:39]
    v_add_u32 v22, 32768, v22
    v_add_u32 v23, 32768, v23
    v_add_u32 v24, 32768, v24
    v_add_u32 v25, 32768, v25
    v_add_u32 v26, 32768, v26
    ds_read_b128 v[100:103], v26 offset:32768
    s_waitcnt lgkmcnt(9)
    v_mfma_f32_16x16x32_bf16 v[40:43], v[108:111], a[56:59], v[40:43]
    ds_read_b128 v[104:107], v27 offset:16384
    v_mfma_f32_16x16x32_bf16 v[44:47], v[108:111], a[128:131], v[44:47]
    s_waitcnt lgkmcnt(9)
    v_mfma_f32_16x16x32_bf16 v[48:51], v[68:71], a[56:59], v[48:51]
    ds_read_b128 v[108:111], v22 offset:32768
    v_mfma_f32_16x16x32_bf16 v[52:55], v[68:71], a[128:131], v[52:55]
    s_waitcnt lgkmcnt(9)
    v_mfma_f32_16x16x32_bf16 v[56:59], v[72:75], a[56:59], v[56:59]
    ds_read_b128 v[68:71], v23 offset:32768
    v_mfma_f32_16x16x32_bf16 v[60:63], v[72:75], a[128:131], v[60:63]
    s_waitcnt lgkmcnt(8)
    v_mfma_f32_16x16x32_bf16 v[64:67], v[76:79], v[80:83], v[64:67]
    ds_read_b128 v[72:75], v24 offset:32768
    s_waitcnt lgkmcnt(8)
    v_mfma_f32_16x16x32_bf16 v[32:35], v[84:87], a[60:63], v[32:35]
    ds_read_b128 v[76:79], v25 offset:32768
    v_mfma_f32_16x16x32_bf16 v[36:39], v[84:87], a[132:135], v[36:39]
    ds_read_b128 v[80:83], v26 offset:36864
    s_waitcnt lgkmcnt(9)
    v_mfma_f32_16x16x32_bf16 v[40:43], v[88:91], a[60:63], v[40:43]
    ds_read_b128 v[84:87], v27 offset:17408
    v_mfma_f32_16x16x32_bf16 v[44:47], v[88:91], a[132:135], v[44:47]
    ds_read_b32 v29, v5 offset:24
    s_waitcnt lgkmcnt(10)
    v_mfma_f32_16x16x32_bf16 v[48:51], v[92:95], a[60:63], v[48:51]
    ds_read_b128 v[88:91], v22 offset:36864
    v_mfma_f32_16x16x32_bf16 v[52:55], v[92:95], a[132:135], v[52:55]
    s_waitcnt lgkmcnt(10)
    v_mfma_f32_16x16x32_bf16 v[56:59], v[96:99], a[60:63], v[56:59]
    ds_read_b128 v[92:95], v23 offset:36864
    v_mfma_f32_16x16x32_bf16 v[60:63], v[96:99], a[132:135], v[60:63]
    s_waitcnt lgkmcnt(2)
    v_cmp_gt_u32 vcc, 1, v29
    s_cbranch_vccz scok_31
    s_mov_b32 s77, 3200000
cw_32:
    ds_read_b32 v29, v5 offset:24
    s_waitcnt lgkmcnt(0)
    v_cmp_gt_u32 vcc, 1, v29
    s_cbranch_vccz cwo_33
    s_sub_u32 s77, s77, 1
    s_cmp_lg_u32 s77, 0
    s_cbranch_scc1 cw_32
cwo_33:
scok_31:
    v_lshlrev_b32 v30, 7, v2
    v_add_u32 v30, 151808, v30
    s_waitcnt lgkmcnt(9)
    v_mfma_f32_16x16x32_bf16 v[64:67], v[100:103], v[104:107], v[64:67]
    ds_read_b128 v[96:99], v24 offset:36864
    s_waitcnt lgkmcnt(9)
    v_mfma_f32_16x16x32_bf16 v[32:35], v[108:111], a[64:67], v[32:35]
    ds_read_b128 v[100:103], v25 offset:36864
    v_mfma_f32_16x16x32_bf16 v[36:39], v[108:111], a[136:139], v[36:39]
    ds_read_b128 v[104:107], v30 offset:0
    s_waitcnt lgkmcnt(10)
    v_mfma_f32_16x16x32_bf16 v[40:43], v[68:71], a[64:67], v[40:43]
    ds_read_b128 v[108:111], v30 offset:16
    v_mfma_f32_16x16x32_bf16 v[44:47], v[68:71], a[136:139], v[44:47]
    ds_read_b128 v[68:71], v30 offset:32
    s_waitcnt lgkmcnt(11)
    v_mfma_f32_16x16x32_bf16 v[48:51], v[72:75], a[64:67], v[48:51]
    v_mfma_f32_16x16x32_bf16 v[52:55], v[72:75], a[136:139], v[52:55]
    ds_read_b128 v[72:75], v30 offset:48
    s_waitcnt lgkmcnt(11)
    v_mfma_f32_16x16x32_bf16 v[56:59], v[76:79], a[64:67], v[56:59]
    v_mfma_f32_16x16x32_bf16 v[60:63], v[76:79], a[136:139], v[60:63]
    ds_read_b128 v[76:79], v30 offset:64
    s_waitcnt lgkmcnt(10)
    v_mfma_f32_16x16x32_bf16 v[64:67], v[80:83], v[84:87], v[64:67]
    ds_read_b128 v[80:83], v30 offset:80
    s_waitcnt lgkmcnt(9)
    v_mfma_f32_16x16x32_bf16 v[32:35], v[88:91], a[68:71], v[32:35]
    ds_read_b128 v[84:87], v30 offset:96
    v_mfma_f32_16x16x32_bf16 v[36:39], v[88:91], a[140:143], v[36:39]
    ds_read_b128 v[88:91], v30 offset:112
    s_waitcnt lgkmcnt(10)
    v_mfma_f32_16x16x32_bf16 v[40:43], v[92:95], a[68:71], v[40:43]
    v_mfma_f32_16x16x32_bf16 v[44:47], v[92:95], a[140:143], v[44:47]
    s_waitcnt lgkmcnt(9)
    v_mfma_f32_16x16x32_bf16 v[48:51], v[96:99], a[68:71], v[48:51]
    v_mfma_f32_16x16x32_bf16 v[52:55], v[96:99], a[140:143], v[52:55]
    s_waitcnt lgkmcnt(8)
    v_mfma_f32_16x16x32_bf16 v[56:59], v[100:103], a[68:71], v[56:59]
    v_mfma_f32_16x16x32_bf16 v[60:63], v[100:103], a[140:143], v[60:63]
    s_setprio 3
    ds_write2_b32 v31, v64, v65 offset0:0 offset1:2
    ds_write2_b32 v31, v66, v67 offset0:4 offset1:6
    v_mov_b32 v64, 1
    s_mov_b64 exec, 1
    ds_add_u32 v5, v64 offset:32
    s_mov_b64 exec, -1
    s_waitcnt lgkmcnt(10)
    v_pk_mul_f32 v[22:23], v[104:105], v[8:9] op_sel:[1,0] op_sel_hi:[1,1]
    v_fma_f32 v22, v104, v32, -v22
    v_fma_f32 v23, v104, v36, -v23
    v_pk_mul_f32 v[24:25], v[106:107], v[8:9] op_sel:[1,0] op_sel_hi:[1,1]
    v_fma_f32 v24, v106, v33, -v24
    v_fma_f32 v25, v106, v37, -v25
    v_pk_fma_f32 v[24:25], v[22:23], v[6:7], v[24:25] op_sel:[0,0,0] op_sel_hi:[1,0,1]
    v_pk_fma_f32 v[24:25], v[22:23], v[6:7], v[24:25] op_sel:[1,1,0] op_sel_hi:[0,1,1] neg_lo:[1,0,0]
    s_waitcnt lgkmcnt(9)
    v_pk_mul_f32 v[26:27], v[108:109], v[8:9] op_sel:[1,0] op_sel_hi:[1,1]
    v_fma_f32 v26, v108, v34, -v26
    v_fma_f32 v27, v108, v38, -v27
    v_pk_fma_f32 v[26:27], v[24:25], v[6:7], v[26:27] op_sel:[0,0,0] op_sel_hi:[1,0,1]
    v_pk_fma_f32 v[26:27], v[24:25], v[6:7], v[26:27] op_sel:[1,1,0] op_sel_hi:[0,1,1] neg_lo:[1,0,0]
    v_pk_mul_f32 v[28:29], v[110:111], v[8:9] op_sel:[1,0] op_sel_hi:[1,1]
    v_fma_f32 v28, v110, v35, -v28
    v_fma_f32 v29, v110, v39, -v29
    v_pk_fma_f32 v[28:29], v[26:27], v[6:7], v[28:29] op_sel:[0,0,0] op_sel_hi:[1,0,1]
    v_pk_fma_f32 v[28:29], v[26:27], v[6:7], v[28:29] op_sel:[1,1,0] op_sel_hi:[0,1,1] neg_lo:[1,0,0]
    s_waitcnt lgkmcnt(8)
    v_pk_mul_f32 v[32:33], v[68:69], v[8:9] op_sel:[1,0] op_sel_hi:[1,1]
    v_fma_f32 v32, v68, v40, -v32
    v_fma_f32 v33, v68, v44, -v33
    v_pk_fma_f32 v[32:33], v[28:29], v[6:7], v[32:33] op_sel:[0,0,0] op_sel_hi:[1,0,1]
    v_pk_fma_f32 v[32:33], v[28:29], v[6:7], v[32:33] op_sel:[1,1,0] op_sel_hi:[0,1,1] neg_lo:[1,0,0]
    v_pk_mul_f32 v[34:35], v[70:71], v[8:9] op_sel:[1,0] op_sel_hi:[1,1]
    v_fma_f32 v34, v70, v41, -v34
    v_fma_f32 v35, v70, v45, -v35
    v_pk_fma_f32 v[34:35], v[32:33], v[6:7], v[34:35] op_sel:[0,0,0] op_sel_hi:[1,0,1]
    v_pk_fma_f32 v[34:35], v[32:33], v[6:7], v[34:35] op_sel:[1,1,0] op_sel_hi:[0,1,1] neg_lo:[1,0,0]
    s_waitcnt lgkmcnt(7)
    v_pk_mul_f32 v[36:37], v[72:73], v[8:9] op_sel:[1,0] op_sel_hi:[1,1]
    v_fma_f32 v36, v72, v42, -v36
    v_fma_f32 v37, v72, v46, -v37
    v_pk_fma_f32 v[36:37], v[34:35], v[6:7], v[36:37] op_sel:[0,0,0] op_sel_hi:[1,0,1]
    v_pk_fma_f32 v[36:37], v[34:35], v[6:7], v[36:37] op_sel:[1,1,0] op_sel_hi:[0,1,1] neg_lo:[1,0,0]
    v_pk_mul_f32 v[38:39], v[74:75], v[8:9] op_sel:[1,0] op_sel_hi:[1,1]
    v_fma_f32 v38, v74, v43, -v38
    v_fma_f32 v39, v74, v47, -v39
    v_pk_fma_f32 v[38:39], v[36:37], v[6:7], v[38:39] op_sel:[0,0,0] op_sel_hi:[1,0,1]
    v_pk_fma_f32 v[38:39], v[36:37], v[6:7], v[38:39] op_sel:[1,1,0] op_sel_hi:[0,1,1] neg_lo:[1,0,0]
    s_waitcnt lgkmcnt(6)
    v_pk_mul_f32 v[40:41], v[76:77], v[8:9] op_sel:[1,0] op_sel_hi:[1,1]
    v_fma_f32 v40, v76, v48, -v40
    v_fma_f32 v41, v76, v52, -v41
    v_pk_fma_f32 v[40:41], v[38:39], v[6:7], v[40:41] op_sel:[0,0,0] op_sel_hi:[1,0,1]
    v_pk_fma_f32 v[40:41], v[38:39], v[6:7], v[40:41] op_sel:[1,1,0] op_sel_hi:[0,1,1] neg_lo:[1,0,0]
    v_pk_mul_f32 v[42:43], v[78:79], v[8:9] op_sel:[1,0] op_sel_hi:[1,1]
    v_fma_f32 v42, v78, v49, -v42
    v_fma_f32 v43, v78, v53, -v43
    v_pk_fma_f32 v[42:43], v[40:41], v[6:7], v[42:43] op_sel:[0,0,0] op_sel_hi:[1,0,1]
    v_pk_fma_f32 v[42:43], v[40:41], v[6:7], v[42:43] op_sel:[1,1,0] op_sel_hi:[0,1,1] neg_lo:[1,0,0]
    s_waitcnt lgkmcnt(5)
    v_pk_mul_f32 v[44:45], v[80:81], v[8:9] op_sel:[1,0] op_sel_hi:[1,1]
    v_fma_f32 v44, v80, v50, -v44
    v_fma_f32 v45, v80, v54, -v45
    v_pk_fma_f32 v[44:45], v[42:43], v[6:7], v[44:45] op_sel:[0,0,0] op_sel_hi:[1,0,1]
    v_pk_fma_f32 v[44:45], v[42:43], v[6:7], v[44:45] op_sel:[1,1,0] op_sel_hi:[0,1,1] neg_lo:[1,0,0]
    v_pk_mul_f32 v[46:47], v[82:83], v[8:9] op_sel:[1,0] op_sel_hi:[1,1]
    v_fma_f32 v46, v82, v51, -v46
    v_fma_f32 v47, v82, v55, -v47
    v_pk_fma_f32 v[46:47], v[44:45], v[6:7], v[46:47] op_sel:[0,0,0] op_sel_hi:[1,0,1]
    v_pk_fma_f32 v[46:47], v[44:45], v[6:7], v[46:47] op_sel:[1,1,0] op_sel_hi:[0,1,1] neg_lo:[1,0,0]
    s_waitcnt lgkmcnt(4)
    v_pk_mul_f32 v[48:49], v[84:85], v[8:9] op_sel:[1,0] op_sel_hi:[1,1]
    v_fma_f32 v48, v84, v56, -v48
    v_fma_f32 v49, v84, v60, -v49
    v_pk_fma_f32 v[48:49], v[46:47], v[6:7], v[48:49] op_sel:[0,0,0] op_sel_hi:[1,0,1]
    v_pk_fma_f32 v[48:49], v[46:47], v[6:7], v[48:49] op_sel:[1,1,0] op_sel_hi:[0,1,1] neg_lo:[1,0,0]
    v_pk_mul_f32 v[50:51], v[86:87], v[8:9] op_sel:[1,0] op_sel_hi:[1,1]
    v_fma_f32 v50, v86, v57, -v50
    v_fma_f32 v51, v86, v61, -v51
    v_pk_fma_f32 v[50:51], v[48:49], v[6:7], v[50:51] op_sel:[0,0,0] op_sel_hi:[1,0,1]
    v_pk_fma_f32 v[50:51], v[48:49], v[6:7], v[50:51] op_sel:[1,1,0] op_sel_hi:[0,1,1] neg_lo:[1,0,0]
    s_waitcnt lgkmcnt(3)
    v_pk_mul_f32 v[52:53], v[88:89], v[8:9] op_sel:[1,0] op_sel_hi:[1,1]
    v_fma_f32 v52, v88, v58, -v52
    v_fma_f32 v53, v88, v62, -v53
    v_pk_fma_f32 v[52:53], v[50:51], v[6:7], v[52:53] op_sel:[0,0,0] op_sel_hi:[1,0,1]
    v_pk_fma_f32 v[52:53], v[50:51], v[6:7], v[52:53] op_sel:[1,1,0] op_sel_hi:[0,1,1] neg_lo:[1,0,0]
    v_pk_mul_f32 v[54:55], v[90:91], v[8:9] op_sel:[1,0] op_sel_hi:[1,1]
    v_fma_f32 v54, v90, v59, -v54
    v_fma_f32 v55, v90, v63, -v55
    v_pk_fma_f32 v[54:55], v[52:53], v[6:7], v[54:55] op_sel:[0,0,0] op_sel_hi:[1,0,1]
    v_pk_fma_f32 v[54:55], v[52:53], v[6:7], v[54:55] op_sel:[1,1,0] op_sel_hi:[0,1,1] neg_lo:[1,0,0]
    s_lshl_b32 s60, s54, 8
    s_add_u32 s60, s60, s34
    v_pk_mul_f32 v[56:57], v[54:55], v[10:11] op_sel:[0,0] op_sel_hi:[1,0]
    v_pk_fma_f32 v[56:57], v[54:55], v[10:11], v[56:57] op_sel:[1,1,0] op_sel_hi:[0,1,1] neg_lo:[1,0,0]
    v_mov_b32 v61, s55
    v_mov_b32 v63, s55
    v_mov_b64 v[58:59], v[56:57]
    s_nop 1
    v_permlane32_swap_b32 v56, v58
    v_permlane32_swap_b32 v57, v59
    v_pk_add_f32 v[56:57], v[56:57], v[58:59]
    v_mov_b64 v[58:59], v[56:57]
    s_nop 1
    v_permlane16_swap_b32 v56, v58
    v_permlane16_swap_b32 v57, v59
    v_add_f32 v60, v56, v58
    v_add_f32 v62, v57, v59
    s_mov_b64 exec, 0xffff
    buffer_store_dwordx4 v[60:63], v3, s[8:11], s60 offen sc1
    s_mov_b64 exec, -1
    s_lshl_b32 s60, s54, 9
    s_add_u32 s60, s60, 156800
    v_and_b32 v64, 15, v0
    v_lshlrev_b32 v64, 5, v64
    v_add_u32 v64, s60, v64
    v_lshl_add_u32 v65, v2, 3, v64
    ds_write_b64 v65, v[54:55]
    ds_read_b128 v[68:71], v64 offset:0
    ds_read_b128 v[72:75], v64 offset:16
    v_pk_mul_f32 v[66:67], v[22:23], v[12:13] op_sel:[0,0] op_sel_hi:[1,0]
    v_pk_fma_f32 v[66:67], v[22:23], v[12:13], v[66:67] op_sel:[1,1,0] op_sel_hi:[0,1,1] neg_lo:[1,0,0]
    v_mov_b64 v[22:23], v[66:67]
    v_pk_mul_f32 v[66:67], v[24:25], v[12:13] op_sel:[0,0] op_sel_hi:[1,0]
    v_pk_fma_f32 v[66:67], v[24:25], v[12:13], v[66:67] op_sel:[1,1,0] op_sel_hi:[0,1,1] neg_lo:[1,0,0]
    v_mov_b64 v[24:25], v[66:67]
    v_pk_mul_f32 v[66:67], v[26:27], v[12:13] op_sel:[0,0] op_sel_hi:[1,0]
    v_pk_fma_f32 v[66:67], v[26:27], v[12:13], v[66:67] op_sel:[1,1,0] op_sel_hi:[0,1,1] neg_lo:[1,0,0]
    v_mov_b64 v[26:27], v[66:67]
    v_pk_mul_f32 v[66:67], v[28:29], v[12:13] op_sel:[0,0] op_sel_hi:[1,0]
    v_pk_fma_f32 v[66:67], v[28:29], v[12:13], v[66:67] op_sel:[1,1,0] op_sel_hi:[0,1,1] neg_lo:[1,0,0]
    v_mov_b64 v[28:29], v[66:67]
    v_pk_mul_f32 v[66:67], v[32:33], v[12:13] op_sel:[0,0] op_sel_hi:[1,0]
    v_pk_fma_f32 v[66:67], v[32:33], v[12:13], v[66:67] op_sel:[1,1,0] op_sel_hi:[0,1,1] neg_lo:[1,0,0]
    v_mov_b64 v[32:33], v[66:67]
    v_pk_mul_f32 v[66:67], v[34:35], v[12:13] op_sel:[0,0] op_sel_hi:[1,0]
    v_pk_fma_f32 v[66:67], v[34:35], v[12:13], v[66:67] op_sel:[1,1,0] op_sel_hi:[0,1,1] neg_lo:[1,0,0]
    v_mov_b64 v[34:35], v[66:67]
    v_pk_mul_f32 v[66:67], v[36:37], v[12:13] op_sel:[0,0] op_sel_hi:[1,0]
    v_pk_fma_f32 v[66:67], v[36:37], v[12:13], v[66:67] op_sel:[1,1,0] op_sel_hi:[0,1,1] neg_lo:[1,0,0]
    v_mov_b64 v[36:37], v[66:67]
    v_pk_mul_f32 v[66:67], v[38:39], v[12:13] op_sel:[0,0] op_sel_hi:[1,0]
    v_pk_fma_f32 v[66:67], v[38:39], v[12:13], v[66:67] op_sel:[1,1,0] op_sel_hi:[0,1,1] neg_lo:[1,0,0]
    v_mov_b64 v[38:39], v[66:67]
    v_pk_mul_f32 v[66:67], v[40:41], v[12:13] op_sel:[0,0] op_sel_hi:[1,0]
    v_pk_fma_f32 v[66:67], v[40:41], v[12:13], v[66:67] op_sel:[1,1,0] op_sel_hi:[0,1,1] neg_lo:[1,0,0]
    v_mov_b64 v[40:41], v[66:67]
    v_pk_mul_f32 v[66:67], v[42:43], v[12:13] op_sel:[0,0] op_sel_hi:[1,0]
    v_pk_fma_f32 v[66:67], v[42:43], v[12:13], v[66:67] op_sel:[1,1,0] op_sel_hi:[0,1,1] neg_lo:[1,0,0]
    v_mov_b64 v[42:43], v[66:67]
    v_pk_mul_f32 v[66:67], v[44:45], v[12:13] op_sel:[0,0] op_sel_hi:[1,0]
    v_pk_fma_f32 v[66:67], v[44:45], v[12:13], v[66:67] op_sel:[1,1,0] op_sel_hi:[0,1,1] neg_lo:[1,0,0]
    v_mov_b64 v[44:45], v[66:67]
    v_pk_mul_f32 v[66:67], v[46:47], v[12:13] op_sel:[0,0] op_sel_hi:[1,0]
    v_pk_fma_f32 v[66:67], v[46:47], v[12:13], v[66:67] op_sel:[1,1,0] op_sel_hi:[0,1,1] neg_lo:[1,0,0]
    v_mov_b64 v[46:47], v[66:67]
    v_pk_mul_f32 v[66:67], v[48:49], v[12:13] op_sel:[0,0] op_sel_hi:[1,0]
    v_pk_fma_f32 v[66:67], v[48:49], v[12:13], v[66:67] op_sel:[1,1,0] op_sel_hi:[0,1,1] neg_lo:[1,0,0]
    v_mov_b64 v[48:49], v[66:67]
    v_pk_mul_f32 v[66:67], v[50:51], v[12:13] op_sel:[0,0] op_sel_hi:[1,0]
    v_pk_fma_f32 v[66:67], v[50:51], v[12:13], v[66:67] op_sel:[1,1,0] op_sel_hi:[0,1,1] neg_lo:[1,0,0]
    v_mov_b64 v[50:51], v[66:67]
    v_pk_mul_f32 v[66:67], v[52:53], v[12:13] op_sel:[0,0] op_sel_hi:[1,0]
    v_pk_fma_f32 v[66:67], v[52:53], v[12:13], v[66:67] op_sel:[1,1,0] op_sel_hi:[0,1,1] neg_lo:[1,0,0]
    v_mov_b64 v[52:53], v[66:67]
    s_waitcnt lgkmcnt(0)
    v_pk_mul_f32 v[66:67], v[54:55], v[12:13] op_sel:[0,0] op_sel_hi:[1,0]
    v_pk_fma_f32 v[66:67], v[54:55], v[12:13], v[66:67] op_sel:[1,1,0] op_sel_hi:[0,1,1] neg_lo:[1,0,0]
    v_mov_b64 v[54:55], v[66:67]
    v_mov_b32 v110, 0
    v_mov_b32 v111, 0
    s_mov_b32 exec_lo, 0xffff0000
    s_mov_b32 exec_hi, 0xffffffff
    v_mov_b64 v[110:111], v[68:69]
    s_mov_b64 exec, -1
    v_pk_fma_f32 v[70:71], v[110:111], v[14:15], v[70:71] op_sel:[0,0,0] op_sel_hi:[1,0,1]
    v_pk_fma_f32 v[70:71], v[110:111], v[14:15], v[70:71] op_sel:[1,1,0] op_sel_hi:[0,1,1] neg_lo:[1,0,0]
    s_mov_b32 exec_lo, 0x0
    s_mov_b32 exec_hi, 0xffffffff
    v_mov_b64 v[110:111], v[70:71]
    s_mov_b64 exec, -1
    v_pk_fma_f32 v[72:73], v[110:111], v[14:15], v[72:73] op_sel:[0,0,0] op_sel_hi:[1,0,1]
    v_pk_fma_f32 v[72:73], v[110:111], v[14:15], v[72:73] op_sel:[1,1,0] op_sel_hi:[0,1,1] neg_lo:[1,0,0]
    s_mov_b32 exec_lo, 0x0
    s_mov_b32 exec_hi, 0xffff0000
    v_mov_b64 v[110:111], v[72:73]
    s_mov_b64 exec, -1
    s_lshl_b32 s60, s54, 8
    s_sub_u32 s61, 32, s52
    v_mul_u32_u24 v106, 8, v2
    v_sub_u32 v108, s52, v106
    v_add_u32 v106, s61, v106
    v_mul_u32_u24 v106, 1152, v106
    v_lshl_add_u32 v106, v1, 4, v106
    v_add_u32 v106, s60, v106
    v_med3_i32 v108, v108, 0, 8
    v_lshlrev_b32 v108, 1, v108
    v_mul_lo_u32 v108, v108, s55
    v_add_u32 v107, 4608, v106
    v_pk_mul_f32 v[88:89], v[12:13], v[6:7] op_sel:[0,0] op_sel_hi:[1,0]
    v_pk_fma_f32 v[88:89], v[12:13], v[6:7], v[88:89] op_sel:[1,1,0] op_sel_hi:[0,1,1] neg_lo:[1,0,0]
    v_pk_mul_f32 v[90:91], v[88:89], v[6:7] op_sel:[0,0] op_sel_hi:[1,0]
    v_pk_fma_f32 v[90:91], v[88:89], v[6:7], v[90:91] op_sel:[1,1,0] op_sel_hi:[0,1,1] neg_lo:[1,0,0]
    v_pk_mul_f32 v[92:93], v[90:91], v[6:7] op_sel:[0,0] op_sel_hi:[1,0]
    v_pk_fma_f32 v[92:93], v[90:91], v[6:7], v[92:93] op_sel:[1,1,0] op_sel_hi:[0,1,1] neg_lo:[1,0,0]
    v_pk_mul_f32 v[94:95], v[92:93], v[6:7] op_sel:[0,0] op_sel_hi:[1,0]
    v_pk_fma_f32 v[94:95], v[92:93], v[6:7], v[94:95] op_sel:[1,1,0] op_sel_hi:[0,1,1] neg_lo:[1,0,0]
    v_pk_mul_f32 v[96:97], v[94:95], v[6:7] op_sel:[0,0] op_sel_hi:[1,0]
    v_pk_fma_f32 v[96:97], v[94:95], v[6:7], v[96:97] op_sel:[1,1,0] op_sel_hi:[0,1,1] neg_lo:[1,0,0]
    v_pk_mul_f32 v[98:99], v[96:97], v[6:7] op_sel:[0,0] op_sel_hi:[1,0]
    v_pk_fma_f32 v[98:99], v[96:97], v[6:7], v[98:99] op_sel:[1,1,0] op_sel_hi:[0,1,1] neg_lo:[1,0,0]
    v_pk_mul_f32 v[100:101], v[98:99], v[6:7] op_sel:[0,0] op_sel_hi:[1,0]
    v_pk_fma_f32 v[100:101], v[98:99], v[6:7], v[100:101] op_sel:[1,1,0] op_sel_hi:[0,1,1] neg_lo:[1,0,0]
    v_pk_mul_f32 v[102:103], v[100:101], v[6:7] op_sel:[0,0] op_sel_hi:[1,0]
    v_pk_fma_f32 v[102:103], v[100:101], v[6:7], v[102:103] op_sel:[1,1,0] op_sel_hi:[0,1,1] neg_lo:[1,0,0]
    v_pk_mul_f32 v[104:105], v[6:7], v[6:7] op_sel:[0,0] op_sel_hi:[1,0]
    v_pk_fma_f32 v[104:105], v[6:7], v[6:7], v[104:105] op_sel:[1,1,0] op_sel_hi:[0,1,1] neg_lo:[1,0,0]
    s_lshl_b32 s60, s54, 1
    s_add_u32 s60, s60, s64
    v_lshrrev_b32 v30, 3, v1
    v_add_u32 v30, s60, v30
    v_and_b32 v109, 1, v30
    v_lshlrev_b32 v109, 2, v109
    v_lshlrev_b32 v30, 8, v30
    v_xor_b32 v109, v109, v1
    v_and_b32 v109, 7, v109
    v_lshl_add_u32 v30, v109, 4, v30
    v_mul_u32_u24 v109, 9216, v2
    v_add_u32 v30, v30, v109
    v_mul_f32 v109, v104, v105
    v_mul_f32 v104, v104, v104
    v_fma_f32 v104, -v105, v105, v104
    v_add_f32 v105, v109, v109
    v_mul_f32 v109, v104, v105
    v_mul_f32 v104, v104, v104
    v_fma_f32 v104, -v105, v105, v104
    v_add_f32 v105, v109, v109
    buffer_load_dwordx4 v[56:59], v106, s[8:11], 0 offen offset:0 sc1
    buffer_load_dwordx4 v[60:63], v106, s[8:11], 0 offen offset:1152 sc1
    buffer_load_dwordx4 v[64:67], v106, s[8:11], 0 offen offset:2304 sc1
    buffer_load_dwordx4 v[68:71], v106, s[8:11], 0 offen offset:3456 sc1
    buffer_load_dwordx4 v[72:75], v107, s[8:11], 0 offen offset:0 sc1
    buffer_load_dwordx4 v[76:79], v107, s[8:11], 0 offen offset:1152 sc1
    buffer_load_dwordx4 v[80:83], v107, s[8:11], 0 offen offset:2304 sc1
    buffer_load_dwordx4 v[84:87], v107, s[8:11], 0 offen offset:3456 sc1
    s_mov_b32 s77, 400000
    s_branch pchk_lbm_36
poll_lbm_34:
    buffer_load_dwordx4 v[56:59], v106, s[8:11], 0 offen offset:0 sc1
    buffer_load_dwordx4 v[60:63], v106, s[8:11], 0 offen offset:1152 sc1
    buffer_load_dwordx4 v[64:67], v106, s[8:11], 0 offen offset:2304 sc1
    buffer_load_dwordx4 v[68:71], v106, s[8:11], 0 offen offset:3456 sc1
    buffer_load_dwordx4 v[72:75], v107, s[8:11], 0 offen offset:0 sc1
    buffer_load_dwordx4 v[76:79], v107, s[8:11], 0 offen offset:1152 sc1
    buffer_load_dwordx4 v[80:83], v107, s[8:11], 0 offen offset:2304 sc1
    buffer_load_dwordx4 v[84:87], v107, s[8:11], 0 offen offset:3456 sc1
pchk_lbm_36:
    s_waitcnt vmcnt(0)
    v_add_u32 v109, v57, v59
    v_add3_u32 v109, v61, v63, v109
    v_add3_u32 v109, v65, v67, v109
    v_add3_u32 v109, v69, v71, v109
    v_add3_u32 v109, v73, v75, v109
    v_add3_u32 v109, v77, v79, v109
    v_add3_u32 v109, v81, v83, v109
    v_add3_u32 v109, v85, v87, v109
    v_cmp_ne_u32 vcc, v109, v108
    s_cbranch_vccz pout_lbm_35
    s_mov_b64 exec, vcc
    s_sleep 3
    s_sub_u32 s77, s77, 1
    s_cmp_lg_u32 s77, 0
    s_cbranch_scc1 poll_lbm_34
pout_lbm_35:
    s_mov_b64 exec, -1
    v_mov_b32 v85, v86
    v_fmac_f32 v80, v84, v18
    v_fma_f32 v81, v85, v18, v82
    v_pk_fma_f32 v[80:81], v[84:85], v[18:19], v[80:81] op_sel:[1,1,0] op_sel_hi:[0,1,1] neg_lo:[1,0,0]
    v_fmac_f32 v76, v80, v18
    v_fma_f32 v77, v81, v18, v78
    v_pk_fma_f32 v[76:77], v[80:81], v[18:19], v[76:77] op_sel:[1,1,0] op_sel_hi:[0,1,1] neg_lo:[1,0,0]
    v_fmac_f32 v72, v76, v18
    v_fma_f32 v73, v77, v18, v74
    v_pk_fma_f32 v[72:73], v[76:77], v[18:19], v[72:73] op_sel:[1,1,0] op_sel_hi:[0,1,1] neg_lo:[1,0,0]
    v_fmac_f32 v68, v72, v18
    v_fma_f32 v69, v73, v18, v70
    v_pk_fma_f32 v[68:69], v[72:73], v[18:19], v[68:69] op_sel:[1,1,0] op_sel_hi:[0,1,1] neg_lo:[1,0,0]
    v_fmac_f32 v64, v68, v18
    v_fma_f32 v65, v69, v18, v66
    v_pk_fma_f32 v[64:65], v[68:69], v[18:19], v[64:65] op_sel:[1,1,0] op_sel_hi:[0,1,1] neg_lo:[1,0,0]
    v_fmac_f32 v60, v64, v18
    v_fma_f32 v61, v65, v18, v62
    v_pk_fma_f32 v[60:61], v[64:65], v[18:19], v[60:61] op_sel:[1,1,0] op_sel_hi:[0,1,1] neg_lo:[1,0,0]
    v_fmac_f32 v56, v60, v18
    v_fma_f32 v57, v61, v18, v58
    v_pk_fma_f32 v[56:57], v[60:61], v[18:19], v[56:57] op_sel:[1,1,0] op_sel_hi:[0,1,1] neg_lo:[1,0,0]
    v_pk_mul_f32 v[60:61], v[56:57], v[20:21] op_sel:[0,0] op_sel_hi:[1,0]
    v_pk_fma_f32 v[60:61], v[56:57], v[20:21], v[60:61] op_sel:[1,1,0] op_sel_hi:[0,1,1] neg_lo:[1,0,0]
    v_mov_b64 v[62:63], v[60:61]
    s_nop 1
    v_permlane32_swap_b32 v60, v62
    v_permlane32_swap_b32 v61, v63
    v_pk_add_f32 v[60:61], v[60:61], v[62:63]
    v_mov_b64 v[62:63], v[60:61]
    s_nop 1
    v_permlane16_swap_b32 v60, v62
    v_permlane16_swap_b32 v61, v63
    v_pk_add_f32 v[60:61], v[60:61], v[62:63]
    v_pk_fma_f32 v[110:111], v[60:61], v[16:17], v[110:111] op_sel:[0,0,0] op_sel_hi:[1,0,1]
    v_pk_fma_f32 v[110:111], v[60:61], v[16:17], v[110:111] op_sel:[1,1,0] op_sel_hi:[0,1,1] neg_lo:[1,0,0]
    v_pk_mul_f32 v[72:73], v[110:111], v[104:105] op_sel:[0,0] op_sel_hi:[1,0]
    v_pk_fma_f32 v[72:73], v[110:111], v[104:105], v[72:73] op_sel:[1,1,0] op_sel_hi:[0,1,1] neg_lo:[1,0,0]
    v_pk_fma_f32 v[22:23], v[88:89], v[110:111], v[22:23] op_sel:[0,0,0] op_sel_hi:[1,0,1]
    v_pk_fma_f32 v[22:23], v[88:89], v[110:111], v[22:23] op_sel:[1,1,0] op_sel_hi:[0,1,1] neg_lo:[1,0,0]
    v_pk_fma_f32 v[24:25], v[90:91], v[110:111], v[24:25] op_sel:[0,0,0] op_sel_hi:[1,0,1]
    v_pk_fma_f32 v[24:25], v[90:91], v[110:111], v[24:25] op_sel:[1,1,0] op_sel_hi:[0,1,1] neg_lo:[1,0,0]
    v_pk_fma_f32 v[26:27], v[92:93], v[110:111], v[26:27] op_sel:[0,0,0] op_sel_hi:[1,0,1]
    v_pk_fma_f32 v[26:27], v[92:93], v[110:111], v[26:27] op_sel:[1,1,0] op_sel_hi:[0,1,1] neg_lo:[1,0,0]
    v_pk_fma_f32 v[28:29], v[94:95], v[110:111], v[28:29] op_sel:[0,0,0] op_sel_hi:[1,0,1]
    v_pk_fma_f32 v[28:29], v[94:95], v[110:111], v[28:29] op_sel:[1,1,0] op_sel_hi:[0,1,1] neg_lo:[1,0,0]
    v_pk_fma_f32 v[32:33], v[96:97], v[110:111], v[32:33] op_sel:[0,0,0] op_sel_hi:[1,0,1]
    v_pk_fma_f32 v[32:33], v[96:97], v[110:111], v[32:33] op_sel:[1,1,0] op_sel_hi:[0,1,1] neg_lo:[1,0,0]
    v_pk_fma_f32 v[34:35], v[98:99], v[110:111], v[34:35] op_sel:[0,0,0] op_sel_hi:[1,0,1]
    v_pk_fma_f32 v[34:35], v[98:99], v[110:111], v[34:35] op_sel:[1,1,0] op_sel_hi:[0,1,1] neg_lo:[1,0,0]
    v_pk_fma_f32 v[36:37], v[100:101], v[110:111], v[36:37] op_sel:[0,0,0] op_sel_hi:[1,0,1]
    v_pk_fma_f32 v[36:37], v[100:101], v[110:111], v[36:37] op_sel:[1,1,0] op_sel_hi:[0,1,1] neg_lo:[1,0,0]
    v_pk_fma_f32 v[38:39], v[102:103], v[110:111], v[38:39] op_sel:[0,0,0] op_sel_hi:[1,0,1]
    v_pk_fma_f32 v[38:39], v[102:103], v[110:111], v[38:39] op_sel:[1,1,0] op_sel_hi:[0,1,1] neg_lo:[1,0,0]
    v_cvt_pk_bf16_f32 v56, v22, v24
    v_cvt_pk_bf16_f32 v57, v26, v28
    v_cvt_pk_bf16_f32 v58, v32, v34
    v_cvt_pk_bf16_f32 v59, v36, v38
    v_cvt_pk_bf16_f32 v60, -v23, -v25
    v_cvt_pk_bf16_f32 v61, -v27, -v29
    v_cvt_pk_bf16_f32 v62, -v33, -v35
    v_cvt_pk_bf16_f32 v63, -v37, -v39
    buffer_store_dwordx4 v[56:59], v30, s[4:7], s62 offen offset:0 sc1
    buffer_store_dwordx4 v[60:63], v30, s[4:7], s63 offen offset:0 sc1
    v_pk_fma_f32 v[40:41], v[88:89], v[72:73], v[40:41] op_sel:[0,0,0] op_sel_hi:[1,0,1]
    v_pk_fma_f32 v[40:41], v[88:89], v[72:73], v[40:41] op_sel:[1,1,0] op_sel_hi:[0,1,1] neg_lo:[1,0,0]
    v_pk_fma_f32 v[42:43], v[90:91], v[72:73], v[42:43] op_sel:[0,0,0] op_sel_hi:[1,0,1]
    v_pk_fma_f32 v[42:43], v[90:91], v[72:73], v[42:43] op_sel:[1,1,0] op_sel_hi:[0,1,1] neg_lo:[1,0,0]
    v_pk_fma_f32 v[44:45], v[92:93], v[72:73], v[44:45] op_sel:[0,0,0] op_sel_hi:[1,0,1]
    v_pk_fma_f32 v[44:45], v[92:93], v[72:73], v[44:45] op_sel:[1,1,0] op_sel_hi:[0,1,1] neg_lo:[1,0,0]
    v_pk_fma_f32 v[46:47], v[94:95], v[72:73], v[46:47] op_sel:[0,0,0] op_sel_hi:[1,0,1]
    v_pk_fma_f32 v[46:47], v[94:95], v[72:73], v[46:47] op_sel:[1,1,0] op_sel_hi:[0,1,1] neg_lo:[1,0,0]
    v_pk_fma_f32 v[48:49], v[96:97], v[72:73], v[48:49] op_sel:[0,0,0] op_sel_hi:[1,0,1]
    v_pk_fma_f32 v[48:49], v[96:97], v[72:73], v[48:49] op_sel:[1,1,0] op_sel_hi:[0,1,1] neg_lo:[1,0,0]
    v_pk_fma_f32 v[50:51], v[98:99], v[72:73], v[50:51] op_sel:[0,0,0] op_sel_hi:[1,0,1]
    v_pk_fma_f32 v[50:51], v[98:99], v[72:73], v[50:51] op_sel:[1,1,0] op_sel_hi:[0,1,1] neg_lo:[1,0,0]
    v_pk_fma_f32 v[52:53], v[100:101], v[72:73], v[52:53] op_sel:[0,0,0] op_sel_hi:[1,0,1]
    v_pk_fma_f32 v[52:53], v[100:101], v[72:73], v[52:53] op_sel:[1,1,0] op_sel_hi:[0,1,1] neg_lo:[1,0,0]
    v_pk_fma_f32 v[54:55], v[102:103], v[72:73], v[54:55] op_sel:[0,0,0] op_sel_hi:[1,0,1]
    v_pk_fma_f32 v[54:55], v[102:103], v[72:73], v[54:55] op_sel:[1,1,0] op_sel_hi:[0,1,1] neg_lo:[1,0,0]
    v_cvt_pk_bf16_f32 v64, v40, v42
    v_cvt_pk_bf16_f32 v65, v44, v46
    v_cvt_pk_bf16_f32 v66, v48, v50
    v_cvt_pk_bf16_f32 v67, v52, v54
    v_cvt_pk_bf16_f32 v68, -v41, -v43
    v_cvt_pk_bf16_f32 v69, -v45, -v47
    v_cvt_pk_bf16_f32 v70, -v49, -v51
    v_cvt_pk_bf16_f32 v71, -v53, -v55
    buffer_store_dwordx4 v[64:67], v30, s[4:7], s62 offen offset:128 sc1
    buffer_store_dwordx4 v[68:71], v30, s[4:7], s63 offen offset:128 sc1
    s_waitcnt vmcnt(0)
    v_mov_b32 v100, 1
    s_mov_b64 exec, 1
    ds_add_rtn_u32 v100, v5, v100 offset:40
    v_mov_b32 v102, s55
    v_mov_b32 v103, 0
    s_waitcnt lgkmcnt(0)
    v_cmp_eq_u32 vcc, 4, v100
    s_cbranch_vccz nf_37
    s_cmp_eq_u32 s30, 0
    s_cbranch_scc1 ssl_38
    buffer_store_dword v102, v103, s[4:7], s1 offen
    s_branch ssj_39
ssl_38:
    buffer_store_dword v102, v103, s[4:7], s1 offen sc1
ssj_39:
nf_37:
    s_mov_b64 exec, -1
L_mpost:
    s_setprio 1
    s_mul_i32 s64, s54, 36864
    s_add_u32 s64, s64, s57
    s_add_u32 s60, s54, 1
    s_and_b32 s60, s60, 3
    s_mul_i32 s60, s60, 9216
    s_add_u32 s68, s60, s64
    s_add_u32 s60, s54, 2
    s_and_b32 s60, s60, 3
    s_mul_i32 s60, s60, 9216
    s_add_u32 s69, s60, s64
    s_add_u32 s60, s54, 3
    s_and_b32 s60, s60, 3
    s_mul_i32 s60, s60, 9216
    s_add_u32 s70, s60, s64
    s_add_u32 s60, s54, 4
    s_and_b32 s60, s60, 3
    s_mul_i32 s60, s60, 9216
    s_add_u32 s71, s60, s64
    s_cmp_lg_u32 s54, 0
    s_cbranch_scc1 fw_40
    v_and_b32 v100, 7, v0
    v_lshlrev_b32 v100, 2, v100
    s_mov_b32 s77, 400000
poll_hf_41:
    buffer_load_dword v101, v100, s[4:7], s35 offen sc1
pchk_hf_43:
    s_waitcnt vmcnt(0)
    v_cmp_ne_u32 vcc, s55, v101
    s_cbranch_vccz pout_hf_42
    s_sub_u32 s77, s77, 1
    s_cmp_lg_u32 s77, 0
    s_cbranch_scc1 poll_hf_41
pout_hf_42:
fw_40:
    s_barrier
    s_add_u32 m0, s59, 0
    s_nop 0
    buffer_load_dwordx4 v3, s[4:7], s68 offen offset:0 sc1 lds
    buffer_load_dwordx4 v3, s[4:7], s68 offen offset:1024 sc1 lds
    buffer_load_dwordx4 v3, s[4:7], s68 offen offset:2048 sc1 lds
    s_add_u32 m0, s59, 3072
    s_add_u32 s68, s68, 3072
    buffer_load_dwordx4 v3, s[4:7], s68 offen offset:0 sc1 lds
    buffer_load_dwordx4 v3, s[4:7], s68 offen offset:1024 sc1 lds
    buffer_load_dwordx4 v3, s[4:7], s68 offen offset:2048 sc1 lds
    s_add_u32 m0, s59, 6144
    s_add_u32 s68, s68, 3072
    buffer_load_dwordx4 v3, s[4:7], s68 offen offset:0 sc1 lds
    buffer_load_dwordx4 v3, s[4:7], s68 offen offset:1024 sc1 lds
    buffer_load_dwordx4 v3, s[4:7], s68 offen offset:2048 sc1 lds
    s_add_u32 m0, s59, 18432
    s_nop 0
    buffer_load_dwordx4 v3, s[4:7], s69 offen offset:0 sc1 lds
    buffer_load_dwordx4 v3, s[4:7], s69 offen offset:1024 sc1 lds
    buffer_load_dwordx4 v3, s[4:7], s69 offen offset:2048 sc1 lds
    s_waitcnt vmcnt(9)
    s_barrier
    s_add_u32 m0, s59, 21504
    s_add_u32 s69, s69, 3072
    buffer_load_dwordx4 v3, s[4:7], s69 offen offset:0 sc1 lds
    buffer_load_dwordx4 v3, s[4:7], s69 offen offset:1024 sc1 lds
    buffer_load_dwordx4 v3, s[4:7], s69 offen offset:2048 sc1 lds
    s_add_u32 m0, s59, 24576
    s_add_u32 s69, s69, 3072
    buffer_load_dwordx4 v3, s[4:7], s69 offen offset:0 sc1 lds
    buffer_load_dwordx4 v3, s[4:7], s69 offen offset:1024 sc1 lds
    buffer_load_dwordx4 v3, s[4:7], s69 offen offset:2048 sc1 lds
    s_waitcnt vmcnt(9)
    s_barrier
    s_add_u32 m0, s59, 9216
    s_nop 0
    buffer_load_dwordx4 v3, s[4:7], s70 offen offset:0 sc1 lds
    buffer_load_dwordx4 v3, s[4:7], s70 offen offset:1024 sc1 lds
    buffer_load_dwordx4 v3, s[4:7], s70 offen offset:2048 sc1 lds
    s_add_u32 m0, s59, 12288
    s_add_u32 s70, s70, 3072
    buffer_load_dwordx4 v3, s[4:7], s70 offen offset:0 sc1 lds
    buffer_load_dwordx4 v3, s[4:7], s70 offen offset:1024 sc1 lds
    buffer_load_dwordx4 v3, s[4:7], s70 offen offset:2048 sc1 lds
    s_add_u32 m0, s59, 15360
    s_add_u32 s70, s70, 3072
    buffer_load_dwordx4 v3, s[4:7], s70 offen offset:0 sc1 lds
    buffer_load_dwordx4 v3, s[4:7], s70 offen offset:1024 sc1 lds
    buffer_load_dwordx4 v3, s[4:7], s70 offen offset:2048 sc1 lds
    s_waitcnt vmcnt(9)
    s_barrier
    s_add_u32 m0, s59, 0
    s_nop 0
    buffer_load_dwordx4 v3, s[4:7], s71 offen offset:0 sc1 lds
    buffer_load_dwordx4 v3, s[4:7], s71 offen offset:1024 sc1 lds
    buffer_load_dwordx4 v3, s[4:7], s71 offen offset:2048 sc1 lds
    s_add_u32 m0, s59, 3072
    s_add_u32 s71, s71, 3072
    buffer_load_dwordx4 v3, s[4:7], s71 offen offset:0 sc1 lds
    buffer_load_dwordx4 v3, s[4:7], s71 offen offset:1024 sc1 lds
    buffer_load_dwordx4 v3, s[4:7], s71 offen offset:2048 sc1 lds
    s_add_u32 m0, s59, 6144
    s_add_u32 s71, s71, 3072
    buffer_load_dwordx4 v3, s[4:7], s71 offen offset:0 sc1 lds
    s_waitcnt vmcnt(7)
    s_barrier
    buffer_load_dwordx4 v3, s[4:7], s71 offen offset:1024 sc1 lds
    buffer_load_dwordx4 v3, s[4:7], s71 offen offset:2048 sc1 lds
    s_mul_i32 s61, s56, 524288
    s_add_u32 s61, s61, 262144
    s_add_u32 s61, s61, s58
    v_lshlrev_b32 v106, 7, v1
    buffer_load_dword v107, v106, s[4:7], s61 offen sc1
    s_lshl_b32 s61, s52, 7
    s_add_u32 s61, s61, 22036480
    v_mov_b32 v106, 0
    buffer_load_dword v107, v106, s[4:7], s61 offen sc1
    s_add_u32 s61, s35, 4096
    buffer_load_dword v107, v106, s[4:7], s61 offen sc1
    v_lshrrev_b32 v104, 1, v0
    v_lshlrev_b32 v104, 12, v104
    v_and_b32 v105, 1, v0
    v_lshl_add_u32 v104, v105, 4, v104
    s_mul_i32 s62, s49, 294912
    s_lshl_b32 s61, s52, 7
    s_add_u32 s62, s62, s61
    s_lshl_b32 s61, s54, 5
    s_add_u32 s62, s62, s61
    s_add_u32 s62, s62, 16777216
    s_lshl_b32 s63, s49, 9
    s_add_u32 s63, s63, 22061056
    v_min_u32 v100, 35, v0
    v_lshlrev_b32 v101, 3, v100
    s_waitcnt vmcnt(3)
    s_barrier
    s_cmp_eq_u32 s56, 0
    s_cbranch_scc1 L_gl0
    s_add_u32 m0, s59, 14336
    s_add_u32 s61, s62, 0
    buffer_load_dwordx4 v104, s[4:7], s61 offen sc1 lds
    s_add_u32 m0, s59, 15360
    s_add_u32 s61, s62, 131072
    buffer_load_dwordx4 v104, s[4:7], s61 offen sc1 lds
    s_mov_b64 exec, 0xffff
    s_add_u32 m0, s59, 16384
    s_add_u32 s61, s62, 262144
    buffer_load_dwordx4 v104, s[4:7], s61 offen sc1 lds
    s_mov_b64 exec, -1
    s_branch L_gl1
L_gl0:
    s_cmp_lg_u32 s54, 0
    s_cbranch_scc1 L_gl1
    buffer_load_dwordx2 v[102:103], v101, s[4:7], s63 offen sc1
L_gl1:
    s_xor_b32 s60, s52, 31
    s_or_b32 s60, s60, s53
    s_or_b32 s60, s60, s54
    s_or_b32 s60, s60, s56
    s_cmp_lg_u32 s60, 0
    s_cbranch_scc1 bump_44
    s_mov_b32 s60, 22069248
    v_mov_b32 v108, s55
    v_mov_b32 v109, 0
    s_mov_b64 exec, 1
    buffer_store_dword v108, v109, s[4:7], s60 offen sc1
    s_mov_b64 exec, -1
bump_44:
    s_barrier
    s_or_b32 s60, s54, s56
    s_cmp_lg_u32 s60, 0
    s_cbranch_scc1 L_gl2
    s_mov_b32 s77, 400000
    s_branch pchk_yf_47
poll_yf_45:
    buffer_load_dwordx2 v[102:103], v101, s[4:7], s63 offen sc1
pchk_yf_47:
    s_waitcnt vmcnt(0)
    v_bitop3_b32 v102, v102, v103, s55 bitop3:0x7e
    v_cmp_ne_u32 vcc, 0, v102
    s_cbranch_vccz pout_yf_46
    s_sleep 2
    s_sub_u32 s77, s77, 1
    s_cmp_lg_u32 s77, 0
    s_cbranch_scc1 poll_yf_45
pout_yf_46:
    s_mov_b32 s64, 0
    s_add_u32 s60, s62, 0
    s_add_u32 m0, s64, 14336
    s_add_u32 s61, s60, 0
    buffer_load_dwordx4 v104, s[4:7], s61 offen sc1 lds
    s_add_u32 m0, s64, 15360
    s_add_u32 s61, s60, 131072
    buffer_load_dwordx4 v104, s[4:7], s61 offen sc1 lds
    s_mov_b64 exec, 0xffff
    s_add_u32 m0, s64, 16384
    s_add_u32 s61, s60, 262144
    buffer_load_dwordx4 v104, s[4:7], s61 offen sc1 lds
    s_mov_b64 exec, -1
    s_mov_b32 s64, 28672
    s_add_u32 s60, s62, 32
    s_add_u32 m0, s64, 14336
    s_add_u32 s61, s60, 0
    buffer_load_dwordx4 v104, s[4:7], s61 offen sc1 lds
    s_add_u32 m0, s64, 15360
    s_add_u32 s61, s60, 131072
    buffer_load_dwordx4 v104, s[4:7], s61 offen sc1 lds
    s_mov_b64 exec, 0xffff
    s_add_u32 m0, s64, 16384
    s_add_u32 s61, s60, 262144
    buffer_load_dwordx4 v104, s[4:7], s61 offen sc1 lds
    s_mov_b64 exec, -1
    s_mov_b32 s64, 57344
    s_add_u32 s60, s62, 64
    s_add_u32 m0, s64, 14336
    s_add_u32 s61, s60, 0
    buffer_load_dwordx4 v104, s[4:7], s61 offen sc1 lds
    s_add_u32 m0, s64, 15360
    s_add_u32 s61, s60, 131072
    buffer_load_dwordx4 v104, s[4:7], s61 offen sc1 lds
    s_mov_b64 exec, 0xffff
    s_add_u32 m0, s64, 16384
    s_add_u32 s61, s60, 262144
    buffer_load_dwordx4 v104, s[4:7], s61 offen sc1 lds
    s_mov_b64 exec, -1
    s_mov_b32 s64, 86016
    s_add_u32 s60, s62, 96
    s_add_u32 m0, s64, 14336
    s_add_u32 s61, s60, 0
    buffer_load_dwordx4 v104, s[4:7], s61 offen sc1 lds
    s_add_u32 m0, s64, 15360
    s_add_u32 s61, s60, 131072
    buffer_load_dwordx4 v104, s[4:7], s61 offen sc1 lds
    s_mov_b64 exec, 0xffff
    s_add_u32 m0, s64, 16384
    s_add_u32 s61, s60, 262144
    buffer_load_dwordx4 v104, s[4:7], s61 offen sc1 lds
    s_mov_b64 exec, -1
L_gl2:
    s_waitcnt vmcnt(0)
    s_barrier
    s_cmp_lg_u32 s56, 0
    s_cbranch_scc1 L_fin
    s_mov_b32 s56, 1
    v_add_u32 v5, 4, v5
    s_setprio 2
    s_branch L_mg1b
L_X:
    s_mov_b32 s53, s63
    s_setprio 2
    v_lshrrev_b32 v30, 3, v0
    v_mul_u32_u24 v27, 1152, v102
    v_add_u32 v27, v27, v103
    s_mul_i32 s60, s52, 73728
    s_mul_i32 s61, s53, 144
    s_add_u32 s60, s60, s61
    s_lshl_b32 s61, s54, 6
    s_lshl_b32 s62, s54, 10
    s_mov_b32 s8, s36
    s_mov_b32 s9, s37
    s_mov_b32 s10, 2359296
    s_mov_b32 s11, 0x20000
    s_mov_b32 s12, s38
    s_mov_b32 s13, s39
    s_mov_b32 s14, 2359296
    s_mov_b32 s15, 0x20000
    s_cmp_ge_u32 s54, 2
    s_cbranch_scc1 L_p0s
    v_add_u32 v40, s61, v0
    v_add_u32 v40, 512, v40
    v_mul_u32_u24 v41, 898, v40
    v_lshrrev_b32 v41, 16, v41
    v_mul_u32_u24 v42, 73, v41
    v_sub_u32 v42, v40, v42
    v_mul_u32_u24 v43, 57, v42
    v_lshrrev_b32 v43, 9, v43
    v_mul_u32_u24 v40, 9, v43
    v_sub_u32 v42, v42, v40
    v_lshl_add_u32 v43, v41, 3, v43
    v_mul_u32_u24 v43, 1152, v43
    v_lshl_add_u32 v43, v42, 4, v43
    v_add_u32 v34, s60, v43
    v_subrev_u32 v37, 3456, v34
    s_add_u32 m0, s62, 61440
    s_nop 0
    buffer_load_dwordx4 v37, s[8:11], 0 offen lds
    s_add_u32 m0, s62, 71680
    s_nop 0
    buffer_load_dwordx4 v34, s[12:15], 0 offen lds
L_p0s:
    v_add_u32 v40, s61, v0
    v_mul_u32_u24 v41, 898, v40
    v_lshrrev_b32 v41, 16, v41
    v_mul_u32_u24 v42, 73, v41
    v_sub_u32 v42, v40, v42
    v_mul_u32_u24 v43, 57, v42
    v_lshrrev_b32 v43, 9, v43
    v_mul_u32_u24 v40, 9, v43
    v_sub_u32 v42, v42, v40
    v_lshl_add_u32 v43, v41, 3, v43
    v_mul_u32_u24 v43, 1152, v43
    v_lshl_add_u32 v43, v42, 4, v43
    v_add_u32 v32, s60, v43
    v_subrev_u32 v35, 3456, v32
    s_add_u32 m0, s62, 53248
    s_nop 0
    buffer_load_dwordx4 v35, s[8:11], 0 offen lds
    s_add_u32 m0, s62, 63488
    s_nop 0
    buffer_load_dwordx4 v32, s[12:15], 0 offen lds
    v_add_u32 v40, s61, v0
    v_add_u32 v40, 256, v40
    v_mul_u32_u24 v41, 898, v40
    v_lshrrev_b32 v41, 16, v41
    v_mul_u32_u24 v42, 73, v41
    v_sub_u32 v42, v40, v42
    v_mul_u32_u24 v43, 57, v42
    v_lshrrev_b32 v43, 9, v43
    v_mul_u32_u24 v40, 9, v43
    v_sub_u32 v42, v42, v40
    v_lshl_add_u32 v43, v41, 3, v43
    v_mul_u32_u24 v43, 1152, v43
    v_lshl_add_u32 v43, v42, 4, v43
    v_add_u32 v33, s60, v43
    v_subrev_u32 v36, 3456, v33
    s_add_u32 m0, s62, 57344
    s_nop 0
    buffer_load_dwordx4 v36, s[8:11], 0 offen lds
    s_add_u32 m0, s62, 67584
    s_nop 0
    buffer_load_dwordx4 v33, s[12:15], 0 offen lds
    s_mul_i32 s60, s53, 72
    s_lshl_b32 s61, s54, 3
    s_add_u32 s61, s61, s60
    v_add_lshl_u32 v100, v30, s61, 3
    global_load_dwordx2 v[12:13], v100, s[40:41]
    global_load_dwordx2 v[14:15], v100, s[40:41] offset:256
    s_add_u32 s61, s60, 64
    v_add_lshl_u32 v100, v30, s61, 3
    global_load_dwordx2 v[16:17], v100, s[40:41]
    s_mul_i32 s61, s2, 72
    s_add_u32 s61, s61, 64
    v_and_b32 v100, 7, v0
    v_add_lshl_u32 v100, v100, s61, 1
    global_load_ushort v104, v100, s[18:19]
    global_load_ushort v105, v100, s[20:21]
    global_load_ushort v106, v100, s[30:31]
    s_add_u32 s49, s52, 0
    s_and_b32 s49, s49, 31
    s_mul_i32 s60, s53, 72
    s_mul_i32 s61, s49, 3
    s_add_u32 s60, s60, s61
    s_add_u32 s60, s60, s54
    s_min_u32 s60, s60, 575
    s_lshl_b32 s67, s60, 12
    s_lshl_b32 s60, s60, 1
    v_mov_b32 v100, s60
    global_load_ushort v107, v100, s[44:45]
    s_cmp_lt_u32 s49, 24
    s_cselect_b32 s66, 1, 0
    s_cmp_lt_u32 s54, 3
    s_cselect_b32 s66, s66, 0
    s_cmp_lt_u32 s54, 2
    s_cselect_b32 s72, s26, s28
    s_cselect_b32 s73, s27, s29
    s_mov_b32 s74, 663552
    s_mov_b32 s75, 0x20000
    s_barrier
    s_and_b32 s60, s54, 1
    s_mul_i32 s60, s60, 576
    s_mul_i32 s65, s53, 82944
    s_add_u32 s65, s65, s60
    s_mul_i32 s0, s54, 4608
    s_add_u32 s0, s0, 114688
    s_lshl_b32 s39, s54, 13
    s_add_u32 s39, s39, 73728
    s_mul_i32 s36, s54, 13312
    s_add_u32 s36, s36, 0
    s_and_b32 s37, s52, 3
    s_mov_b32 s12, s42
    s_mov_b32 s13, s43
    s_mov_b32 s14, 2359296
    s_mov_b32 s15, 0x20000
    s_mul_i32 s40, s53, 294912
    s_lshl_b32 s62, s52, 7
    s_sub_u32 s40, s40, s62
    s_add_u32 s40, s40, 13635456
    s_lshl_b32 s60, s53, 7
    s_lshl_b32 s61, s52, 2
    s_add_u32 s60, s60, s61
    s_add_u32 s41, s60, 22052864
    s_cmp_eq_u32 s66, 0
    s_cselect_b32 s60, -8192, s67
    buffer_load_dwordx4 a[96:99], v3, s[12:15], s60 offen offset:0
    buffer_load_dwordx4 a[100:103], v3, s[12:15], s60 offen offset:1024
    buffer_load_dwordx4 a[104:107], v3, s[12:15], s60 offen offset:2048
    buffer_load_dwordx4 a[108:111], v3, s[12:15], s60 offen offset:3072
    s_lshl_b32 s60, s52, 7
    s_add_u32 s60, s60, 22020096
    v_mov_b32 v110, 0
    buffer_load_dword v111, v110, s[4:7], s60 offen sc1
    s_waitcnt vmcnt(9)
    v_mov_b32 v34, 1
    s_mov_b64 exec, 1
    ds_add_u32 v5, v34 offset:16
    s_mov_b64 exec, -1
    v_readfirstlane_b32 s55, v109
    s_lshl_b32 s62, s54, 3
    s_add_u32 s55, s55, 1
    s_cmp_lg_u32 s54, 3
    s_cbranch_scc1 L_nxc
    s_getreg_b32 s31, hwreg(HW_REG_XCC_ID)
    s_and_b32 s31, s31, 15
    s_lshl_b32 s60, s52, 7
    s_lshl_b32 s61, s53, 3
    s_add_u32 s60, s60, s61
    s_add_u32 s60, s60, 22077440
    v_mov_b32 v92, s55
    v_mov_b32 v93, s31
    v_mov_b32 v94, 0
    s_mov_b64 exec, 1
    buffer_store_dwordx2 v[92:93], v94, s[4:7], s60 offen sc1
    s_mov_b64 exec, -1
L_nxc:
    s_mov_b32 s77, 3200000
cw_48:
    ds_read_b32 v34, v5 offset:16
    s_waitcnt lgkmcnt(0)
    v_cmp_gt_u32 vcc, 4, v34
    s_cbranch_vccz cwo_49
    s_sub_u32 s77, s77, 1
    s_cmp_lg_u32 s77, 0
    s_cbranch_scc1 cw_48
cwo_49:
L_kvr:
    v_add_u32 v7, s62, v30
    v_and_b32 v8, 7, v0
    v_mul_u32_u24 v6, 1168, v8
    v_lshrrev_b32 v9, 1, v7
    v_lshl_add_u32 v6, v9, 2, v6
    v_add_u32 v6, 53248, v6
    ds_read_b32 v32, v6 offset:0
    ds_read_b32 v33, v6 offset:144
    ds_read_b32 v34, v6 offset:288
    ds_read_b32 v35, v6 offset:432
    ds_read_b32 v36, v6 offset:576
    ds_read_b32 v37, v6 offset:720
    ds_read_b32 v38, v6 offset:864
    ds_read_b32 v39, v6 offset:1008
    ds_read_b32 v40, v6 offset:1168
    ds_read_b32 v41, v6 offset:1312
    ds_read_b32 v42, v6 offset:1456
    ds_read_b32 v44, v6 offset:10240
    ds_read_b32 v45, v6 offset:10384
    ds_read_b32 v46, v6 offset:10528
    ds_read_b32 v47, v6 offset:10672
    ds_read_b32 v48, v6 offset:10816
    ds_read_b32 v49, v6 offset:10960
    ds_read_b32 v50, v6 offset:11104
    ds_read_b32 v51, v6 offset:11248
    v_and_b32 v10, 1, v7
    v_lshlrev_b32 v10, 4, v10
    v_and_b32 v52, 0xffff, v12
    v_lshrrev_b32 v53, 16, v12
    v_and_b32 v54, 0xffff, v13
    v_lshrrev_b32 v55, 16, v13
    v_lshlrev_b32 v52, v10, v52
    v_lshlrev_b32 v53, v10, v53
    v_lshlrev_b32 v54, v10, v54
    v_lshlrev_b32 v55, v10, v55
    v_lshlrev_b32 v7, 12, v7
    v_sub_u32 v8, 7, v8
    v_lshl_add_u32 v7, v8, 4, v7
    s_mov_b32 s61, 0x3f803f80
    s_waitcnt lgkmcnt(8)
    v_dot2_f32_bf16 v56, v32, v55, 0
    v_dot2_f32_bf16 v57, v33, v54, 0
    v_dot2_f32_bf16 v58, v34, v53, 0
    v_dot2_f32_bf16 v59, v35, v52, 0
    v_dot2_f32_bf16 v60, v33, v55, 0
    v_dot2_f32_bf16 v61, v34, v54, 0
    v_dot2_f32_bf16 v62, v35, v53, 0
    v_dot2_f32_bf16 v63, v36, v52, 0
    v_dot2_f32_bf16 v64, v34, v55, 0
    v_dot2_f32_bf16 v65, v35, v54, 0
    v_dot2_f32_bf16 v66, v36, v53, 0
    v_dot2_f32_bf16 v67, v37, v52, 0
    v_dot2_f32_bf16 v68, v35, v55, 0
    v_dot2_f32_bf16 v69, v36, v54, 0
    v_dot2_f32_bf16 v70, v37, v53, 0
    v_dot2_f32_bf16 v71, v38, v52, 0
    v_dot2_f32_bf16 v72, v36, v55, 0
    v_dot2_f32_bf16 v73, v37, v54, 0
    v_dot2_f32_bf16 v74, v38, v53, 0
    v_dot2_f32_bf16 v75, v39, v52, 0
    v_dot2_f32_bf16 v76, v37, v55, 0
    v_dot2_f32_bf16 v77, v38, v54, 0
    v_dot2_f32_bf16 v78, v39, v53, 0
    v_dot2_f32_bf16 v79, v40, v52, 0
    v_dot2_f32_bf16 v80, v38, v55, 0
    v_dot2_f32_bf16 v81, v39, v54, 0
    v_dot2_f32_bf16 v82, v40, v53, 0
    v_dot2_f32_bf16 v83, v41, v52, 0
    v_dot2_f32_bf16 v84, v39, v55, 0
    v_dot2_f32_bf16 v85, v40, v54, 0
    v_dot2_f32_bf16 v86, v41, v53, 0
    v_dot2_f32_bf16 v87, v42, v52, 0
    v_cvt_pk_bf16_f32 v56, v56, v57
    v_cvt_pk_bf16_f32 v60, v60, v61
    v_cvt_pk_bf16_f32 v64, v64, v65
    v_cvt_pk_bf16_f32 v68, v68, v69
    v_cvt_pk_bf16_f32 v72, v72, v73
    v_cvt_pk_bf16_f32 v76, v76, v77
    v_cvt_pk_bf16_f32 v80, v80, v81
    v_cvt_pk_bf16_f32 v84, v84, v85
    v_dot2_f32_bf16 v56, v56, s61, 0
    v_dot2_f32_bf16 v60, v60, s61, 0
    v_dot2_f32_bf16 v64, v64, s61, 0
    v_dot2_f32_bf16 v68, v68, s61, 0
    v_dot2_f32_bf16 v72, v72, s61, 0
    v_dot2_f32_bf16 v76, v76, s61, 0
    v_dot2_f32_bf16 v80, v80, s61, 0
    v_dot2_f32_bf16 v84, v84, s61, 0
    v_cvt_pk_bf16_f32 v56, v56, v58
    v_cvt_pk_bf16_f32 v60, v60, v62
    v_cvt_pk_bf16_f32 v64, v64, v66
    v_cvt_pk_bf16_f32 v68, v68, v70
    v_cvt_pk_bf16_f32 v72, v72, v74
    v_cvt_pk_bf16_f32 v76, v76, v78
    v_cvt_pk_bf16_f32 v80, v80, v82
    v_cvt_pk_bf16_f32 v84, v84, v86
    v_dot2_f32_bf16 v56, v56, s61, 0
    v_dot2_f32_bf16 v60, v60, s61, 0
    v_dot2_f32_bf16 v64, v64, s61, 0
    v_dot2_f32_bf16 v68, v68, s61, 0
    v_dot2_f32_bf16 v72, v72, s61, 0
    v_dot2_f32_bf16 v76, v76, s61, 0
    v_dot2_f32_bf16 v80, v80, s61, 0
    v_dot2_f32_bf16 v84, v84, s61, 0
    v_cvt_pk_bf16_f32 v56, v56, v59
    v_cvt_pk_bf16_f32 v60, v60, v63
    v_cvt_pk_bf16_f32 v64, v64, v67
    v_cvt_pk_bf16_f32 v68, v68, v71
    v_cvt_pk_bf16_f32 v72, v72, v75
    v_cvt_pk_bf16_f32 v76, v76, v79
    v_cvt_pk_bf16_f32 v80, v80, v83
    v_cvt_pk_bf16_f32 v84, v84, v87
    v_dot2_f32_bf16 v56, v56, s61, 0
    v_dot2_f32_bf16 v60, v60, s61, 0
    v_dot2_f32_bf16 v64, v64, s61, 0
    v_dot2_f32_bf16 v68, v68, s61, 0
    v_dot2_f32_bf16 v72, v72, s61, 0
    v_dot2_f32_bf16 v76, v76, s61, 0
    v_dot2_f32_bf16 v80, v80, s61, 0
    v_dot2_f32_bf16 v84, v84, s61, 0
    v_cvt_pk_bf16_f32 v56, v56, 0
    v_cvt_pk_bf16_f32 v60, v60, 0
    v_cvt_pk_bf16_f32 v64, v64, 0
    v_cvt_pk_bf16_f32 v68, v68, 0
    v_cvt_pk_bf16_f32 v72, v72, 0
    v_cvt_pk_bf16_f32 v76, v76, 0
    v_cvt_pk_bf16_f32 v80, v80, 0
    v_cvt_pk_bf16_f32 v84, v84, 0
    v_lshlrev_b32 v56, v10, v56
    v_lshlrev_b32 v60, v10, v60
    v_lshlrev_b32 v64, v10, v64
    v_lshlrev_b32 v68, v10, v68
    v_lshlrev_b32 v72, v10, v72
    v_lshlrev_b32 v76, v10, v76
    v_lshlrev_b32 v80, v10, v80
    v_lshlrev_b32 v84, v10, v84
    s_waitcnt lgkmcnt(0)
    v_dot2_f32_bf16 v56, v56, v44, 0
    v_dot2_f32_bf16 v60, v60, v45, 0
    v_dot2_f32_bf16 v64, v64, v46, 0
    v_dot2_f32_bf16 v68, v68, v47, 0
    v_dot2_f32_bf16 v72, v72, v48, 0
    v_dot2_f32_bf16 v76, v76, v49, 0
    v_dot2_f32_bf16 v80, v80, v50, 0
    v_dot2_f32_bf16 v84, v84, v51, 0
    v_cvt_pk_bf16_f32 v23, v60, v56
    v_cvt_pk_bf16_f32 v22, v68, v64
    v_cvt_pk_bf16_f32 v21, v76, v72
    v_cvt_pk_bf16_f32 v20, v84, v80
    buffer_store_dwordx4 v[20:23], v7, s[4:7], s40 offen sc1
    v_mov_b64 v[12:13], v[14:15]
    v_mov_b64 v[14:15], v[16:17]
    s_add_u32 s62, s62, 32
    s_cmp_lt_u32 s62, 64
    s_cbranch_scc1 L_kvr
    s_cmp_eq_u32 s62, 64
    s_cbranch_scc1 L_kvr
    v_mov_b32 v32, 1
    s_mov_b64 exec, 1
    ds_add_u32 v5, v32 offset:20
    s_mov_b64 exec, -1
    s_cmp_lg_u32 s54, 3
    s_cbranch_scc1 L_kvd
    s_waitcnt vmcnt(6)
    v_lshlrev_b32 v104, 16, v104
    v_lshlrev_b32 v105, 16, v105
    v_lshlrev_b32 v106, 16, v106
    v_mul_f32 v106, 0x3fb8aa3b, v106
    v_exp_f32 v106, v106
    s_nop 0
    v_cvt_pk_bf16_f32 v106, v106, 0
    v_lshlrev_b32 v106, 16, v106
    v_mul_f32 v32, v106, v104
    v_mul_f32 v33, v106, v105
    v_mul_f32 v32, 0x3fb8aa3b, v32
    v_exp_f32 v32, v32
    v_mul_f32 v33, 0.15915494, v33
    v_rndne_f32 v34, v33
    v_sub_f32 v33, v33, v34
    v_cos_f32 v64, v33
    v_sin_f32 v65, v33
    v_mul_f32 v64, v64, v32
    v_mul_f32 v65, v65, v32
    v_subrev_f32 v32, 1.0, v64
    v_mul_f32 v33, v104, v104
    v_fmac_f32 v33, v105, v105
    v_rcp_f32 v33, v33
    s_nop 0
    v_add_f32 v33, v33, v33
    v_mul_f32 v70, v32, v104
    v_fmac_f32 v70, v65, v105
    v_mul_f32 v70, v70, v33
    v_mul_f32 v71, v65, v104
    v_fma_f32 v71, -v32, v105, v71
    v_mul_f32 v71, v71, v33
    v_pk_mul_f32 v[34:35], v[64:65], v[64:65] op_sel:[0,0] op_sel_hi:[1,0]
    v_pk_fma_f32 v[34:35], v[64:65], v[64:65], v[34:35] op_sel:[1,1,0] op_sel_hi:[0,1,1] neg_lo:[1,0,0]
    v_pk_mul_f32 v[36:37], v[34:35], v[34:35] op_sel:[0,0] op_sel_hi:[1,0]
    v_pk_fma_f32 v[36:37], v[34:35], v[34:35], v[36:37] op_sel:[1,1,0] op_sel_hi:[0,1,1] neg_lo:[1,0,0]
    v_pk_mul_f32 v[38:39], v[36:37], v[36:37] op_sel:[0,0] op_sel_hi:[1,0]
    v_pk_fma_f32 v[38:39], v[36:37], v[36:37], v[38:39] op_sel:[1,1,0] op_sel_hi:[0,1,1] neg_lo:[1,0,0]
    v_pk_mul_f32 v[40:41], v[38:39], v[38:39] op_sel:[0,0] op_sel_hi:[1,0]
    v_pk_fma_f32 v[40:41], v[38:39], v[38:39], v[40:41] op_sel:[1,1,0] op_sel_hi:[0,1,1] neg_lo:[1,0,0]
    v_pk_mul_f32 v[42:43], v[40:41], v[40:41] op_sel:[0,0] op_sel_hi:[1,0]
    v_pk_fma_f32 v[42:43], v[40:41], v[40:41], v[42:43] op_sel:[1,1,0] op_sel_hi:[0,1,1] neg_lo:[1,0,0]
    v_pk_mul_f32 v[44:45], v[42:43], v[42:43] op_sel:[0,0] op_sel_hi:[1,0]
    v_pk_fma_f32 v[44:45], v[42:43], v[42:43], v[44:45] op_sel:[1,1,0] op_sel_hi:[0,1,1] neg_lo:[1,0,0]
    v_pk_mul_f32 v[46:47], v[44:45], v[44:45] op_sel:[0,0] op_sel_hi:[1,0]
    v_pk_fma_f32 v[46:47], v[44:45], v[44:45], v[46:47] op_sel:[1,1,0] op_sel_hi:[0,1,1] neg_lo:[1,0,0]
    v_pk_mul_f32 v[48:49], v[46:47], v[46:47] op_sel:[0,0] op_sel_hi:[1,0]
    v_pk_fma_f32 v[48:49], v[46:47], v[46:47], v[48:49] op_sel:[1,1,0] op_sel_hi:[0,1,1] neg_lo:[1,0,0]
    v_pk_mul_f32 v[50:51], v[48:49], v[48:49] op_sel:[0,0] op_sel_hi:[1,0]
    v_pk_fma_f32 v[50:51], v[48:49], v[48:49], v[50:51] op_sel:[1,1,0] op_sel_hi:[0,1,1] neg_lo:[1,0,0]
    v_pk_mul_f32 v[52:53], v[50:51], v[50:51] op_sel:[0,0] op_sel_hi:[1,0]
    v_pk_fma_f32 v[52:53], v[50:51], v[50:51], v[52:53] op_sel:[1,1,0] op_sel_hi:[0,1,1] neg_lo:[1,0,0]
    v_mov_b64 v[72:73], v[38:39]
    v_mov_b64 v[76:77], v[44:45]
    v_mov_b32 v68, 1.0
    v_mov_b32 v69, 0
    v_and_b32 v58, 1, v30
    v_cmp_eq_u32 vcc, 0, v58
    v_pk_mul_f32 v[56:57], v[68:69], v[38:39] op_sel:[0,0] op_sel_hi:[1,0]
    v_pk_fma_f32 v[56:57], v[68:69], v[38:39], v[56:57] op_sel:[1,1,0] op_sel_hi:[0,1,1] neg_lo:[1,0,0]
    v_cndmask_b32 v68, v68, v56, vcc
    v_cndmask_b32 v69, v69, v57, vcc
    v_and_b32 v58, 2, v30
    v_cmp_eq_u32 vcc, 0, v58
    v_pk_mul_f32 v[56:57], v[68:69], v[40:41] op_sel:[0,0] op_sel_hi:[1,0]
    v_pk_fma_f32 v[56:57], v[68:69], v[40:41], v[56:57] op_sel:[1,1,0] op_sel_hi:[0,1,1] neg_lo:[1,0,0]
    v_cndmask_b32 v68, v68, v56, vcc
    v_cndmask_b32 v69, v69, v57, vcc
    v_and_b32 v58, 4, v30
    v_cmp_eq_u32 vcc, 0, v58
    v_pk_mul_f32 v[56:57], v[68:69], v[42:43] op_sel:[0,0] op_sel_hi:[1,0]
    v_pk_fma_f32 v[56:57], v[68:69], v[42:43], v[56:57] op_sel:[1,1,0] op_sel_hi:[0,1,1] neg_lo:[1,0,0]
    v_cndmask_b32 v68, v68, v56, vcc
    v_cndmask_b32 v69, v69, v57, vcc
    v_mov_b32 v74, 1.0
    v_mov_b32 v75, 0
    v_and_b32 v58, 1, v30
    v_cmp_ne_u32 vcc, 0, v58
    v_pk_mul_f32 v[56:57], v[74:75], v[38:39] op_sel:[0,0] op_sel_hi:[1,0]
    v_pk_fma_f32 v[56:57], v[74:75], v[38:39], v[56:57] op_sel:[1,1,0] op_sel_hi:[0,1,1] neg_lo:[1,0,0]
    v_cndmask_b32 v74, v74, v56, vcc
    v_cndmask_b32 v75, v75, v57, vcc
    v_and_b32 v58, 2, v30
    v_cmp_ne_u32 vcc, 0, v58
    v_pk_mul_f32 v[56:57], v[74:75], v[40:41] op_sel:[0,0] op_sel_hi:[1,0]
    v_pk_fma_f32 v[56:57], v[74:75], v[40:41], v[56:57] op_sel:[1,1,0] op_sel_hi:[0,1,1] neg_lo:[1,0,0]
    v_cndmask_b32 v74, v74, v56, vcc
    v_cndmask_b32 v75, v75, v57, vcc
    v_and_b32 v58, 4, v30
    v_cmp_ne_u32 vcc, 0, v58
    v_pk_mul_f32 v[56:57], v[74:75], v[42:43] op_sel:[0,0] op_sel_hi:[1,0]
    v_pk_fma_f32 v[56:57], v[74:75], v[42:43], v[56:57] op_sel:[1,1,0] op_sel_hi:[0,1,1] neg_lo:[1,0,0]
    v_cndmask_b32 v74, v74, v56, vcc
    v_cndmask_b32 v75, v75, v57, vcc
    v_mov_b32 v78, 1.0
    v_mov_b32 v79, 0
    v_and_b32 v58, 1, v30
    v_cmp_ne_u32 vcc, 0, v58
    v_pk_mul_f32 v[56:57], v[78:79], v[48:49] op_sel:[0,0] op_sel_hi:[1,0]
    v_pk_fma_f32 v[56:57], v[78:79], v[48:49], v[56:57] op_sel:[1,1,0] op_sel_hi:[0,1,1] neg_lo:[1,0,0]
    v_cndmask_b32 v78, v78, v56, vcc
    v_cndmask_b32 v79, v79, v57, vcc
    v_and_b32 v58, 2, v30
    v_cmp_ne_u32 vcc, 0, v58
    v_pk_mul_f32 v[56:57], v[78:79], v[50:51] op_sel:[0,0] op_sel_hi:[1,0]
    v_pk_fma_f32 v[56:57], v[78:79], v[50:51], v[56:57] op_sel:[1,1,0] op_sel_hi:[0,1,1] neg_lo:[1,0,0]
    v_cndmask_b32 v78, v78, v56, vcc
    v_cndmask_b32 v79, v79, v57, vcc
    v_and_b32 v58, 4, v30
    v_cmp_ne_u32 vcc, 0, v58
    v_pk_mul_f32 v[56:57], v[78:79], v[52:53] op_sel:[0,0] op_sel_hi:[1,0]
    v_pk_fma_f32 v[56:57], v[78:79], v[52:53], v[56:57] op_sel:[1,1,0] op_sel_hi:[0,1,1] neg_lo:[1,0,0]
    v_cndmask_b32 v78, v78, v56, vcc
    v_cndmask_b32 v79, v79, v57, vcc
    v_add_u32 v32, 159360, v3
    ds_write_b128 v32, v[64:67] offset:0
    ds_write_b128 v32, v[68:71] offset:1024
    ds_write_b128 v32, v[72:75] offset:2048
    ds_write_b128 v32, v[76:79] offset:3072
L_kvd:
    s_mov_b32 s8, s16
    s_mov_b32 s9, s17
    s_mov_b32 s10, 2359296
    s_mov_b32 s11, 0x20000
    s_cmp_lt_u32 s54, 2
    s_cselect_b32 s68, s22, s24
    s_cselect_b32 s69, s23, s25
    s_mov_b32 s70, 663552
    s_mov_b32 s71, 0x20000
    s_cselect_b32 s62, -1, 0
    s_cselect_b32 s63, 0, -1
    s_lshl_b32 s61, s52, 6
    s_lshl_b32 s60, s54, 2
    s_add_u32 s61, s61, s60
    s_mul_i32 s61, s61, 1152
    v_and_b32 v32, 3, v102
    v_lshl_add_u32 v32, v2, 4, v32
    v_mul_u32_u24 v31, 1152, v32
    v_add3_u32 v31, v31, v103, s61
    s_mul_i32 s61, s2, 72
    s_add_u32 s61, s61, 64
    s_mul_i32 s61, s61, 1152
    v_and_b32 v32, 7, v102
    v_mul_u32_u24 v32, 1152, v32
    v_add3_u32 v25, v32, v103, s61
    s_and_b32 s60, s54, 1
    s_lshl_b32 s76, s60, 10
    s_lshl_b32 s64, s60, 6
    s_add_u32 s64, s64, s3
    s_lshl_b32 s38, s54, 10
    v_lshrrev_b32 v32, 2, v1
    v_and_b32 v34, 3, v1
    v_lshlrev_b32 v32, 10, v32
    v_lshl_add_u32 v32, v34, 6, v32
    s_lshl_b32 s60, s101, 8
    v_add_u32 v32, s60, v32
    s_mul_i32 s60, s53, 9
    s_sub_u32 s61, 0, s101
    s_and_b32 s61, s61, 3
    s_lshr_b32 s40, s3, 6
    v_lshrrev_b32 v33, 1, v2
    v_add_u32 v33, s60, v33
    v_and_b32 v34, 1, v2
    v_lshl_add_u32 v32, v34, 3, v32
    s_xor_b32 s60, s37, 0
    s_mul_i32 s60, s60, 2
    v_add_u32 v35, s60, v33
    v_min_u32 v35, 71, v35
    v_and_b32 v36, 3, v35
    v_xor_b32 v36, s61, v36
    v_lshrrev_b32 v35, 2, v35
    v_subrev_u32 v35, s40, v35
    v_lshl_add_u32 v98, v35, 12, v32
    v_lshl_add_u32 v98, v36, 4, v98
    s_xor_b32 s60, s37, 1
    s_mul_i32 s60, s60, 2
    v_add_u32 v35, s60, v33
    v_min_u32 v35, 71, v35
    v_and_b32 v36, 3, v35
    v_xor_b32 v36, s61, v36
    v_lshrrev_b32 v35, 2, v35
    v_subrev_u32 v35, s40, v35
    v_lshl_add_u32 v99, v35, 12, v32
    v_lshl_add_u32 v99, v36, 4, v99
    s_xor_b32 s60, s37, 2
    s_mul_i32 s60, s60, 2
    v_add_u32 v35, s60, v33
    v_min_u32 v35, 71, v35
    v_and_b32 v36, 3, v35
    v_xor_b32 v36, s61, v36
    v_lshrrev_b32 v35, 2, v35
    v_subrev_u32 v35, s40, v35
    v_lshl_add_u32 v100, v35, 12, v32
    v_lshl_add_u32 v100, v36, 4, v100
    s_xor_b32 s60, s37, 3
    s_mul_i32 s60, s60, 2
    v_add_u32 v35, s60, v33
    v_min_u32 v35, 71, v35
    v_and_b32 v36, 3, v35
    v_xor_b32 v36, s61, v36
    v_lshrrev_b32 v35, 2, v35
    v_subrev_u32 v35, s40, v35
    v_lshl_add_u32 v101, v35, 12, v32
    v_lshl_add_u32 v101, v36, 4, v101
    s_mov_b32 s60, 8
    v_add_u32 v35, s60, v33
    v_min_u32 v35, 71, v35
    v_and_b32 v36, 3, v35
    v_xor_b32 v36, s61, v36
    v_lshrrev_b32 v35, 2, v35
    v_subrev_u32 v35, s40, v35
    v_lshl_add_u32 v102, v35, 12, v32
    v_lshl_add_u32 v102, v36, 4, v102
    s_waitcnt vmcnt(0)
    v_mov_b32 v32, 1
    s_mov_b64 exec, 1
    ds_add_rtn_u32 v32, v5, v32 offset:84
    v_mov_b32 v34, s55
    v_mov_b32 v35, 0
    s_waitcnt lgkmcnt(0)
    v_cmp_eq_u32 vcc, 3, v32
    s_cbranch_vccz nf_50
    buffer_store_dword v34, v35, s[4:7], s41 offen sc1
nf_50:
    s_mov_b64 exec, -1
    s_mov_b32 s77, 3200000
cw_51:
    ds_read_b32 v40, v5 offset:0
    s_waitcnt lgkmcnt(0)
    v_cmp_gt_u32 vcc, 4, v40
    s_cbranch_vccz cwo_52
    s_sleep 1
    s_sub_u32 s77, s77, 1
    s_cmp_lg_u32 s77, 0
    s_cbranch_scc1 cw_51
cwo_52:
    ds_read_b64 v[40:41], v98
    ds_read_b64 v[42:43], v99
    ds_read_b64 v[44:45], v100
    ds_read_b64 v[46:47], v101
    ds_read_b64 v[48:49], v102
    s_add_u32 s61, s64, 512
    s_sub_u32 s60, s61, 1152
    s_min_u32 s61, s61, s60
    s_mov_b64 exec, s[62:63]
    s_add_u32 m0, s76, 141312
    s_nop 0
    buffer_load_dwordx4 v25, s[68:71], s61 offen lds
    s_mov_b64 exec, -1
    s_add_u32 s61, s64, 640
    s_sub_u32 s60, s61, 1152
    s_min_u32 s61, s61, s60
    s_mov_b64 exec, s[62:63]
    s_add_u32 m0, s76, 143360
    s_nop 0
    buffer_load_dwordx4 v25, s[68:71], s61 offen lds
    s_mov_b64 exec, -1
    s_add_u32 s61, s64, 768
    s_sub_u32 s60, s61, 1152
    s_min_u32 s61, s61, s60
    s_mov_b64 exec, s[62:63]
    s_add_u32 m0, s76, 145408
    s_nop 0
    buffer_load_dwordx4 v25, s[68:71], s61 offen lds
    s_mov_b64 exec, -1
    s_add_u32 s61, s3, 512
    s_sub_u32 s60, s61, 1152
    s_min_u32 s61, s61, s60
    s_add_u32 m0, s38, 32768
    s_nop 0
    buffer_load_dwordx4 v31, s[8:11], s61 offen lds
    s_add_u32 s61, s3, 576
    s_sub_u32 s60, s61, 1152
    s_min_u32 s61, s61, s60
    s_add_u32 m0, s38, 36864
    s_nop 0
    buffer_load_dwordx4 v31, s[8:11], s61 offen lds
    s_add_u32 s61, s3, 640
    s_sub_u32 s60, s61, 1152
    s_min_u32 s61, s61, s60
    s_add_u32 m0, s38, 40960
    s_nop 0
    buffer_load_dwordx4 v31, s[8:11], s61 offen lds
    s_add_u32 s61, s3, 704
    s_sub_u32 s60, s61, 1152
    s_min_u32 s61, s61, s60
    s_add_u32 m0, s38, 45056
    s_nop 0
    buffer_load_dwordx4 v31, s[8:11], s61 offen lds
    s_add_u32 s61, s3, 768
    s_sub_u32 s60, s61, 1152
    s_min_u32 s61, s61, s60
    s_add_u32 m0, s38, 49152
    s_nop 0
    buffer_load_dwordx4 v31, s[8:11], s61 offen lds
    s_add_u32 s61, s64, 896
    s_sub_u32 s60, s61, 1152
    s_min_u32 s61, s61, s60
    s_mov_b64 exec, s[62:63]
    s_add_u32 m0, s76, 147456
    s_nop 0
    buffer_load_dwordx4 v25, s[68:71], s61 offen lds
    s_mov_b64 exec, -1
    s_add_u32 s61, s64, 1024
    s_sub_u32 s60, s61, 1152
    s_min_u32 s61, s61, s60
    s_mov_b64 exec, s[62:63]
    s_add_u32 m0, s76, 149504
    s_nop 0
    buffer_load_dwordx4 v25, s[68:71], s61 offen lds
    s_mov_b64 exec, -1
    s_mov_b32 s77, 3200000
cw_53:
    ds_read_b32 v32, v5 offset:20
    s_waitcnt lgkmcnt(0)
    v_cmp_gt_u32 vcc, 4, v32
    s_cbranch_vccz cwo_54
    s_sub_u32 s77, s77, 1
    s_cmp_lg_u32 s77, 0
    s_cbranch_scc1 cw_53
cwo_54:
    s_add_u32 s61, s3, 832
    s_sub_u32 s60, s61, 1152
    s_min_u32 s61, s61, s60
    s_add_u32 m0, s38, 53248
    s_nop 0
    buffer_load_dwordx4 v31, s[8:11], s61 offen lds
    s_add_u32 s61, s3, 896
    s_sub_u32 s60, s61, 1152
    s_min_u32 s61, s61, s60
    s_add_u32 m0, s38, 57344
    s_nop 0
    buffer_load_dwordx4 v31, s[8:11], s61 offen lds
    s_add_u32 s61, s3, 960
    s_sub_u32 s60, s61, 1152
    s_min_u32 s61, s61, s60
    s_add_u32 m0, s38, 61440
    s_nop 0
    buffer_load_dwordx4 v31, s[8:11], s61 offen lds
    s_add_u32 s61, s3, 1024
    s_sub_u32 s60, s61, 1152
    s_min_u32 s61, s61, s60
    s_add_u32 m0, s38, 65536
    s_nop 0
    buffer_load_dwordx4 v31, s[8:11], s61 offen lds
    s_add_u32 s61, s3, 1088
    s_sub_u32 s60, s61, 1152
    s_min_u32 s61, s61, s60
    s_add_u32 m0, s38, 69632
    s_nop 0
    buffer_load_dwordx4 v31, s[8:11], s61 offen lds
    v_lshlrev_b32 v6, 16, v40
    v_and_b32 v7, 0xffff0000, v40
    v_lshlrev_b32 v8, 16, v41
    v_and_b32 v9, 0xffff0000, v41
    v_lshlrev_b32 v10, 16, v42
    v_and_b32 v11, 0xffff0000, v42
    v_lshlrev_b32 v12, 16, v43
    v_and_b32 v13, 0xffff0000, v43
    v_lshlrev_b32 v14, 16, v44
    v_and_b32 v15, 0xffff0000, v44
    v_lshlrev_b32 v16, 16, v45
    v_and_b32 v17, 0xffff0000, v45
    v_lshlrev_b32 v18, 16, v46
    v_and_b32 v19, 0xffff0000, v46
    v_lshlrev_b32 v20, 16, v47
    v_and_b32 v21, 0xffff0000, v47
    v_lshlrev_b32 v22, 16, v48
    v_and_b32 v23, 0xffff0000, v48
    v_lshlrev_b32 v24, 16, v49
    v_and_b32 v25, 0xffff0000, v49
    s_mov_b32 exec_lo, 0x0
    s_mov_b32 exec_hi, 0xffffffff
    v_mov_b32 v22, 0
    v_mov_b32 v23, 0
    v_mov_b32 v24, 0
    v_mov_b32 v25, 0
    s_mov_b64 exec, -1
    v_pk_add_f32 v[40:41], v[6:7], v[8:9]
    v_pk_mul_f32 v[42:43], v[6:7], v[6:7]
    v_pk_fma_f32 v[42:43], v[8:9], v[8:9], v[42:43]
    v_pk_add_f32 v[40:41], v[40:41], v[10:11]
    v_pk_fma_f32 v[42:43], v[10:11], v[10:11], v[42:43]
    v_pk_add_f32 v[40:41], v[40:41], v[12:13]
    v_pk_fma_f32 v[42:43], v[12:13], v[12:13], v[42:43]
    v_pk_add_f32 v[40:41], v[40:41], v[14:15]
    v_pk_fma_f32 v[42:43], v[14:15], v[14:15], v[42:43]
    v_pk_add_f32 v[40:41], v[40:41], v[16:17]
    v_pk_fma_f32 v[42:43], v[16:17], v[16:17], v[42:43]
    v_pk_add_f32 v[40:41], v[40:41], v[18:19]
    v_pk_fma_f32 v[42:43], v[18:19], v[18:19], v[42:43]
    v_pk_add_f32 v[40:41], v[40:41], v[20:21]
    v_pk_fma_f32 v[42:43], v[20:21], v[20:21], v[42:43]
    v_pk_add_f32 v[40:41], v[40:41], v[22:23]
    v_pk_fma_f32 v[42:43], v[22:23], v[22:23], v[42:43]
    v_pk_add_f32 v[40:41], v[40:41], v[24:25]
    v_pk_fma_f32 v[42:43], v[24:25], v[24:25], v[42:43]
    v_add_f32 v40, v40, v41
    v_add_f32 v41, v42, v43
    v_mov_b32 v45, s55
    v_mov_b32 v47, s55
    v_mov_b64 v[42:43], v[40:41]
    s_nop 1
    v_permlane32_swap_b32 v40, v42
    v_permlane32_swap_b32 v41, v43
    v_pk_add_f32 v[40:41], v[40:41], v[42:43]
    v_mov_b64 v[42:43], v[40:41]
    s_lshl_b32 s61, s53, 8
    s_add_u32 s61, s61, s58
    v_permlane16_swap_b32 v40, v42
    v_permlane16_swap_b32 v41, v43
    v_add_f32 v44, v40, v42
    v_add_f32 v46, v41, v43
    s_mov_b64 exec, 0xffff
    buffer_store_dwordx4 v[44:47], v3, s[4:7], s61 offen sc1
    s_mov_b64 exec, -1
    s_waitcnt vmcnt(8)
    v_mov_b32 v32, 1
    s_mov_b64 exec, 1
    ds_add_u32 v5, v32 offset:8
    s_mov_b64 exec, -1
    s_waitcnt vmcnt(1)
    v_mov_b32 v32, 1
    s_mov_b64 exec, 1
    ds_add_u32 v5, v32 offset:60
    s_mov_b64 exec, -1
    s_lshl_b32 s38, s54, 13
    s_add_u32 s38, s38, 40960
    s_lshl_b32 s40, s54, 11
    s_add_u32 s40, s40, 106496
    s_add_u32 s41, s65, 73728
    v_add_u32 v108, s0, v4
    v_add_u32 v109, s40, v4
    v_add_u32 v110, s39, v4
    v_add_u32 v31, s38, v4
    s_setprio 0
    s_cmp_lg_u32 s66, 0
    s_cbranch_scc1 L_conv
    s_cmp_eq_u32 s54, 3
    s_cbranch_scc1 L_x7
    s_mov_b32 s77, 3200000
cw_55:
    ds_read_b32 v32, v5 offset:88
    s_waitcnt lgkmcnt(0)
    v_cmp_gt_u32 vcc, 4, v32
    s_cbranch_vccz cwo_56
    s_sleep 2
    s_sub_u32 s77, s77, 1
    s_cmp_lg_u32 s77, 0
    s_cbranch_scc1 cw_55
cwo_56:
    s_xor_b32 s60, s37, 0
    s_mul_i32 s60, s60, 18432
    s_add_u32 s60, s60, s65
    v_and_b32 v32, 3, v0
    v_lshrrev_b32 v33, 2, v0
    v_mul_u32_u24 v33, 1152, v33
    v_lshl_add_u32 v32, v32, 7, v33
    buffer_load_dword a0, v32, s[72:75], s60 offen
    buffer_load_dword a1, v33, s[72:75], s60 offen offset:512
    s_mul_i32 s60, s37, 2304
    s_add_u32 s60, s60, s41
    s_mov_b64 exec, 0xff
    buffer_load_dword a2, v32, s[72:75], s60 offen
    buffer_load_dword a3, v33, s[72:75], s60 offen offset:512
    s_mov_b64 exec, -1
    s_mov_b32 s77, 3200000
cw_57:
    ds_read_b32 v32, v5 offset:64
    s_waitcnt lgkmcnt(0)
    v_cmp_gt_u32 vcc, 4, v32
    s_cbranch_vccz cwo_58
    s_sleep 1
    s_sub_u32 s77, s77, 1
    s_cmp_lg_u32 s77, 0
    s_cbranch_scc1 cw_57
cwo_58:
    s_waitcnt vmcnt(0)
    ds_read_b128 a[0:3], v108 offset:0
    ds_read_b128 a[4:7], v108 offset:1024
    ds_read_b128 a[8:11], v108 offset:2048
    ds_read_b128 a[12:15], v108 offset:3072
    ds_read_b128 a[16:19], v109 offset:0
    ds_read_b128 a[20:23], v109 offset:1024
    ds_read_b128 a[24:27], v31 offset:0
    ds_read_b128 a[28:31], v31 offset:1024
    ds_read_b128 a[32:35], v31 offset:2048
    ds_read_b128 a[36:39], v31 offset:3072
    ds_read_b128 a[40:43], v31 offset:4096
    ds_read_b128 a[44:47], v31 offset:5120
    ds_read_b128 a[48:51], v31 offset:6144
    ds_read_b128 a[52:55], v31 offset:7168
    ds_read_b128 a[56:59], v110 offset:0
    ds_read_b128 a[60:63], v110 offset:1024
    ds_read_b128 a[64:67], v110 offset:2048
    ds_read_b128 a[68:71], v110 offset:3072
    ds_read_b128 a[72:75], v110 offset:4096
    ds_read_b128 a[76:79], v110 offset:5120
    ds_read_b128 a[80:83], v110 offset:6144
    ds_read_b128 a[84:87], v110 offset:7168
    v_mov_b32 v32, 1
    s_mov_b64 exec, 1
    ds_add_u32 v5, v32 offset:100
    s_mov_b64 exec, -1
    s_branch L_xres
L_x7:
    s_branch L_t8
L_conv:
    v_mov_b32 v28, v107
    s_mov_b32 s77, 3200000
cw_59:
    ds_read_b32 v74, v5 offset:12
    s_waitcnt lgkmcnt(0)
    v_cmp_gt_u32 vcc, 4, v74
    s_cbranch_vccz cwo_60
    s_sleep 2
    s_sub_u32 s77, s77, 1
    s_cmp_lg_u32 s77, 0
    s_cbranch_scc1 cw_59
cwo_60:
    s_lshl_b32 s76, s53, 7
    s_add_u32 s76, s76, 22052864
    v_lshlrev_b32 v72, 2, v0
    v_and_b32 v72, 127, v72
    s_mov_b32 s77, 400000
poll_kvf_61:
    buffer_load_dword v73, v72, s[4:7], s76 offen sc1
pchk_kvf_63:
    s_waitcnt vmcnt(0)
    v_cmp_ne_u32 vcc, s55, v73
    s_cbranch_vccz pout_kvf_62
    s_sleep 8
    s_sub_u32 s77, s77, 1
    s_cmp_lg_u32 s77, 0
    s_cbranch_scc1 poll_kvf_61
pout_kvf_62:
    s_add_u32 s60, s67, 13631488
    buffer_load_dwordx4 v[32:35], v3, s[4:7], s60 offen offset:0 sc1
    buffer_load_dword v76, v3, s[4:7], s60 offen offset:16 sc1
    buffer_load_dwordx4 v[36:39], v3, s[4:7], s60 offen offset:1024 sc1
    buffer_load_dword v77, v3, s[4:7], s60 offen offset:1040 sc1
    buffer_load_dwordx4 v[40:43], v3, s[4:7], s60 offen offset:2048 sc1
    buffer_load_dword v78, v3, s[4:7], s60 offen offset:2064 sc1
    buffer_load_dwordx4 v[44:47], v3, s[4:7], s60 offen offset:3072 sc1
    buffer_load_dword v79, v3, s[4:7], s60 offen offset:3088 sc1
    v_lshlrev_b32 v69, 3, v2
    v_sub_u32 v69, v69, v1
    v_lshlrev_b32 v69, 1, v69
    v_and_b32 v70, 1, v1
    v_cmp_eq_u32 vcc, 1, v70
    v_mov_b32 v70, 8220
    v_mov_b32 v71, 4062
    v_cndmask_b32 v70, v70, v71, vcc
    v_add3_u32 v69, v69, v70, s36
    v_subrev_u32 v104, 960, v69
    v_subrev_u32 v105, 1984, v69
    v_subrev_u32 v106, 3008, v69
    v_subrev_u32 v107, 4032, v69
    v_lshlrev_b32 v111, 5, v1
    v_lshl_add_u32 v111, v2, 4, v111
    s_add_u32 s60, s36, 8480
    v_add_u32 v111, s60, v111
    v_mov_b32 v64, 0
    v_mov_b32 v65, 0
    v_mov_b32 v66, 0
    v_mov_b32 v67, 0
    v_add_u32 v68, s36, v3
    v_lshlrev_b32 v29, 16, v28
    s_waitcnt vmcnt(0)
    v_writelane_b32 v79, 0, 63
    v_alignbit_b32 v48, v33, v32, 16
    v_alignbit_b32 v49, v34, v33, 16
    v_alignbit_b32 v50, v35, v34, 16
    v_alignbit_b32 v51, v76, v35, 16
    v_alignbit_b32 v52, v37, v36, 16
    v_alignbit_b32 v53, v38, v37, 16
    v_alignbit_b32 v54, v39, v38, 16
    v_alignbit_b32 v55, v77, v39, 16
    v_alignbit_b32 v56, v41, v40, 16
    v_alignbit_b32 v57, v42, v41, 16
    v_alignbit_b32 v58, v43, v42, 16
    v_alignbit_b32 v59, v78, v43, 16
    v_alignbit_b32 v60, v45, v44, 16
    v_alignbit_b32 v61, v46, v45, 16
    v_alignbit_b32 v62, v47, v46, 16
    v_alignbit_b32 v63, v79, v47, 16
    s_mov_b32 s77, 3200000
cw_64:
    ds_read_b32 v74, v5 offset:88
    s_waitcnt lgkmcnt(0)
    v_cmp_gt_u32 vcc, 4, v74
    s_cbranch_vccz cwo_65
    s_sleep 2
    s_sub_u32 s77, s77, 1
    s_cmp_lg_u32 s77, 0
    s_cbranch_scc1 cw_64
cwo_65:
    s_xor_b32 s60, s37, 0
    s_mul_i32 s60, s60, 18432
    s_add_u32 s60, s60, s65
    v_and_b32 v74, 3, v0
    v_lshrrev_b32 v75, 2, v0
    v_mul_u32_u24 v75, 1152, v75
    v_lshl_add_u32 v74, v74, 7, v75
    buffer_load_dword a0, v74, s[72:75], s60 offen
    buffer_load_dword a1, v75, s[72:75], s60 offen offset:512
    s_mul_i32 s60, s37, 2304
    s_add_u32 s60, s60, s41
    s_mov_b64 exec, 0xff
    buffer_load_dword a2, v74, s[72:75], s60 offen
    buffer_load_dword a3, v75, s[72:75], s60 offen offset:512
    s_mov_b64 exec, -1
    ds_write_b128 v68, a[96:99] offset:8960
    ds_write_b128 v68, v[44:47] offset:3072
    ds_write_b128 v68, v[60:63] offset:7232
    ds_write_b128 v68, a[100:103] offset:9984
    ds_write_b128 v68, v[40:43] offset:2048
    ds_write_b128 v68, v[56:59] offset:6208
    ds_write_b128 v68, a[104:107] offset:11008
    ds_write_b128 v68, v[36:39] offset:1024
    ds_write_b128 v68, v[52:55] offset:5184
    ds_write_b128 v68, a[108:111] offset:12032
    ds_write_b128 v68, v[32:35] offset:0
    ds_write_b128 v68, v[48:51] offset:4160
    s_mov_b32 exec_lo, 0xffffffff
    s_mov_b32 exec_hi, 0x0
    ds_write_b128 v68, v[64:67] offset:8448
    s_mov_b64 exec, 0x3
    ds_write_b128 v68, v[64:67] offset:4096
    ds_write_b128 v68, v[64:67] offset:8256
    s_mov_b64 exec, -1
    ds_read_b128 v[64:67], v111 offset:448
    ds_read2_b32 v[32:33], v104 offset0:240 offset1:241
    ds_read2_b32 v[34:35], v104 offset0:242 offset1:243
    ds_read_b128 v[92:95], v111 offset:4032
    ds_read2_b32 v[60:61], v107 offset0:112 offset1:113
    ds_read2_b32 v[62:63], v107 offset0:114 offset1:115
    ds_read_b128 v[88:91], v111 offset:3520
    ds_read2_b32 v[56:57], v107 offset0:240 offset1:241
    ds_read2_b32 v[58:59], v107 offset0:242 offset1:243
    ds_read_b128 v[68:71], v111 offset:960
    ds_read2_b32 v[36:37], v104 offset0:112 offset1:113
    ds_read2_b32 v[38:39], v104 offset0:114 offset1:115
    ds_read_b128 v[84:87], v111 offset:3008
    ds_read2_b32 v[52:53], v106 offset0:112 offset1:113
    ds_read2_b32 v[54:55], v106 offset0:114 offset1:115
    ds_read_b128 v[72:75], v111 offset:1472
    ds_read2_b32 v[40:41], v105 offset0:240 offset1:241
    ds_read2_b32 v[42:43], v105 offset0:242 offset1:243
    ds_read_b128 v[80:83], v111 offset:2496
    ds_read2_b32 v[48:49], v106 offset0:240 offset1:241
    ds_read2_b32 v[50:51], v106 offset0:242 offset1:243
    ds_read_b128 v[76:79], v111 offset:1984
    ds_read2_b32 v[44:45], v105 offset0:112 offset1:113
    ds_read2_b32 v[46:47], v105 offset0:114 offset1:115
    s_waitcnt lgkmcnt(15)
    v_mfma_f32_16x16x32_bf16 a[140:143], v[60:63], v[64:67], 0
    ds_read_b128 v[100:103], v111 offset:384
    v_mfma_f32_16x16x32_bf16 a[140:143], v[32:35], v[92:95], a[140:143]
    ds_read2_b32 v[96:97], v104 offset0:224 offset1:225
    s_waitcnt lgkmcnt(15)
    v_mfma_f32_16x16x32_bf16 a[136:139], v[56:59], v[64:67], 0
    ds_read2_b32 v[98:99], v104 offset0:226 offset1:227
    v_mfma_f32_16x16x32_bf16 a[136:139], v[32:35], v[88:91], a[136:139]
    ds_read_b128 v[92:95], v111 offset:3968
    s_waitcnt lgkmcnt(15)
    v_mfma_f32_16x16x32_bf16 a[140:143], v[56:59], v[68:71], a[140:143]
    ds_read2_b32 v[60:61], v107 offset0:96 offset1:97
    v_mfma_f32_16x16x32_bf16 a[140:143], v[36:39], v[88:91], a[140:143]
    ds_read2_b32 v[62:63], v107 offset0:98 offset1:99
    s_waitcnt lgkmcnt(15)
    v_mfma_f32_16x16x32_bf16 a[132:135], v[52:55], v[64:67], 0
    ds_read_b128 v[88:91], v111 offset:3456
    v_mfma_f32_16x16x32_bf16 a[132:135], v[32:35], v[84:87], a[132:135]
    ds_read2_b32 v[56:57], v107 offset0:224 offset1:225
    v_mfma_f32_16x16x32_bf16 a[136:139], v[52:55], v[68:71], a[136:139]
    ds_read2_b32 v[58:59], v107 offset0:226 offset1:227
    v_mfma_f32_16x16x32_bf16 a[136:139], v[36:39], v[84:87], a[136:139]
    s_waitcnt lgkmcnt(15)
    v_mfma_f32_16x16x32_bf16 a[140:143], v[52:55], v[72:75], a[140:143]
    v_mfma_f32_16x16x32_bf16 a[140:143], v[40:43], v[84:87], a[140:143]
    s_waitcnt lgkmcnt(12)
    v_mfma_f32_16x16x32_bf16 a[128:131], v[48:51], v[64:67], 0
    ds_read_b128 v[84:87], v111 offset:2944
    v_mfma_f32_16x16x32_bf16 a[128:131], v[32:35], v[80:83], a[128:131]
    ds_read2_b32 v[52:53], v106 offset0:96 offset1:97
    v_mfma_f32_16x16x32_bf16 a[132:135], v[48:51], v[68:71], a[132:135]
    ds_read2_b32 v[54:55], v106 offset0:98 offset1:99
    v_mfma_f32_16x16x32_bf16 a[132:135], v[36:39], v[80:83], a[132:135]
    v_mfma_f32_16x16x32_bf16 a[136:139], v[48:51], v[72:75], a[136:139]
    v_mfma_f32_16x16x32_bf16 a[136:139], v[40:43], v[80:83], a[136:139]
    s_waitcnt lgkmcnt(12)
    v_mfma_f32_16x16x32_bf16 a[140:143], v[48:51], v[76:79], a[140:143]
    v_mfma_f32_16x16x32_bf16 a[140:143], v[44:47], v[80:83], a[140:143]
    v_mfma_f32_16x16x32_bf16 a[116:119], v[36:39], v[64:67], 0
    ds_read_b128 v[80:83], v111 offset:2432
    v_mfma_f32_16x16x32_bf16 a[120:123], v[36:39], v[68:71], 0
    ds_read2_b32 v[48:49], v106 offset0:224 offset1:225
    v_mfma_f32_16x16x32_bf16 a[124:127], v[36:39], v[72:75], 0
    ds_read2_b32 v[50:51], v106 offset0:226 offset1:227
    v_mfma_f32_16x16x32_bf16 a[128:131], v[36:39], v[76:79], a[128:131]
    v_mfma_f32_16x16x32_bf16 a[116:119], v[32:35], v[68:71], a[116:119]
    v_mfma_f32_16x16x32_bf16 a[124:127], v[40:43], v[68:71], a[124:127]
    v_mfma_f32_16x16x32_bf16 a[128:131], v[44:47], v[68:71], a[128:131]
    v_mfma_f32_16x16x32_bf16 a[128:131], v[40:43], v[72:75], a[128:131]
    ds_read_b128 v[68:71], v111 offset:896
    v_mfma_f32_16x16x32_bf16 a[132:135], v[40:43], v[76:79], a[132:135]
    ds_read2_b32 v[36:37], v104 offset0:96 offset1:97
    v_mfma_f32_16x16x32_bf16 a[132:135], v[44:47], v[72:75], a[132:135]
    ds_read2_b32 v[38:39], v104 offset0:98 offset1:99
    v_mfma_f32_16x16x32_bf16 a[120:123], v[40:43], v[64:67], a[120:123]
    v_mfma_f32_16x16x32_bf16 a[120:123], v[32:35], v[72:75], a[120:123]
    v_mfma_f32_16x16x32_bf16 a[136:139], v[44:47], v[76:79], a[136:139]
    ds_read_b128 v[72:75], v111 offset:1408
    v_mfma_f32_16x16x32_bf16 a[124:127], v[44:47], v[64:67], a[124:127]
    ds_read2_b32 v[40:41], v105 offset0:224 offset1:225
    v_mfma_f32_16x16x32_bf16 a[124:127], v[32:35], v[76:79], a[124:127]
    ds_read2_b32 v[42:43], v105 offset0:226 offset1:227
    v_mfma_f32_16x16x32_bf16 a[112:115], v[32:35], v[64:67], 0
    ds_read_b128 v[76:79], v111 offset:1920
    ds_read2_b32 v[44:45], v105 offset0:96 offset1:97
    ds_read2_b32 v[46:47], v105 offset0:98 offset1:99
    s_waitcnt lgkmcnt(15)
    v_mfma_f32_16x16x32_bf16 a[140:143], v[60:63], v[100:103], a[140:143]
    ds_read_b128 v[64:67], v111 offset:320
    v_mfma_f32_16x16x32_bf16 a[140:143], v[96:99], v[92:95], a[140:143]
    ds_read2_b32 v[32:33], v104 offset0:208 offset1:209
    s_waitcnt lgkmcnt(15)
    v_mfma_f32_16x16x32_bf16 a[136:139], v[56:59], v[100:103], a[136:139]
    ds_read2_b32 v[34:35], v104 offset0:210 offset1:211
    v_mfma_f32_16x16x32_bf16 a[136:139], v[96:99], v[88:91], a[136:139]
    ds_read_b128 v[92:95], v111 offset:3904
    s_waitcnt lgkmcnt(10)
    v_mfma_f32_16x16x32_bf16 a[140:143], v[56:59], v[68:71], a[140:143]
    ds_read2_b32 v[60:61], v107 offset0:80 offset1:81
    v_mfma_f32_16x16x32_bf16 a[140:143], v[36:39], v[88:91], a[140:143]
    ds_read2_b32 v[62:63], v107 offset0:82 offset1:83
    s_waitcnt lgkmcnt(15)
    v_mfma_f32_16x16x32_bf16 a[132:135], v[52:55], v[100:103], a[132:135]
    ds_read_b128 v[88:91], v111 offset:3392
    v_mfma_f32_16x16x32_bf16 a[132:135], v[96:99], v[84:87], a[132:135]
    ds_read2_b32 v[56:57], v107 offset0:208 offset1:209
    v_mfma_f32_16x16x32_bf16 a[136:139], v[52:55], v[68:71], a[136:139]
    ds_read2_b32 v[58:59], v107 offset0:210 offset1:211
    v_mfma_f32_16x16x32_bf16 a[136:139], v[36:39], v[84:87], a[136:139]
    s_waitcnt lgkmcnt(12)
    v_mfma_f32_16x16x32_bf16 a[140:143], v[52:55], v[72:75], a[140:143]
    v_mfma_f32_16x16x32_bf16 a[140:143], v[40:43], v[84:87], a[140:143]
    s_waitcnt lgkmcnt(15)
    v_mfma_f32_16x16x32_bf16 a[128:131], v[48:51], v[100:103], a[128:131]
    ds_read_b128 v[84:87], v111 offset:2880
    v_mfma_f32_16x16x32_bf16 a[128:131], v[96:99], v[80:83], a[128:131]
    ds_read2_b32 v[52:53], v106 offset0:80 offset1:81
    v_mfma_f32_16x16x32_bf16 a[132:135], v[48:51], v[68:71], a[132:135]
    ds_read2_b32 v[54:55], v106 offset0:82 offset1:83
    v_mfma_f32_16x16x32_bf16 a[132:135], v[36:39], v[80:83], a[132:135]
    v_mfma_f32_16x16x32_bf16 a[136:139], v[48:51], v[72:75], a[136:139]
    v_mfma_f32_16x16x32_bf16 a[136:139], v[40:43], v[80:83], a[136:139]
    s_waitcnt lgkmcnt(12)
    v_mfma_f32_16x16x32_bf16 a[140:143], v[48:51], v[76:79], a[140:143]
    v_mfma_f32_16x16x32_bf16 a[140:143], v[44:47], v[80:83], a[140:143]
    v_mfma_f32_16x16x32_bf16 a[116:119], v[36:39], v[100:103], a[116:119]
    ds_read_b128 v[80:83], v111 offset:2368
    v_mfma_f32_16x16x32_bf16 a[120:123], v[36:39], v[68:71], a[120:123]
    ds_read2_b32 v[48:49], v106 offset0:208 offset1:209
    v_mfma_f32_16x16x32_bf16 a[124:127], v[36:39], v[72:75], a[124:127]
    ds_read2_b32 v[50:51], v106 offset0:210 offset1:211
    v_mfma_f32_16x16x32_bf16 a[128:131], v[36:39], v[76:79], a[128:131]
    v_mfma_f32_16x16x32_bf16 a[116:119], v[96:99], v[68:71], a[116:119]
    v_mfma_f32_16x16x32_bf16 a[124:127], v[40:43], v[68:71], a[124:127]
    v_mfma_f32_16x16x32_bf16 a[128:131], v[44:47], v[68:71], a[128:131]
    v_mfma_f32_16x16x32_bf16 a[128:131], v[40:43], v[72:75], a[128:131]
    ds_read_b128 v[68:71], v111 offset:832
    v_mfma_f32_16x16x32_bf16 a[132:135], v[40:43], v[76:79], a[132:135]
    ds_read2_b32 v[36:37], v104 offset0:80 offset1:81
    v_mfma_f32_16x16x32_bf16 a[132:135], v[44:47], v[72:75], a[132:135]
    ds_read2_b32 v[38:39], v104 offset0:82 offset1:83
    v_mfma_f32_16x16x32_bf16 a[120:123], v[40:43], v[100:103], a[120:123]
    v_mfma_f32_16x16x32_bf16 a[120:123], v[96:99], v[72:75], a[120:123]
    v_mfma_f32_16x16x32_bf16 a[136:139], v[44:47], v[76:79], a[136:139]
    ds_read_b128 v[72:75], v111 offset:1344
    v_mfma_f32_16x16x32_bf16 a[124:127], v[44:47], v[100:103], a[124:127]
    ds_read2_b32 v[40:41], v105 offset0:208 offset1:209
    v_mfma_f32_16x16x32_bf16 a[124:127], v[96:99], v[76:79], a[124:127]
    ds_read2_b32 v[42:43], v105 offset0:210 offset1:211
    v_mfma_f32_16x16x32_bf16 a[112:115], v[96:99], v[100:103], a[112:115]
    ds_read_b128 v[76:79], v111 offset:1856
    ds_read2_b32 v[44:45], v105 offset0:80 offset1:81
    ds_read2_b32 v[46:47], v105 offset0:82 offset1:83
    s_waitcnt lgkmcnt(15)
    v_mfma_f32_16x16x32_bf16 a[140:143], v[60:63], v[64:67], a[140:143]
    ds_read_b128 v[100:103], v111 offset:256
    v_mfma_f32_16x16x32_bf16 a[140:143], v[32:35], v[92:95], a[140:143]
    ds_read2_b32 v[96:97], v104 offset0:192 offset1:193
    s_waitcnt lgkmcnt(15)
    v_mfma_f32_16x16x32_bf16 a[136:139], v[56:59], v[64:67], a[136:139]
    ds_read2_b32 v[98:99], v104 offset0:194 offset1:195
    v_mfma_f32_16x16x32_bf16 a[136:139], v[32:35], v[88:91], a[136:139]
    ds_read_b128 v[92:95], v111 offset:3840
    s_waitcnt lgkmcnt(10)
    v_mfma_f32_16x16x32_bf16 a[140:143], v[56:59], v[68:71], a[140:143]
    ds_read2_b32 v[60:61], v107 offset0:64 offset1:65
    v_mfma_f32_16x16x32_bf16 a[140:143], v[36:39], v[88:91], a[140:143]
    ds_read2_b32 v[62:63], v107 offset0:66 offset1:67
    s_waitcnt lgkmcnt(15)
    v_mfma_f32_16x16x32_bf16 a[132:135], v[52:55], v[64:67], a[132:135]
    ds_read_b128 v[88:91], v111 offset:3328
    v_mfma_f32_16x16x32_bf16 a[132:135], v[32:35], v[84:87], a[132:135]
    ds_read2_b32 v[56:57], v107 offset0:192 offset1:193
    v_mfma_f32_16x16x32_bf16 a[136:139], v[52:55], v[68:71], a[136:139]
    ds_read2_b32 v[58:59], v107 offset0:194 offset1:195
    v_mfma_f32_16x16x32_bf16 a[136:139], v[36:39], v[84:87], a[136:139]
    s_waitcnt lgkmcnt(12)
    v_mfma_f32_16x16x32_bf16 a[140:143], v[52:55], v[72:75], a[140:143]
    v_mfma_f32_16x16x32_bf16 a[140:143], v[40:43], v[84:87], a[140:143]
    s_waitcnt lgkmcnt(15)
    v_mfma_f32_16x16x32_bf16 a[128:131], v[48:51], v[64:67], a[128:131]
    ds_read_b128 v[84:87], v111 offset:2816
    v_mfma_f32_16x16x32_bf16 a[128:131], v[32:35], v[80:83], a[128:131]
    ds_read2_b32 v[52:53], v106 offset0:64 offset1:65
    v_mfma_f32_16x16x32_bf16 a[132:135], v[48:51], v[68:71], a[132:135]
    ds_read2_b32 v[54:55], v106 offset0:66 offset1:67
    v_mfma_f32_16x16x32_bf16 a[132:135], v[36:39], v[80:83], a[132:135]
    v_mfma_f32_16x16x32_bf16 a[136:139], v[48:51], v[72:75], a[136:139]
    v_mfma_f32_16x16x32_bf16 a[136:139], v[40:43], v[80:83], a[136:139]
    s_waitcnt lgkmcnt(12)
    v_mfma_f32_16x16x32_bf16 a[140:143], v[48:51], v[76:79], a[140:143]
    v_mfma_f32_16x16x32_bf16 a[140:143], v[44:47], v[80:83], a[140:143]
    v_mfma_f32_16x16x32_bf16 a[116:119], v[36:39], v[64:67], a[116:119]
    ds_read_b128 v[80:83], v111 offset:2304
    v_mfma_f32_16x16x32_bf16 a[120:123], v[36:39], v[68:71], a[120:123]
    ds_read2_b32 v[48:49], v106 offset0:192 offset1:193
    v_mfma_f32_16x16x32_bf16 a[124:127], v[36:39], v[72:75], a[124:127]
    ds_read2_b32 v[50:51], v106 offset0:194 offset1:195
    v_mfma_f32_16x16x32_bf16 a[128:131], v[36:39], v[76:79], a[128:131]
    v_mfma_f32_16x16x32_bf16 a[116:119], v[32:35], v[68:71], a[116:119]
    v_mfma_f32_16x16x32_bf16 a[124:127], v[40:43], v[68:71], a[124:127]
    v_mfma_f32_16x16x32_bf16 a[128:131], v[44:47], v[68:71], a[128:131]
    v_mfma_f32_16x16x32_bf16 a[128:131], v[40:43], v[72:75], a[128:131]
    ds_read_b128 v[68:71], v111 offset:768
    v_mfma_f32_16x16x32_bf16 a[132:135], v[40:43], v[76:79], a[132:135]
    ds_read2_b32 v[36:37], v104 offset0:64 offset1:65
    v_mfma_f32_16x16x32_bf16 a[132:135], v[44:47], v[72:75], a[132:135]
    ds_read2_b32 v[38:39], v104 offset0:66 offset1:67
    v_mfma_f32_16x16x32_bf16 a[120:123], v[40:43], v[64:67], a[120:123]
    v_mfma_f32_16x16x32_bf16 a[120:123], v[32:35], v[72:75], a[120:123]
    v_mfma_f32_16x16x32_bf16 a[136:139], v[44:47], v[76:79], a[136:139]
    ds_read_b128 v[72:75], v111 offset:1280
    v_mfma_f32_16x16x32_bf16 a[124:127], v[44:47], v[64:67], a[124:127]
    ds_read2_b32 v[40:41], v105 offset0:192 offset1:193
    v_mfma_f32_16x16x32_bf16 a[124:127], v[32:35], v[76:79], a[124:127]
    ds_read2_b32 v[42:43], v105 offset0:194 offset1:195
    v_mfma_f32_16x16x32_bf16 a[112:115], v[32:35], v[64:67], a[112:115]
    ds_read_b128 v[76:79], v111 offset:1792
    ds_read2_b32 v[44:45], v105 offset0:64 offset1:65
    ds_read2_b32 v[46:47], v105 offset0:66 offset1:67
    s_waitcnt lgkmcnt(15)
    v_mfma_f32_16x16x32_bf16 a[140:143], v[60:63], v[100:103], a[140:143]
    ds_read_b128 v[64:67], v111 offset:192
    v_mfma_f32_16x16x32_bf16 a[140:143], v[96:99], v[92:95], a[140:143]
    ds_read2_b32 v[32:33], v104 offset0:176 offset1:177
    s_waitcnt lgkmcnt(15)
    v_mfma_f32_16x16x32_bf16 a[136:139], v[56:59], v[100:103], a[136:139]
    ds_read2_b32 v[34:35], v104 offset0:178 offset1:179
    v_mfma_f32_16x16x32_bf16 a[136:139], v[96:99], v[88:91], a[136:139]
    ds_read_b128 v[92:95], v111 offset:3776
    s_waitcnt lgkmcnt(10)
    v_mfma_f32_16x16x32_bf16 a[140:143], v[56:59], v[68:71], a[140:143]
    ds_read2_b32 v[60:61], v107 offset0:48 offset1:49
    v_mfma_f32_16x16x32_bf16 a[140:143], v[36:39], v[88:91], a[140:143]
    ds_read2_b32 v[62:63], v107 offset0:50 offset1:51
    s_waitcnt lgkmcnt(15)
    v_mfma_f32_16x16x32_bf16 a[132:135], v[52:55], v[100:103], a[132:135]
    ds_read_b128 v[88:91], v111 offset:3264
    v_mfma_f32_16x16x32_bf16 a[132:135], v[96:99], v[84:87], a[132:135]
    ds_read2_b32 v[56:57], v107 offset0:176 offset1:177
    v_mfma_f32_16x16x32_bf16 a[136:139], v[52:55], v[68:71], a[136:139]
    ds_read2_b32 v[58:59], v107 offset0:178 offset1:179
    v_mfma_f32_16x16x32_bf16 a[136:139], v[36:39], v[84:87], a[136:139]
    s_waitcnt lgkmcnt(12)
    v_mfma_f32_16x16x32_bf16 a[140:143], v[52:55], v[72:75], a[140:143]
    v_mfma_f32_16x16x32_bf16 a[140:143], v[40:43], v[84:87], a[140:143]
    s_waitcnt lgkmcnt(15)
    v_mfma_f32_16x16x32_bf16 a[128:131], v[48:51], v[100:103], a[128:131]
    ds_read_b128 v[84:87], v111 offset:2752
    v_mfma_f32_16x16x32_bf16 a[128:131], v[96:99], v[80:83], a[128:131]
    ds_read2_b32 v[52:53], v106 offset0:48 offset1:49
    v_mfma_f32_16x16x32_bf16 a[132:135], v[48:51], v[68:71], a[132:135]
    ds_read2_b32 v[54:55], v106 offset0:50 offset1:51
    v_mfma_f32_16x16x32_bf16 a[132:135], v[36:39], v[80:83], a[132:135]
    v_mfma_f32_16x16x32_bf16 a[136:139], v[48:51], v[72:75], a[136:139]
    v_mfma_f32_16x16x32_bf16 a[136:139], v[40:43], v[80:83], a[136:139]
    s_waitcnt lgkmcnt(12)
    v_mfma_f32_16x16x32_bf16 a[140:143], v[48:51], v[76:79], a[140:143]
    v_mfma_f32_16x16x32_bf16 a[140:143], v[44:47], v[80:83], a[140:143]
    v_mfma_f32_16x16x32_bf16 a[116:119], v[36:39], v[100:103], a[116:119]
    ds_read_b128 v[80:83], v111 offset:2240
    v_mfma_f32_16x16x32_bf16 a[120:123], v[36:39], v[68:71], a[120:123]
    ds_read2_b32 v[48:49], v106 offset0:176 offset1:177
    v_mfma_f32_16x16x32_bf16 a[124:127], v[36:39], v[72:75], a[124:127]
    ds_read2_b32 v[50:51], v106 offset0:178 offset1:179
    v_mfma_f32_16x16x32_bf16 a[128:131], v[36:39], v[76:79], a[128:131]
    v_mfma_f32_16x16x32_bf16 a[116:119], v[96:99], v[68:71], a[116:119]
    v_mfma_f32_16x16x32_bf16 a[124:127], v[40:43], v[68:71], a[124:127]
    v_mfma_f32_16x16x32_bf16 a[128:131], v[44:47], v[68:71], a[128:131]
    v_mfma_f32_16x16x32_bf16 a[128:131], v[40:43], v[72:75], a[128:131]
    ds_read_b128 v[68:71], v111 offset:704
    v_mfma_f32_16x16x32_bf16 a[132:135], v[40:43], v[76:79], a[132:135]
    ds_read2_b32 v[36:37], v104 offset0:48 offset1:49
    v_mfma_f32_16x16x32_bf16 a[132:135], v[44:47], v[72:75], a[132:135]
    ds_read2_b32 v[38:39], v104 offset0:50 offset1:51
    v_mfma_f32_16x16x32_bf16 a[120:123], v[40:43], v[100:103], a[120:123]
    v_mfma_f32_16x16x32_bf16 a[120:123], v[96:99], v[72:75], a[120:123]
    v_mfma_f32_16x16x32_bf16 a[136:139], v[44:47], v[76:79], a[136:139]
    ds_read_b128 v[72:75], v111 offset:1216
    v_mfma_f32_16x16x32_bf16 a[124:127], v[44:47], v[100:103], a[124:127]
    ds_read2_b32 v[40:41], v105 offset0:176 offset1:177
    v_mfma_f32_16x16x32_bf16 a[124:127], v[96:99], v[76:79], a[124:127]
    ds_read2_b32 v[42:43], v105 offset0:178 offset1:179
    v_mfma_f32_16x16x32_bf16 a[112:115], v[96:99], v[100:103], a[112:115]
    ds_read_b128 v[76:79], v111 offset:1728
    ds_read2_b32 v[44:45], v105 offset0:48 offset1:49
    ds_read2_b32 v[46:47], v105 offset0:50 offset1:51
    s_waitcnt lgkmcnt(15)
    v_mfma_f32_16x16x32_bf16 a[140:143], v[60:63], v[64:67], a[140:143]
    ds_read_b128 v[100:103], v111 offset:128
    v_mfma_f32_16x16x32_bf16 a[140:143], v[32:35], v[92:95], a[140:143]
    ds_read2_b32 v[96:97], v104 offset0:160 offset1:161
    s_waitcnt lgkmcnt(15)
    v_mfma_f32_16x16x32_bf16 a[136:139], v[56:59], v[64:67], a[136:139]
    ds_read2_b32 v[98:99], v104 offset0:162 offset1:163
    v_mfma_f32_16x16x32_bf16 a[136:139], v[32:35], v[88:91], a[136:139]
    ds_read_b128 v[92:95], v111 offset:3712
    s_waitcnt lgkmcnt(10)
    v_mfma_f32_16x16x32_bf16 a[140:143], v[56:59], v[68:71], a[140:143]
    ds_read2_b32 v[60:61], v107 offset0:32 offset1:33
    v_mfma_f32_16x16x32_bf16 a[140:143], v[36:39], v[88:91], a[140:143]
    ds_read2_b32 v[62:63], v107 offset0:34 offset1:35
    s_waitcnt lgkmcnt(15)
    v_mfma_f32_16x16x32_bf16 a[132:135], v[52:55], v[64:67], a[132:135]
    ds_read_b128 v[88:91], v111 offset:3200
    v_mfma_f32_16x16x32_bf16 a[132:135], v[32:35], v[84:87], a[132:135]
    ds_read2_b32 v[56:57], v107 offset0:160 offset1:161
    v_mfma_f32_16x16x32_bf16 a[136:139], v[52:55], v[68:71], a[136:139]
    ds_read2_b32 v[58:59], v107 offset0:162 offset1:163
    v_mfma_f32_16x16x32_bf16 a[136:139], v[36:39], v[84:87], a[136:139]
    s_waitcnt lgkmcnt(12)
    v_mfma_f32_16x16x32_bf16 a[140:143], v[52:55], v[72:75], a[140:143]
    v_mfma_f32_16x16x32_bf16 a[140:143], v[40:43], v[84:87], a[140:143]
    s_waitcnt lgkmcnt(15)
    v_mfma_f32_16x16x32_bf16 a[128:131], v[48:51], v[64:67], a[128:131]
    ds_read_b128 v[84:87], v111 offset:2688
    v_mfma_f32_16x16x32_bf16 a[128:131], v[32:35], v[80:83], a[128:131]
    ds_read2_b32 v[52:53], v106 offset0:32 offset1:33
    v_mfma_f32_16x16x32_bf16 a[132:135], v[48:51], v[68:71], a[132:135]
    ds_read2_b32 v[54:55], v106 offset0:34 offset1:35
    v_mfma_f32_16x16x32_bf16 a[132:135], v[36:39], v[80:83], a[132:135]
    v_mfma_f32_16x16x32_bf16 a[136:139], v[48:51], v[72:75], a[136:139]
    v_mfma_f32_16x16x32_bf16 a[136:139], v[40:43], v[80:83], a[136:139]
    s_waitcnt lgkmcnt(12)
    v_mfma_f32_16x16x32_bf16 a[140:143], v[48:51], v[76:79], a[140:143]
    v_mfma_f32_16x16x32_bf16 a[140:143], v[44:47], v[80:83], a[140:143]
    v_mfma_f32_16x16x32_bf16 a[116:119], v[36:39], v[64:67], a[116:119]
    ds_read_b128 v[80:83], v111 offset:2176
    v_mfma_f32_16x16x32_bf16 a[120:123], v[36:39], v[68:71], a[120:123]
    ds_read2_b32 v[48:49], v106 offset0:160 offset1:161
    v_mfma_f32_16x16x32_bf16 a[124:127], v[36:39], v[72:75], a[124:127]
    ds_read2_b32 v[50:51], v106 offset0:162 offset1:163
    v_mfma_f32_16x16x32_bf16 a[128:131], v[36:39], v[76:79], a[128:131]
    v_mfma_f32_16x16x32_bf16 a[116:119], v[32:35], v[68:71], a[116:119]
    v_mfma_f32_16x16x32_bf16 a[124:127], v[40:43], v[68:71], a[124:127]
    v_mfma_f32_16x16x32_bf16 a[128:131], v[44:47], v[68:71], a[128:131]
    v_mfma_f32_16x16x32_bf16 a[128:131], v[40:43], v[72:75], a[128:131]
    ds_read_b128 v[68:71], v111 offset:640
    v_mfma_f32_16x16x32_bf16 a[132:135], v[40:43], v[76:79], a[132:135]
    ds_read2_b32 v[36:37], v104 offset0:32 offset1:33
    v_mfma_f32_16x16x32_bf16 a[132:135], v[44:47], v[72:75], a[132:135]
    ds_read2_b32 v[38:39], v104 offset0:34 offset1:35
    v_mfma_f32_16x16x32_bf16 a[120:123], v[40:43], v[64:67], a[120:123]
    v_mfma_f32_16x16x32_bf16 a[120:123], v[32:35], v[72:75], a[120:123]
    v_mfma_f32_16x16x32_bf16 a[136:139], v[44:47], v[76:79], a[136:139]
    ds_read_b128 v[72:75], v111 offset:1152
    v_mfma_f32_16x16x32_bf16 a[124:127], v[44:47], v[64:67], a[124:127]
    ds_read2_b32 v[40:41], v105 offset0:160 offset1:161
    v_mfma_f32_16x16x32_bf16 a[124:127], v[32:35], v[76:79], a[124:127]
    ds_read2_b32 v[42:43], v105 offset0:162 offset1:163
    v_mfma_f32_16x16x32_bf16 a[112:115], v[32:35], v[64:67], a[112:115]
    ds_read_b128 v[76:79], v111 offset:1664
    ds_read2_b32 v[44:45], v105 offset0:32 offset1:33
    ds_read2_b32 v[46:47], v105 offset0:34 offset1:35
    s_waitcnt lgkmcnt(15)
    v_mfma_f32_16x16x32_bf16 a[140:143], v[60:63], v[100:103], a[140:143]
    ds_read_b128 v[64:67], v111 offset:64
    v_mfma_f32_16x16x32_bf16 a[140:143], v[96:99], v[92:95], a[140:143]
    ds_read2_b32 v[32:33], v104 offset0:144 offset1:145
    s_waitcnt lgkmcnt(15)
    v_mfma_f32_16x16x32_bf16 a[136:139], v[56:59], v[100:103], a[136:139]
    ds_read2_b32 v[34:35], v104 offset0:146 offset1:147
    v_mfma_f32_16x16x32_bf16 a[136:139], v[96:99], v[88:91], a[136:139]
    ds_read_b128 v[92:95], v111 offset:3648
    s_waitcnt lgkmcnt(10)
    v_mfma_f32_16x16x32_bf16 a[140:143], v[56:59], v[68:71], a[140:143]
    ds_read2_b32 v[60:61], v107 offset0:16 offset1:17
    v_mfma_f32_16x16x32_bf16 a[140:143], v[36:39], v[88:91], a[140:143]
    ds_read2_b32 v[62:63], v107 offset0:18 offset1:19
    s_waitcnt lgkmcnt(15)
    v_mfma_f32_16x16x32_bf16 a[132:135], v[52:55], v[100:103], a[132:135]
    ds_read_b128 v[88:91], v111 offset:3136
    v_mfma_f32_16x16x32_bf16 a[132:135], v[96:99], v[84:87], a[132:135]
    ds_read2_b32 v[56:57], v107 offset0:144 offset1:145
    v_mfma_f32_16x16x32_bf16 a[136:139], v[52:55], v[68:71], a[136:139]
    ds_read2_b32 v[58:59], v107 offset0:146 offset1:147
    v_mfma_f32_16x16x32_bf16 a[136:139], v[36:39], v[84:87], a[136:139]
    s_waitcnt lgkmcnt(12)
    v_mfma_f32_16x16x32_bf16 a[140:143], v[52:55], v[72:75], a[140:143]
    v_mfma_f32_16x16x32_bf16 a[140:143], v[40:43], v[84:87], a[140:143]
    s_waitcnt lgkmcnt(15)
    v_mfma_f32_16x16x32_bf16 a[128:131], v[48:51], v[100:103], a[128:131]
    ds_read_b128 v[84:87], v111 offset:2624
    v_mfma_f32_16x16x32_bf16 a[128:131], v[96:99], v[80:83], a[128:131]
    ds_read2_b32 v[52:53], v106 offset0:16 offset1:17
    v_mfma_f32_16x16x32_bf16 a[132:135], v[48:51], v[68:71], a[132:135]
    ds_read2_b32 v[54:55], v106 offset0:18 offset1:19
    v_mfma_f32_16x16x32_bf16 a[132:135], v[36:39], v[80:83], a[132:135]
    v_mfma_f32_16x16x32_bf16 a[136:139], v[48:51], v[72:75], a[136:139]
    v_mfma_f32_16x16x32_bf16 a[136:139], v[40:43], v[80:83], a[136:139]
    s_waitcnt lgkmcnt(12)
    v_mfma_f32_16x16x32_bf16 a[140:143], v[48:51], v[76:79], a[140:143]
    v_mfma_f32_16x16x32_bf16 a[140:143], v[44:47], v[80:83], a[140:143]
    v_mfma_f32_16x16x32_bf16 a[116:119], v[36:39], v[100:103], a[116:119]
    ds_read_b128 v[80:83], v111 offset:2112
    v_mfma_f32_16x16x32_bf16 a[120:123], v[36:39], v[68:71], a[120:123]
    ds_read2_b32 v[48:49], v106 offset0:144 offset1:145
    v_mfma_f32_16x16x32_bf16 a[124:127], v[36:39], v[72:75], a[124:127]
    ds_read2_b32 v[50:51], v106 offset0:146 offset1:147
    v_mfma_f32_16x16x32_bf16 a[128:131], v[36:39], v[76:79], a[128:131]
    v_mfma_f32_16x16x32_bf16 a[116:119], v[96:99], v[68:71], a[116:119]
    v_mfma_f32_16x16x32_bf16 a[124:127], v[40:43], v[68:71], a[124:127]
    v_mfma_f32_16x16x32_bf16 a[128:131], v[44:47], v[68:71], a[128:131]
    v_mfma_f32_16x16x32_bf16 a[128:131], v[40:43], v[72:75], a[128:131]
    ds_read_b128 v[68:71], v111 offset:576
    v_mfma_f32_16x16x32_bf16 a[132:135], v[40:43], v[76:79], a[132:135]
    ds_read2_b32 v[36:37], v104 offset0:16 offset1:17
    v_mfma_f32_16x16x32_bf16 a[132:135], v[44:47], v[72:75], a[132:135]
    ds_read2_b32 v[38:39], v104 offset0:18 offset1:19
    v_mfma_f32_16x16x32_bf16 a[120:123], v[40:43], v[100:103], a[120:123]
    v_mfma_f32_16x16x32_bf16 a[120:123], v[96:99], v[72:75], a[120:123]
    v_mfma_f32_16x16x32_bf16 a[136:139], v[44:47], v[76:79], a[136:139]
    ds_read_b128 v[72:75], v111 offset:1088
    v_mfma_f32_16x16x32_bf16 a[124:127], v[44:47], v[100:103], a[124:127]
    ds_read2_b32 v[40:41], v105 offset0:144 offset1:145
    v_mfma_f32_16x16x32_bf16 a[124:127], v[96:99], v[76:79], a[124:127]
    ds_read2_b32 v[42:43], v105 offset0:146 offset1:147
    v_mfma_f32_16x16x32_bf16 a[112:115], v[96:99], v[100:103], a[112:115]
    ds_read_b128 v[76:79], v111 offset:1600
    ds_read2_b32 v[44:45], v105 offset0:16 offset1:17
    ds_read2_b32 v[46:47], v105 offset0:18 offset1:19
    s_mov_b32 s77, 3200000
cw_66:
    ds_read_b32 v26, v5 offset:64
    s_waitcnt lgkmcnt(0)
    v_cmp_gt_u32 vcc, 4, v26
    s_cbranch_vccz cwo_67
    s_sleep 1
    s_sub_u32 s77, s77, 1
    s_cmp_lg_u32 s77, 0
    s_cbranch_scc1 cw_66
cwo_67:
    s_waitcnt vmcnt(0)
    s_waitcnt lgkmcnt(15)
    v_mfma_f32_16x16x32_bf16 a[140:143], v[60:63], v[64:67], a[140:143]
    ds_read_b128 v[100:103], v111 offset:0
    ds_read_b128 a[0:3], v108 offset:0
    v_mfma_f32_16x16x32_bf16 a[140:143], v[32:35], v[92:95], a[140:143]
    ds_read2_b32 v[96:97], v104 offset0:128 offset1:129
    ds_read_b128 a[4:7], v108 offset:1024
    s_waitcnt lgkmcnt(15)
    v_mfma_f32_16x16x32_bf16 a[136:139], v[56:59], v[64:67], a[136:139]
    ds_read2_b32 v[98:99], v104 offset0:130 offset1:131
    ds_read_b128 a[8:11], v108 offset:2048
    v_mfma_f32_16x16x32_bf16 a[136:139], v[32:35], v[88:91], a[136:139]
    ds_read_b128 v[92:95], v111 offset:3584
    ds_read_b128 a[12:15], v108 offset:3072
    s_waitcnt lgkmcnt(14)
    v_mfma_f32_16x16x32_bf16 a[140:143], v[56:59], v[68:71], a[140:143]
    ds_read2_b32 v[60:61], v107 offset0:0 offset1:1
    ds_read_b128 a[16:19], v109 offset:0
    v_mfma_f32_16x16x32_bf16 a[140:143], v[36:39], v[88:91], a[140:143]
    ds_read2_b32 v[62:63], v107 offset0:2 offset1:3
    ds_read_b128 a[20:23], v109 offset:1024
    s_waitcnt lgkmcnt(15)
    v_mfma_f32_16x16x32_bf16 a[132:135], v[52:55], v[64:67], a[132:135]
    ds_read_b128 v[88:91], v111 offset:3072
    ds_read_b128 a[24:27], v31 offset:0
    v_mfma_f32_16x16x32_bf16 a[132:135], v[32:35], v[84:87], a[132:135]
    ds_read2_b32 v[56:57], v107 offset0:128 offset1:129
    ds_read_b128 a[28:31], v31 offset:1024
    v_mfma_f32_16x16x32_bf16 a[136:139], v[52:55], v[68:71], a[136:139]
    ds_read2_b32 v[58:59], v107 offset0:130 offset1:131
    ds_read_b128 a[32:35], v31 offset:2048
    v_mfma_f32_16x16x32_bf16 a[136:139], v[36:39], v[84:87], a[136:139]
    ds_read_b128 a[36:39], v31 offset:3072
    s_waitcnt lgkmcnt(15)
    v_mfma_f32_16x16x32_bf16 a[140:143], v[52:55], v[72:75], a[140:143]
    ds_read_b128 a[40:43], v31 offset:4096
    v_mfma_f32_16x16x32_bf16 a[140:143], v[40:43], v[84:87], a[140:143]
    ds_read_b128 a[44:47], v31 offset:5120
    s_waitcnt lgkmcnt(15)
    v_mfma_f32_16x16x32_bf16 a[128:131], v[48:51], v[64:67], a[128:131]
    ds_read_b128 v[84:87], v111 offset:2560
    ds_read_b128 a[48:51], v31 offset:6144
    v_mfma_f32_16x16x32_bf16 a[128:131], v[32:35], v[80:83], a[128:131]
    ds_read2_b32 v[52:53], v106 offset0:0 offset1:1
    ds_read_b128 a[52:55], v31 offset:7168
    v_mfma_f32_16x16x32_bf16 a[132:135], v[48:51], v[68:71], a[132:135]
    ds_read2_b32 v[54:55], v106 offset0:2 offset1:3
    ds_read_b128 a[56:59], v110 offset:0
    v_mfma_f32_16x16x32_bf16 a[132:135], v[36:39], v[80:83], a[132:135]
    ds_read_b128 a[60:63], v110 offset:1024
    v_mfma_f32_16x16x32_bf16 a[136:139], v[48:51], v[72:75], a[136:139]
    ds_read_b128 a[64:67], v110 offset:2048
    v_mfma_f32_16x16x32_bf16 a[136:139], v[40:43], v[80:83], a[136:139]
    ds_read_b128 a[68:71], v110 offset:3072
    s_waitcnt lgkmcnt(15)
    v_mfma_f32_16x16x32_bf16 a[140:143], v[48:51], v[76:79], a[140:143]
    ds_read_b128 a[72:75], v110 offset:4096
    v_mfma_f32_16x16x32_bf16 a[140:143], v[44:47], v[80:83], a[140:143]
    ds_read_b128 a[76:79], v110 offset:5120
    v_mfma_f32_16x16x32_bf16 a[116:119], v[36:39], v[64:67], a[116:119]
    ds_read_b128 v[80:83], v111 offset:2048
    ds_read_b128 a[80:83], v110 offset:6144
    v_mfma_f32_16x16x32_bf16 a[120:123], v[36:39], v[68:71], a[120:123]
    ds_read2_b32 v[48:49], v106 offset0:128 offset1:129
    ds_read_b128 a[84:87], v110 offset:7168
    v_mfma_f32_16x16x32_bf16 a[124:127], v[36:39], v[72:75], a[124:127]
    ds_read2_b32 v[50:51], v106 offset0:130 offset1:131
    v_mov_b32 v26, 1
    s_mov_b64 exec, 1
    ds_add_u32 v5, v26 offset:100
    s_mov_b64 exec, -1
    v_mfma_f32_16x16x32_bf16 a[128:131], v[36:39], v[76:79], a[128:131]
    v_mfma_f32_16x16x32_bf16 a[116:119], v[32:35], v[68:71], a[116:119]
    v_mfma_f32_16x16x32_bf16 a[124:127], v[40:43], v[68:71], a[124:127]
    v_mfma_f32_16x16x32_bf16 a[128:131], v[44:47], v[68:71], a[128:131]
    v_mfma_f32_16x16x32_bf16 a[128:131], v[40:43], v[72:75], a[128:131]
    ds_read_b128 v[68:71], v111 offset:512
    v_mfma_f32_16x16x32_bf16 a[132:135], v[40:43], v[76:79], a[132:135]
    ds_read2_b32 v[36:37], v104 offset0:0 offset1:1
    v_mfma_f32_16x16x32_bf16 a[132:135], v[44:47], v[72:75], a[132:135]
    ds_read2_b32 v[38:39], v104 offset0:2 offset1:3
    v_mfma_f32_16x16x32_bf16 a[120:123], v[40:43], v[64:67], a[120:123]
    v_mfma_f32_16x16x32_bf16 a[120:123], v[32:35], v[72:75], a[120:123]
    v_mfma_f32_16x16x32_bf16 a[136:139], v[44:47], v[76:79], a[136:139]
    ds_read_b128 v[72:75], v111 offset:1024
    v_mfma_f32_16x16x32_bf16 a[124:127], v[44:47], v[64:67], a[124:127]
    ds_read2_b32 v[40:41], v105 offset0:128 offset1:129
    v_mfma_f32_16x16x32_bf16 a[124:127], v[32:35], v[76:79], a[124:127]
    ds_read2_b32 v[42:43], v105 offset0:130 offset1:131
    v_mfma_f32_16x16x32_bf16 a[112:115], v[32:35], v[64:67], a[112:115]
    ds_read_b128 v[76:79], v111 offset:1536
    ds_read2_b32 v[44:45], v105 offset0:0 offset1:1
    ds_read2_b32 v[46:47], v105 offset0:2 offset1:3
    s_waitcnt lgkmcnt(15)
    v_mfma_f32_16x16x32_bf16 a[140:143], v[60:63], v[100:103], a[140:143]
    v_mfma_f32_16x16x32_bf16 a[140:143], v[96:99], v[92:95], a[140:143]
    s_waitcnt lgkmcnt(15)
    v_mfma_f32_16x16x32_bf16 a[136:139], v[56:59], v[100:103], a[136:139]
    v_mfma_f32_16x16x32_bf16 a[136:139], v[96:99], v[88:91], a[136:139]
    s_waitcnt lgkmcnt(6)
    v_mfma_f32_16x16x32_bf16 a[140:143], v[56:59], v[68:71], a[140:143]
    v_mfma_f32_16x16x32_bf16 a[140:143], v[36:39], v[88:91], a[140:143]
    s_waitcnt lgkmcnt(15)
    v_mfma_f32_16x16x32_bf16 a[132:135], v[52:55], v[100:103], a[132:135]
    v_mfma_f32_16x16x32_bf16 a[132:135], v[96:99], v[84:87], a[132:135]
    v_mfma_f32_16x16x32_bf16 a[136:139], v[52:55], v[68:71], a[136:139]
    v_mfma_f32_16x16x32_bf16 a[136:139], v[36:39], v[84:87], a[136:139]
    s_waitcnt lgkmcnt(3)
    v_mfma_f32_16x16x32_bf16 a[140:143], v[52:55], v[72:75], a[140:143]
    v_mfma_f32_16x16x32_bf16 a[140:143], v[40:43], v[84:87], a[140:143]
    s_waitcnt lgkmcnt(10)
    v_mfma_f32_16x16x32_bf16 a[128:131], v[48:51], v[100:103], a[128:131]
    v_mfma_f32_16x16x32_bf16 a[128:131], v[96:99], v[80:83], a[128:131]
    v_mfma_f32_16x16x32_bf16 a[132:135], v[48:51], v[68:71], a[132:135]
    v_mfma_f32_16x16x32_bf16 a[132:135], v[36:39], v[80:83], a[132:135]
    v_mfma_f32_16x16x32_bf16 a[136:139], v[48:51], v[72:75], a[136:139]
    v_mfma_f32_16x16x32_bf16 a[136:139], v[40:43], v[80:83], a[136:139]
    s_waitcnt lgkmcnt(0)
    v_mfma_f32_16x16x32_bf16 a[140:143], v[48:51], v[76:79], a[140:143]
    v_mfma_f32_16x16x32_bf16 a[140:143], v[44:47], v[80:83], a[140:143]
    v_mfma_f32_16x16x32_bf16 a[116:119], v[36:39], v[100:103], a[116:119]
    v_mfma_f32_16x16x32_bf16 a[120:123], v[36:39], v[68:71], a[120:123]
    v_mfma_f32_16x16x32_bf16 a[124:127], v[36:39], v[72:75], a[124:127]
    v_mfma_f32_16x16x32_bf16 a[128:131], v[36:39], v[76:79], a[128:131]
    v_mfma_f32_16x16x32_bf16 a[116:119], v[96:99], v[68:71], a[116:119]
    v_mfma_f32_16x16x32_bf16 a[124:127], v[40:43], v[68:71], a[124:127]
    v_mfma_f32_16x16x32_bf16 a[128:131], v[44:47], v[68:71], a[128:131]
    v_mfma_f32_16x16x32_bf16 a[128:131], v[40:43], v[72:75], a[128:131]
    v_mfma_f32_16x16x32_bf16 a[132:135], v[40:43], v[76:79], a[132:135]
    v_mfma_f32_16x16x32_bf16 a[132:135], v[44:47], v[72:75], a[132:135]
    v_mfma_f32_16x16x32_bf16 a[120:123], v[40:43], v[100:103], a[120:123]
    v_mfma_f32_16x16x32_bf16 a[120:123], v[96:99], v[72:75], a[120:123]
    v_mfma_f32_16x16x32_bf16 a[136:139], v[44:47], v[76:79], a[136:139]
    v_mfma_f32_16x16x32_bf16 a[124:127], v[44:47], v[100:103], a[124:127]
    v_mfma_f32_16x16x32_bf16 a[124:127], v[96:99], v[76:79], a[124:127]
    v_mfma_f32_16x16x32_bf16 a[112:115], v[96:99], v[100:103], a[112:115]
    v_lshlrev_b32 v104, 5, v1
    v_lshl_add_u32 v104, v2, 3, v104
    s_add_u32 s60, s36, 504
    v_sub_u32 v104, s60, v104
    ds_read_b64 v[32:33], v104 offset:3584
    ds_read_b64 v[34:35], v104 offset:3072
    ds_read_b64 v[36:37], v104 offset:2560
    ds_read_b64 v[38:39], v104 offset:2048
    ds_read_b64 v[40:41], v104 offset:1536
    ds_read_b64 v[42:43], v104 offset:1024
    ds_read_b64 v[44:45], v104 offset:512
    ds_read_b64 v[46:47], v104 offset:0
    v_and_b32 v105, 1, v2
    v_lshlrev_b32 v105, 9, v105
    v_lshl_add_u32 v105, v1, 5, v105
    v_lshrrev_b32 v106, 1, v2
    v_lshl_add_u32 v105, v106, 4, v105
    s_mov_b32 s61, 0x3f803f80
    s_waitcnt lgkmcnt(0)
    v_dot2_f32_bf16 v48, v33, v29, 0
    v_dot2_f32_bf16 v49, v33, v28, 0
    v_dot2_f32_bf16 v50, v32, v29, 0
    v_dot2_f32_bf16 v51, v32, v28, 0
    v_dot2_f32_bf16 v52, v35, v29, 0
    v_dot2_f32_bf16 v53, v35, v28, 0
    v_dot2_f32_bf16 v54, v34, v29, 0
    v_dot2_f32_bf16 v55, v34, v28, 0
    v_dot2_f32_bf16 v56, v37, v29, 0
    v_dot2_f32_bf16 v57, v37, v28, 0
    v_dot2_f32_bf16 v58, v36, v29, 0
    v_dot2_f32_bf16 v59, v36, v28, 0
    v_dot2_f32_bf16 v60, v39, v29, 0
    v_dot2_f32_bf16 v61, v39, v28, 0
    v_dot2_f32_bf16 v62, v38, v29, 0
    v_dot2_f32_bf16 v63, v38, v28, 0
    v_dot2_f32_bf16 v64, v41, v29, 0
    v_dot2_f32_bf16 v65, v41, v28, 0
    v_dot2_f32_bf16 v66, v40, v29, 0
    v_dot2_f32_bf16 v67, v40, v28, 0
    v_dot2_f32_bf16 v68, v43, v29, 0
    v_dot2_f32_bf16 v69, v43, v28, 0
    v_dot2_f32_bf16 v70, v42, v29, 0
    v_dot2_f32_bf16 v71, v42, v28, 0
    v_dot2_f32_bf16 v72, v45, v29, 0
    v_dot2_f32_bf16 v73, v45, v28, 0
    v_dot2_f32_bf16 v74, v44, v29, 0
    v_dot2_f32_bf16 v75, v44, v28, 0
    v_dot2_f32_bf16 v76, v47, v29, 0
    v_dot2_f32_bf16 v77, v47, v28, 0
    v_dot2_f32_bf16 v78, v46, v29, 0
    v_dot2_f32_bf16 v79, v46, v28, 0
    v_accvgpr_read_b32 v80, a112
    v_accvgpr_read_b32 v81, a113
    v_accvgpr_read_b32 v82, a114
    v_accvgpr_read_b32 v83, a115
    v_accvgpr_read_b32 v84, a116
    v_accvgpr_read_b32 v85, a117
    v_accvgpr_read_b32 v86, a118
    v_accvgpr_read_b32 v87, a119
    v_accvgpr_read_b32 v88, a120
    v_accvgpr_read_b32 v89, a121
    v_accvgpr_read_b32 v90, a122
    v_accvgpr_read_b32 v91, a123
    v_accvgpr_read_b32 v92, a124
    v_accvgpr_read_b32 v93, a125
    v_accvgpr_read_b32 v94, a126
    v_accvgpr_read_b32 v95, a127
    v_cvt_pk_bf16_f32 v48, v80, v48
    v_cvt_pk_bf16_f32 v49, v81, v49
    v_cvt_pk_bf16_f32 v50, v82, v50
    v_cvt_pk_bf16_f32 v51, v83, v51
    v_cvt_pk_bf16_f32 v52, v84, v52
    v_cvt_pk_bf16_f32 v53, v85, v53
    v_cvt_pk_bf16_f32 v54, v86, v54
    v_cvt_pk_bf16_f32 v55, v87, v55
    v_cvt_pk_bf16_f32 v56, v88, v56
    v_cvt_pk_bf16_f32 v57, v89, v57
    v_cvt_pk_bf16_f32 v58, v90, v58
    v_cvt_pk_bf16_f32 v59, v91, v59
    v_cvt_pk_bf16_f32 v60, v92, v60
    v_cvt_pk_bf16_f32 v61, v93, v61
    v_cvt_pk_bf16_f32 v62, v94, v62
    v_cvt_pk_bf16_f32 v63, v95, v63
    v_accvgpr_read_b32 v80, a128
    v_accvgpr_read_b32 v81, a129
    v_accvgpr_read_b32 v82, a130
    v_accvgpr_read_b32 v83, a131
    v_accvgpr_read_b32 v84, a132
    v_accvgpr_read_b32 v85, a133
    v_accvgpr_read_b32 v86, a134
    v_accvgpr_read_b32 v87, a135
    v_accvgpr_read_b32 v88, a136
    v_accvgpr_read_b32 v89, a137
    v_accvgpr_read_b32 v90, a138
    v_accvgpr_read_b32 v91, a139
    v_accvgpr_read_b32 v92, a140
    v_accvgpr_read_b32 v93, a141
    v_accvgpr_read_b32 v94, a142
    v_accvgpr_read_b32 v95, a143
    v_cvt_pk_bf16_f32 v64, v80, v64
    v_cvt_pk_bf16_f32 v65, v81, v65
    v_cvt_pk_bf16_f32 v66, v82, v66
    v_cvt_pk_bf16_f32 v67, v83, v67
    v_cvt_pk_bf16_f32 v68, v84, v68
    v_cvt_pk_bf16_f32 v69, v85, v69
    v_cvt_pk_bf16_f32 v70, v86, v70
    v_cvt_pk_bf16_f32 v71, v87, v71
    v_cvt_pk_bf16_f32 v72, v88, v72
    v_cvt_pk_bf16_f32 v73, v89, v73
    v_cvt_pk_bf16_f32 v74, v90, v74
    v_cvt_pk_bf16_f32 v75, v91, v75
    v_cvt_pk_bf16_f32 v76, v92, v76
    v_cvt_pk_bf16_f32 v77, v93, v77
    v_cvt_pk_bf16_f32 v78, v94, v78
    v_cvt_pk_bf16_f32 v79, v95, v79
    v_dot2_f32_bf16 v48, v48, s61, 0
    v_dot2_f32_bf16 v49, v49, s61, 0
    v_dot2_f32_bf16 v50, v50, s61, 0
    v_dot2_f32_bf16 v51, v51, s61, 0
    v_dot2_f32_bf16 v52, v52, s61, 0
    v_dot2_f32_bf16 v53, v53, s61, 0
    v_dot2_f32_bf16 v54, v54, s61, 0
    v_dot2_f32_bf16 v55, v55, s61, 0
    v_dot2_f32_bf16 v56, v56, s61, 0
    v_dot2_f32_bf16 v57, v57, s61, 0
    v_dot2_f32_bf16 v58, v58, s61, 0
    v_dot2_f32_bf16 v59, v59, s61, 0
    v_dot2_f32_bf16 v60, v60, s61, 0
    v_dot2_f32_bf16 v61, v61, s61, 0
    v_dot2_f32_bf16 v62, v62, s61, 0
    v_dot2_f32_bf16 v63, v63, s61, 0
    v_dot2_f32_bf16 v64, v64, s61, 0
    v_dot2_f32_bf16 v65, v65, s61, 0
    v_dot2_f32_bf16 v66, v66, s61, 0
    v_dot2_f32_bf16 v67, v67, s61, 0
    v_dot2_f32_bf16 v68, v68, s61, 0
    v_dot2_f32_bf16 v69, v69, s61, 0
    v_dot2_f32_bf16 v70, v70, s61, 0
    v_dot2_f32_bf16 v71, v71, s61, 0
    v_dot2_f32_bf16 v72, v72, s61, 0
    v_dot2_f32_bf16 v73, v73, s61, 0
    v_dot2_f32_bf16 v74, v74, s61, 0
    v_dot2_f32_bf16 v75, v75, s61, 0
    v_dot2_f32_bf16 v76, v76, s61, 0
    v_dot2_f32_bf16 v77, v77, s61, 0
    v_dot2_f32_bf16 v78, v78, s61, 0
    v_dot2_f32_bf16 v79, v79, s61, 0
    v_cvt_pk_bf16_f32 v32, v48, v49
    v_cvt_pk_bf16_f32 v33, v50, v51
    v_cvt_pk_bf16_f32 v34, v52, v53
    v_cvt_pk_bf16_f32 v35, v54, v55
    v_cvt_pk_bf16_f32 v36, v56, v57
    v_cvt_pk_bf16_f32 v37, v58, v59
    v_cvt_pk_bf16_f32 v38, v60, v61
    v_cvt_pk_bf16_f32 v39, v62, v63
    v_cvt_pk_bf16_f32 v40, v64, v65
    v_cvt_pk_bf16_f32 v41, v66, v67
    v_cvt_pk_bf16_f32 v42, v68, v69
    v_cvt_pk_bf16_f32 v43, v70, v71
    v_cvt_pk_bf16_f32 v44, v72, v73
    v_cvt_pk_bf16_f32 v45, v74, v75
    v_cvt_pk_bf16_f32 v46, v76, v77
    v_cvt_pk_bf16_f32 v47, v78, v79
    v_permlane16_swap_b32 v32, v34
    v_permlane16_swap_b32 v33, v35
    v_permlane16_swap_b32 v36, v38
    v_permlane16_swap_b32 v37, v39
    v_permlane16_swap_b32 v40, v42
    v_permlane16_swap_b32 v41, v43
    v_permlane16_swap_b32 v44, v46
    v_permlane16_swap_b32 v45, v47
    s_add_u32 s60, s67, 16777216
    buffer_store_dwordx4 v[32:35], v105, s[4:7], s60 offen offset:0 sc1
    buffer_store_dwordx4 v[36:39], v105, s[4:7], s60 offen offset:1024 sc1
    buffer_store_dwordx4 v[40:43], v105, s[4:7], s60 offen offset:2048 sc1
    buffer_store_dwordx4 v[44:47], v105, s[4:7], s60 offen offset:3072 sc1
    s_branch L_xres
L_t8:
    s_cmp_lg_u32 s56, 0
    s_cbranch_scc1 L_x1
    s_mov_b32 s77, 3200000
cw_68:
    ds_read_b32 v106, v5 offset:80
    s_waitcnt lgkmcnt(0)
    v_cmp_gt_u32 vcc, 4, v106
    s_cbranch_vccz cwo_69
    s_sleep 1
    s_sub_u32 s77, s77, 1
    s_cmp_lg_u32 s77, 0
    s_cbranch_scc1 cw_68
cwo_69:
    s_lshl_b32 s62, s52, 7
    s_add_u32 s62, s62, 22077440
    v_and_b32 v68, 7, v0
    v_lshlrev_b32 v68, 3, v68
    buffer_load_dwordx2 v[70:71], v68, s[4:7], s62 offen sc1
L_x1:
    s_mul_i32 s60, s56, 524288
    s_andn2_b32 s61, s58, 6144
    s_add_u32 s60, s60, s61
    v_lshlrev_b32 v67, 11, v2
    v_lshl_add_u32 v67, v1, 4, v67
    s_lshl_b32 s61, s55, 4
    s_cmp_eq_u32 s56, 0
    s_cbranch_scc1 L_x3
    s_barrier
    s_barrier
L_x3:
    buffer_load_dwordx4 v[32:35], v67, s[4:7], s60 offen offset:0 sc1
    buffer_load_dwordx4 v[36:39], v67, s[4:7], s60 offen offset:256 sc1
    buffer_load_dwordx4 v[40:43], v67, s[4:7], s60 offen offset:512 sc1
    buffer_load_dwordx4 v[44:47], v67, s[4:7], s60 offen offset:768 sc1
    buffer_load_dwordx4 v[48:51], v67, s[4:7], s60 offen offset:1024 sc1
    buffer_load_dwordx4 v[52:55], v67, s[4:7], s60 offen offset:1280 sc1
    buffer_load_dwordx4 v[56:59], v67, s[4:7], s60 offen offset:1536 sc1
    buffer_load_dwordx4 v[60:63], v67, s[4:7], s60 offen offset:1792 sc1
    s_cmp_eq_u32 s56, 0
    s_cbranch_scc1 L_x4
    s_barrier
    s_barrier
L_x4:
    s_mov_b32 s77, 400000
    s_branch pchk_st13_72
poll_st13_70:
    buffer_load_dwordx4 v[32:35], v67, s[4:7], s60 offen offset:0 sc1
    buffer_load_dwordx4 v[36:39], v67, s[4:7], s60 offen offset:256 sc1
    buffer_load_dwordx4 v[40:43], v67, s[4:7], s60 offen offset:512 sc1
    buffer_load_dwordx4 v[44:47], v67, s[4:7], s60 offen offset:768 sc1
    buffer_load_dwordx4 v[48:51], v67, s[4:7], s60 offen offset:1024 sc1
    buffer_load_dwordx4 v[52:55], v67, s[4:7], s60 offen offset:1280 sc1
    buffer_load_dwordx4 v[56:59], v67, s[4:7], s60 offen offset:1536 sc1
    buffer_load_dwordx4 v[60:63], v67, s[4:7], s60 offen offset:1792 sc1
pchk_st13_72:
    s_waitcnt vmcnt(0)
    v_add_u32 v106, v33, v35
    v_add3_u32 v106, v37, v39, v106
    v_add3_u32 v106, v41, v43, v106
    v_add3_u32 v106, v45, v47, v106
    v_add3_u32 v106, v49, v51, v106
    v_add3_u32 v106, v53, v55, v106
    v_add3_u32 v106, v57, v59, v106
    v_add3_u32 v106, v61, v63, v106
    v_cmp_ne_u32 vcc, s61, v106
    s_cbranch_vccz pout_st13_71
    s_mov_b64 exec, vcc
    s_sleep 3
    s_sub_u32 s77, s77, 1
    s_cmp_lg_u32 s77, 0
    s_cbranch_scc1 poll_st13_70
pout_st13_71:
    s_mov_b64 exec, -1
    v_add_f32 v32, v32, v36
    v_add_f32 v34, v34, v38
    v_add_f32 v32, v32, v40
    v_add_f32 v34, v34, v42
    v_add_f32 v32, v32, v44
    v_add_f32 v34, v34, v46
    v_add_f32 v32, v32, v48
    v_add_f32 v34, v34, v50
    v_add_f32 v32, v32, v52
    v_add_f32 v34, v34, v54
    v_add_f32 v32, v32, v56
    v_add_f32 v34, v34, v58
    v_add_f32 v32, v32, v60
    v_add_f32 v34, v34, v62
    v_mul_f32 v32, 0x3ae38e39, v32
    v_mul_f32 v34, 0x3ae38e39, v34
    v_fma_f32 v34, -v32, v32, v34
    v_max_f32 v34, 0, v34
    s_cmp_lg_u32 s56, 0
    s_cbranch_scc1 L_ln3
    s_mov_b32 s77, 400000
    s_branch pchk_xc_75
poll_xc_73:
    buffer_load_dwordx2 v[70:71], v68, s[4:7], s62 offen sc1
pchk_xc_75:
    s_waitcnt vmcnt(0)
    v_cmp_ne_u32 vcc, s55, v70
    s_cbranch_vccz pout_xc_74
    s_sleep 3
    s_sub_u32 s77, s77, 1
    s_cmp_lg_u32 s77, 0
    s_cbranch_scc1 poll_xc_73
pout_xc_74:
    v_cmp_ne_u32 s[62:63], s31, v71
    s_nop 0
    s_or_b64 vcc, vcc, s[62:63]
    s_cmp_eq_u64 vcc, 0
    s_cselect_b32 s30, 1, 0
    v_mov_b32 v69, s30
    ds_write_b32 v5, v69 offset:128
    v_cvt_pk_bf16_f32 v32, v32, 0
    v_lshlrev_b32 v32, 16, v32
    v_cvt_pk_bf16_f32 v34, v34, 0
    v_lshlrev_b32 v34, 16, v34
    v_add_f32 v34, 0x3727c5ac, v34
    v_cvt_pk_bf16_f32 v34, v34, 0
    v_lshlrev_b32 v34, 16, v34
    v_sqrt_f32 v34, v34
    s_nop 0
    v_cvt_pk_bf16_f32 v34, v34, 0
    v_lshlrev_b32 v34, 16, v34
    v_rcp_f32 v36, v34
    s_branch L_lnj
L_ln3:
    v_add_f32 v34, 0x3727c5ac, v34
    v_rsq_f32 v36, v34
L_lnj:
    v_lshlrev_b32 v38, 3, v0
    v_mul_f32 v37, v32, v36
    v_add_u32 v38, 151808, v38
    ds_write_b64 v38, v[36:37]
    v_lshlrev_b32 v39, 2, v0
    v_add_u32 v39, 163456, v39
    ds_write_b32 v39, v32
    v_mov_b32 v106, 1
    s_mov_b64 exec, 1
    ds_add_u32 v5, v106 offset:24
    s_mov_b64 exec, -1
    s_cmp_lg_u32 s56, 0
    s_cbranch_scc1 L_x6
    s_xor_b32 s60, s37, 0
    s_mul_i32 s60, s60, 18432
    s_add_u32 s60, s60, s65
    v_and_b32 v40, 3, v0
    v_lshrrev_b32 v41, 2, v0
    v_mul_u32_u24 v41, 1152, v41
    v_lshl_add_u32 v40, v40, 7, v41
    buffer_load_dword a0, v40, s[72:75], s60 offen
    buffer_load_dword a1, v41, s[72:75], s60 offen offset:512
    s_mul_i32 s60, s37, 2304
    s_add_u32 s60, s60, s41
    s_mov_b64 exec, 0xff
    buffer_load_dword a2, v40, s[72:75], s60 offen
    buffer_load_dword a3, v41, s[72:75], s60 offen offset:512
    s_mov_b64 exec, -1
L_x6:
    s_lshl_b32 s60, s56, 3
    s_add_u32 s60, s60, s2
    s_mul_i32 s60, s60, 36864
    s_add_u32 s60, s60, 19922944
    s_add_u32 s8, s50, s60
    s_addc_u32 s9, s51, 0
    s_mov_b32 s10, 36864
    s_mov_b32 s11, 0x20000
    s_sub_u32 s60, 31, s52
    s_mul_i32 s34, s60, 1152
    s_lshl_b32 s60, s56, 5
    s_add_u32 s60, s60, s52
    s_mul_i32 s57, s60, 147456
    s_lshl_b32 s60, s60, 7
    s_add_u32 s35, s60, 22020096
    s_lshl_b32 s1, s2, 2
    s_add_u32 s1, s1, s35
    s_lshr_b32 s60, s2, 2
    s_mul_i32 s62, s60, 36864
    s_add_u32 s62, s62, s57
    s_add_u32 s63, s62, 73728
    s_and_b32 s64, s2, 3
    s_mul_i32 s64, s64, 9
    v_add_u32 v32, 159360, v3
    ds_read_b128 v[88:91], v32 offset:0
    ds_read_b128 v[92:95], v32 offset:1024
    ds_read_b128 v[96:99], v32 offset:2048
    ds_read_b128 v[100:103], v32 offset:3072
    v_and_b32 v106, 7, v0
    v_mul_u32_u24 v64, 528, v106
    v_lshl_add_u32 v64, v30, 6, v64
    v_add_u32 v64, 152576, v64
    v_lshlrev_b32 v65, 6, v30
    v_add_u32 v65, 151808, v65
    v_lshlrev_b32 v66, 3, v106
    v_add_u32 v66, 152320, v66
    s_sub_u32 s61, 32, s52
    v_mul_u32_u24 v104, 4, v30
    v_sub_u32 v105, s52, v104
    v_add_u32 v104, s61, v104
    v_mul_u32_u24 v104, 1152, v104
    v_lshl_add_u32 v104, v106, 4, v104
    v_add_u32 v104, 1024, v104
    v_med3_i32 v105, v105, 0, 4
    v_lshlrev_b32 v105, 1, v105
    v_mul_lo_u32 v105, v105, s55
    s_add_u32 s60, s64, 8
    s_and_b32 s61, s60, 1
    s_lshl_b32 s61, s61, 2
    s_lshl_b32 s60, s60, 8
    v_xor_b32 v107, s61, v106
    v_lshlrev_b32 v107, 4, v107
    v_mul_u32_u24 v106, 9216, v2
    v_add3_u32 v107, v107, s60, v106
    v_and_b32 v106, 1, v30
    v_lshl_add_u32 v107, v106, 7, v107
    s_mov_b32 s77, 3200000
cw_76:
    ds_read_b32 v106, v5 offset:32
    s_waitcnt lgkmcnt(0)
    v_cmp_gt_u32 vcc, 4, v106
    s_cbranch_vccz cwo_77
    s_sleep 1
    s_sub_u32 s77, s77, 1
    s_cmp_lg_u32 s77, 0
    s_cbranch_scc1 cw_76
cwo_77:
    s_setprio 3
    ds_read_b64 v[90:91], v66
    ds_read_b128 v[48:51], v65 offset:0
    ds_read_b128 v[32:35], v64 offset:0
    ds_read_b128 v[52:55], v65 offset:16
    ds_read_b128 v[36:39], v64 offset:16
    ds_read_b128 v[56:59], v65 offset:32
    ds_read_b128 v[40:43], v64 offset:32
    ds_read_b128 v[60:63], v65 offset:48
    ds_read_b128 v[44:47], v64 offset:48
    s_waitcnt lgkmcnt(6)
    v_pk_mul_f32 v[68:69], v[48:49], v[90:91] op_sel:[1,0] op_sel_hi:[1,1]
    v_pk_fma_f32 v[32:33], v[48:49], v[32:33], v[68:69] op_sel:[0,0,0] op_sel_hi:[0,1,1] neg_lo:[0,0,1] neg_hi:[0,0,1]
    v_pk_mul_f32 v[68:69], v[50:51], v[90:91] op_sel:[1,0] op_sel_hi:[1,1]
    v_pk_fma_f32 v[34:35], v[50:51], v[34:35], v[68:69] op_sel:[0,0,0] op_sel_hi:[0,1,1] neg_lo:[0,0,1] neg_hi:[0,0,1]
    v_pk_fma_f32 v[34:35], v[32:33], v[88:89], v[34:35] op_sel:[0,0,0] op_sel_hi:[1,0,1]
    v_pk_fma_f32 v[34:35], v[32:33], v[88:89], v[34:35] op_sel:[1,1,0] op_sel_hi:[0,1,1] neg_lo:[1,0,0]
    s_waitcnt lgkmcnt(4)
    v_pk_mul_f32 v[68:69], v[52:53], v[90:91] op_sel:[1,0] op_sel_hi:[1,1]
    v_pk_fma_f32 v[36:37], v[52:53], v[36:37], v[68:69] op_sel:[0,0,0] op_sel_hi:[0,1,1] neg_lo:[0,0,1] neg_hi:[0,0,1]
    v_pk_fma_f32 v[36:37], v[34:35], v[88:89], v[36:37] op_sel:[0,0,0] op_sel_hi:[1,0,1]
    v_pk_fma_f32 v[36:37], v[34:35], v[88:89], v[36:37] op_sel:[1,1,0] op_sel_hi:[0,1,1] neg_lo:[1,0,0]
    v_pk_mul_f32 v[68:69], v[54:55], v[90:91] op_sel:[1,0] op_sel_hi:[1,1]
    v_pk_fma_f32 v[38:39], v[54:55], v[38:39], v[68:69] op_sel:[0,0,0] op_sel_hi:[0,1,1] neg_lo:[0,0,1] neg_hi:[0,0,1]
    v_pk_fma_f32 v[38:39], v[36:37], v[88:89], v[38:39] op_sel:[0,0,0] op_sel_hi:[1,0,1]
    v_pk_fma_f32 v[38:39], v[36:37], v[88:89], v[38:39] op_sel:[1,1,0] op_sel_hi:[0,1,1] neg_lo:[1,0,0]
    s_waitcnt lgkmcnt(2)
    v_pk_mul_f32 v[68:69], v[56:57], v[90:91] op_sel:[1,0] op_sel_hi:[1,1]
    v_pk_fma_f32 v[40:41], v[56:57], v[40:41], v[68:69] op_sel:[0,0,0] op_sel_hi:[0,1,1] neg_lo:[0,0,1] neg_hi:[0,0,1]
    v_pk_fma_f32 v[40:41], v[38:39], v[88:89], v[40:41] op_sel:[0,0,0] op_sel_hi:[1,0,1]
    v_pk_fma_f32 v[40:41], v[38:39], v[88:89], v[40:41] op_sel:[1,1,0] op_sel_hi:[0,1,1] neg_lo:[1,0,0]
    v_pk_mul_f32 v[68:69], v[58:59], v[90:91] op_sel:[1,0] op_sel_hi:[1,1]
    v_pk_fma_f32 v[42:43], v[58:59], v[42:43], v[68:69] op_sel:[0,0,0] op_sel_hi:[0,1,1] neg_lo:[0,0,1] neg_hi:[0,0,1]
    v_pk_fma_f32 v[42:43], v[40:41], v[88:89], v[42:43] op_sel:[0,0,0] op_sel_hi:[1,0,1]
    v_pk_fma_f32 v[42:43], v[40:41], v[88:89], v[42:43] op_sel:[1,1,0] op_sel_hi:[0,1,1] neg_lo:[1,0,0]
    s_waitcnt lgkmcnt(0)
    v_pk_mul_f32 v[68:69], v[60:61], v[90:91] op_sel:[1,0] op_sel_hi:[1,1]
    v_pk_fma_f32 v[44:45], v[60:61], v[44:45], v[68:69] op_sel:[0,0,0] op_sel_hi:[0,1,1] neg_lo:[0,0,1] neg_hi:[0,0,1]
    v_pk_fma_f32 v[44:45], v[42:43], v[88:89], v[44:45] op_sel:[0,0,0] op_sel_hi:[1,0,1]
    v_pk_fma_f32 v[44:45], v[42:43], v[88:89], v[44:45] op_sel:[1,1,0] op_sel_hi:[0,1,1] neg_lo:[1,0,0]
    v_pk_mul_f32 v[68:69], v[62:63], v[90:91] op_sel:[1,0] op_sel_hi:[1,1]
    v_pk_fma_f32 v[46:47], v[62:63], v[46:47], v[68:69] op_sel:[0,0,0] op_sel_hi:[0,1,1] neg_lo:[0,0,1] neg_hi:[0,0,1]
    v_pk_fma_f32 v[46:47], v[44:45], v[88:89], v[46:47] op_sel:[0,0,0] op_sel_hi:[1,0,1]
    v_pk_fma_f32 v[46:47], v[44:45], v[88:89], v[46:47] op_sel:[1,1,0] op_sel_hi:[0,1,1] neg_lo:[1,0,0]
    s_add_u32 s60, s34, 1024
    v_pk_mul_f32 v[64:65], v[46:47], v[92:93] op_sel:[0,0] op_sel_hi:[1,0]
    v_pk_fma_f32 v[64:65], v[46:47], v[92:93], v[64:65] op_sel:[1,1,0] op_sel_hi:[0,1,1] neg_lo:[1,0,0]
    v_mov_b32 v69, s55
    v_mov_b32 v71, s55
    v_mov_b64 v[66:67], v[64:65]
    s_nop 1
    v_permlane32_swap_b32 v64, v66
    v_permlane32_swap_b32 v65, v67
    v_pk_add_f32 v[64:65], v[64:65], v[66:67]
    s_nop 1
    v_add_f32_dpp v64, v64, v64 row_ror:8 row_mask:0xf bank_mask:0xf
    v_add_f32_dpp v65, v65, v65 row_ror:8 row_mask:0xf bank_mask:0xf
    v_mov_b64 v[66:67], v[64:65]
    s_nop 1
    v_permlane16_swap_b32 v64, v66
    v_permlane16_swap_b32 v65, v67
    v_add_f32 v68, v64, v66
    v_add_f32 v70, v65, v67
    s_mov_b64 exec, 0xff
    buffer_store_dwordx4 v[68:71], v3, s[8:11], s60 offen sc1
    s_mov_b64 exec, -1
    v_mov_b32 v64, 1
    s_mov_b64 exec, 1
    ds_add_u32 v5, v64 offset:108
    s_mov_b64 exec, -1
    s_mov_b32 s68, s32
    s_mov_b32 s69, s33
    s_mov_b32 s70, 1152
    s_mov_b32 s71, 0x20000
    s_mul_i32 s61, s53, 144
    v_lshlrev_b32 v84, 3, v2
    s_xor_b32 s60, s37, 0
    s_mul_i32 s60, s60, 32
    s_add_u32 s60, s60, s61
    buffer_load_dwordx2 v[72:73], v84, s[68:71], s60 offen
    s_xor_b32 s60, s37, 1
    s_mul_i32 s60, s60, 32
    s_add_u32 s60, s60, s61
    buffer_load_dwordx2 v[74:75], v84, s[68:71], s60 offen
    s_xor_b32 s60, s37, 2
    s_mul_i32 s60, s60, 32
    s_add_u32 s60, s60, s61
    buffer_load_dwordx2 v[76:77], v84, s[68:71], s60 offen
    s_xor_b32 s60, s37, 3
    s_mul_i32 s60, s60, 32
    s_add_u32 s60, s60, s61
    buffer_load_dwordx2 v[78:79], v84, s[68:71], s60 offen
    s_mov_b32 s60, 128
    s_add_u32 s60, s60, s61
    buffer_load_dwordx2 v[80:81], v84, s[68:71], s60 offen
    s_lshl_b32 s60, s101, 7
    s_add_u32 s60, s60, 151808
    v_lshl_add_u32 v85, v1, 3, s60
    ds_read_b32 v83, v85
    s_lshl_b32 s60, s101, 6
    s_add_u32 s60, s60, 163456
    v_lshl_add_u32 v85, v1, 2, s60
    ds_read_b32 v82, v85
    s_mov_b32 s60, 158848
    v_and_b32 v48, 7, v0
    v_lshlrev_b32 v48, 6, v48
    v_add_u32 v48, s60, v48
    v_lshl_add_u32 v49, v30, 3, v48
    ds_write_b64 v49, v[46:47]
    ds_read_b128 v[52:55], v48 offset:0
    ds_read_b128 v[56:59], v48 offset:16
    ds_read_b128 v[60:63], v48 offset:32
    ds_read_b128 v[64:67], v48 offset:48
    v_pk_mul_f32 v[50:51], v[32:33], v[94:95] op_sel:[0,0] op_sel_hi:[1,0]
    v_pk_fma_f32 v[50:51], v[32:33], v[94:95], v[50:51] op_sel:[1,1,0] op_sel_hi:[0,1,1] neg_lo:[1,0,0]
    v_mov_b64 v[32:33], v[50:51]
    v_pk_mul_f32 v[50:51], v[34:35], v[94:95] op_sel:[0,0] op_sel_hi:[1,0]
    v_pk_fma_f32 v[50:51], v[34:35], v[94:95], v[50:51] op_sel:[1,1,0] op_sel_hi:[0,1,1] neg_lo:[1,0,0]
    v_mov_b64 v[34:35], v[50:51]
    v_pk_mul_f32 v[50:51], v[36:37], v[94:95] op_sel:[0,0] op_sel_hi:[1,0]
    v_pk_fma_f32 v[50:51], v[36:37], v[94:95], v[50:51] op_sel:[1,1,0] op_sel_hi:[0,1,1] neg_lo:[1,0,0]
    v_mov_b64 v[36:37], v[50:51]
    v_pk_mul_f32 v[50:51], v[38:39], v[94:95] op_sel:[0,0] op_sel_hi:[1,0]
    v_pk_fma_f32 v[50:51], v[38:39], v[94:95], v[50:51] op_sel:[1,1,0] op_sel_hi:[0,1,1] neg_lo:[1,0,0]
    v_mov_b64 v[38:39], v[50:51]
    v_pk_mul_f32 v[50:51], v[40:41], v[94:95] op_sel:[0,0] op_sel_hi:[1,0]
    v_pk_fma_f32 v[50:51], v[40:41], v[94:95], v[50:51] op_sel:[1,1,0] op_sel_hi:[0,1,1] neg_lo:[1,0,0]
    v_mov_b64 v[40:41], v[50:51]
    v_pk_mul_f32 v[50:51], v[42:43], v[94:95] op_sel:[0,0] op_sel_hi:[1,0]
    v_pk_fma_f32 v[50:51], v[42:43], v[94:95], v[50:51] op_sel:[1,1,0] op_sel_hi:[0,1,1] neg_lo:[1,0,0]
    v_mov_b64 v[42:43], v[50:51]
    v_pk_mul_f32 v[50:51], v[44:45], v[94:95] op_sel:[0,0] op_sel_hi:[1,0]
    v_pk_fma_f32 v[50:51], v[44:45], v[94:95], v[50:51] op_sel:[1,1,0] op_sel_hi:[0,1,1] neg_lo:[1,0,0]
    v_mov_b64 v[44:45], v[50:51]
    s_waitcnt lgkmcnt(0)
    v_pk_mul_f32 v[50:51], v[46:47], v[94:95] op_sel:[0,0] op_sel_hi:[1,0]
    v_pk_fma_f32 v[50:51], v[46:47], v[94:95], v[50:51] op_sel:[1,1,0] op_sel_hi:[0,1,1] neg_lo:[1,0,0]
    v_mov_b64 v[46:47], v[50:51]
    v_mov_b32 v28, 0
    v_mov_b32 v29, 0
    s_mov_b32 exec_lo, 0xffffff00
    s_mov_b32 exec_hi, 0xffffffff
    v_mov_b64 v[28:29], v[52:53]
    s_mov_b64 exec, -1
    v_pk_fma_f32 v[54:55], v[28:29], v[96:97], v[54:55] op_sel:[0,0,0] op_sel_hi:[1,0,1]
    v_pk_fma_f32 v[54:55], v[28:29], v[96:97], v[54:55] op_sel:[1,1,0] op_sel_hi:[0,1,1] neg_lo:[1,0,0]
    s_mov_b32 exec_lo, 0xffff0000
    s_mov_b32 exec_hi, 0xffffffff
    v_mov_b64 v[28:29], v[54:55]
    s_mov_b64 exec, -1
    v_pk_fma_f32 v[56:57], v[28:29], v[96:97], v[56:57] op_sel:[0,0,0] op_sel_hi:[1,0,1]
    v_pk_fma_f32 v[56:57], v[28:29], v[96:97], v[56:57] op_sel:[1,1,0] op_sel_hi:[0,1,1] neg_lo:[1,0,0]
    s_mov_b32 exec_lo, 0xff000000
    s_mov_b32 exec_hi, 0xffffffff
    v_mov_b64 v[28:29], v[56:57]
    s_mov_b64 exec, -1
    v_pk_fma_f32 v[58:59], v[28:29], v[96:97], v[58:59] op_sel:[0,0,0] op_sel_hi:[1,0,1]
    v_pk_fma_f32 v[58:59], v[28:29], v[96:97], v[58:59] op_sel:[1,1,0] op_sel_hi:[0,1,1] neg_lo:[1,0,0]
    s_mov_b32 exec_lo, 0x0
    s_mov_b32 exec_hi, 0xffffffff
    v_mov_b64 v[28:29], v[58:59]
    s_mov_b64 exec, -1
    v_pk_fma_f32 v[60:61], v[28:29], v[96:97], v[60:61] op_sel:[0,0,0] op_sel_hi:[1,0,1]
    v_pk_fma_f32 v[60:61], v[28:29], v[96:97], v[60:61] op_sel:[1,1,0] op_sel_hi:[0,1,1] neg_lo:[1,0,0]
    s_mov_b32 exec_lo, 0x0
    s_mov_b32 exec_hi, 0xffffff00
    v_mov_b64 v[28:29], v[60:61]
    s_mov_b64 exec, -1
    v_pk_fma_f32 v[62:63], v[28:29], v[96:97], v[62:63] op_sel:[0,0,0] op_sel_hi:[1,0,1]
    v_pk_fma_f32 v[62:63], v[28:29], v[96:97], v[62:63] op_sel:[1,1,0] op_sel_hi:[0,1,1] neg_lo:[1,0,0]
    s_mov_b32 exec_lo, 0x0
    s_mov_b32 exec_hi, 0xffff0000
    v_mov_b64 v[28:29], v[62:63]
    s_mov_b64 exec, -1
    v_pk_fma_f32 v[64:65], v[28:29], v[96:97], v[64:65] op_sel:[0,0,0] op_sel_hi:[1,0,1]
    v_pk_fma_f32 v[64:65], v[28:29], v[96:97], v[64:65] op_sel:[1,1,0] op_sel_hi:[0,1,1] neg_lo:[1,0,0]
    s_mov_b32 exec_lo, 0x0
    s_mov_b32 exec_hi, 0xff000000
    v_mov_b64 v[28:29], v[64:65]
    s_mov_b64 exec, -1
    buffer_load_dwordx4 v[48:51], v104, s[8:11], 0 offen offset:0 sc1
    buffer_load_dwordx4 v[52:55], v104, s[8:11], 0 offen offset:1152 sc1
    buffer_load_dwordx4 v[56:59], v104, s[8:11], 0 offen offset:2304 sc1
    buffer_load_dwordx4 v[60:63], v104, s[8:11], 0 offen offset:3456 sc1
    s_waitcnt vmcnt(4)
    v_add_f32 v64, v26, v82
    s_cmp_eq_u32 s56, 0
    s_cselect_b64 vcc, -1, 0
    v_cndmask_b32 v26, v64, v82, vcc
    v_pk_add_f32 v[6:7], v[6:7], v[82:83] op_sel_hi:[1,0] neg_lo:[0,1] neg_hi:[0,1]
    v_pk_add_f32 v[8:9], v[8:9], v[82:83] op_sel_hi:[1,0] neg_lo:[0,1] neg_hi:[0,1]
    v_pk_add_f32 v[10:11], v[10:11], v[82:83] op_sel_hi:[1,0] neg_lo:[0,1] neg_hi:[0,1]
    v_pk_add_f32 v[12:13], v[12:13], v[82:83] op_sel_hi:[1,0] neg_lo:[0,1] neg_hi:[0,1]
    v_pk_add_f32 v[14:15], v[14:15], v[82:83] op_sel_hi:[1,0] neg_lo:[0,1] neg_hi:[0,1]
    v_pk_add_f32 v[16:17], v[16:17], v[82:83] op_sel_hi:[1,0] neg_lo:[0,1] neg_hi:[0,1]
    v_pk_add_f32 v[18:19], v[18:19], v[82:83] op_sel_hi:[1,0] neg_lo:[0,1] neg_hi:[0,1]
    v_pk_add_f32 v[20:21], v[20:21], v[82:83] op_sel_hi:[1,0] neg_lo:[0,1] neg_hi:[0,1]
    v_pk_add_f32 v[22:23], v[22:23], v[82:83] op_sel_hi:[1,0] neg_lo:[0,1] neg_hi:[0,1]
    v_pk_add_f32 v[24:25], v[24:25], v[82:83] op_sel_hi:[1,0] neg_lo:[0,1] neg_hi:[0,1]
    v_lshlrev_b32 v64, 16, v72
    v_and_b32 v65, 0xffff0000, v72
    v_lshlrev_b32 v66, 16, v73
    v_and_b32 v67, 0xffff0000, v73
    v_pk_fma_f32 v[64:65], v[82:83], v[64:65], 1.0 op_sel:[1,0,0] op_sel_hi:[1,1,0]
    v_pk_fma_f32 v[66:67], v[82:83], v[66:67], 1.0 op_sel:[1,0,0] op_sel_hi:[1,1,0]
    v_pk_mul_f32 v[6:7], v[6:7], v[64:65]
    v_pk_mul_f32 v[8:9], v[8:9], v[66:67]
    v_lshlrev_b32 v64, 16, v74
    v_and_b32 v65, 0xffff0000, v74
    v_lshlrev_b32 v66, 16, v75
    v_and_b32 v67, 0xffff0000, v75
    v_pk_fma_f32 v[64:65], v[82:83], v[64:65], 1.0 op_sel:[1,0,0] op_sel_hi:[1,1,0]
    v_pk_fma_f32 v[66:67], v[82:83], v[66:67], 1.0 op_sel:[1,0,0] op_sel_hi:[1,1,0]
    v_pk_mul_f32 v[10:11], v[10:11], v[64:65]
    v_pk_mul_f32 v[12:13], v[12:13], v[66:67]
    v_lshlrev_b32 v64, 16, v76
    v_and_b32 v65, 0xffff0000, v76
    v_lshlrev_b32 v66, 16, v77
    v_and_b32 v67, 0xffff0000, v77
    v_pk_fma_f32 v[64:65], v[82:83], v[64:65], 1.0 op_sel:[1,0,0] op_sel_hi:[1,1,0]
    v_pk_fma_f32 v[66:67], v[82:83], v[66:67], 1.0 op_sel:[1,0,0] op_sel_hi:[1,1,0]
    v_pk_mul_f32 v[14:15], v[14:15], v[64:65]
    v_pk_mul_f32 v[16:17], v[16:17], v[66:67]
    v_lshlrev_b32 v64, 16, v78
    v_and_b32 v65, 0xffff0000, v78
    v_lshlrev_b32 v66, 16, v79
    v_and_b32 v67, 0xffff0000, v79
    v_pk_fma_f32 v[64:65], v[82:83], v[64:65], 1.0 op_sel:[1,0,0] op_sel_hi:[1,1,0]
    v_pk_fma_f32 v[66:67], v[82:83], v[66:67], 1.0 op_sel:[1,0,0] op_sel_hi:[1,1,0]
    v_pk_mul_f32 v[18:19], v[18:19], v[64:65]
    v_pk_mul_f32 v[20:21], v[20:21], v[66:67]
    v_lshlrev_b32 v64, 16, v80
    v_and_b32 v65, 0xffff0000, v80
    v_lshlrev_b32 v66, 16, v81
    v_and_b32 v67, 0xffff0000, v81
    v_pk_fma_f32 v[64:65], v[82:83], v[64:65], 1.0 op_sel:[1,0,0] op_sel_hi:[1,1,0]
    v_pk_fma_f32 v[66:67], v[82:83], v[66:67], 1.0 op_sel:[1,0,0] op_sel_hi:[1,1,0]
    v_pk_mul_f32 v[22:23], v[22:23], v[64:65]
    v_pk_mul_f32 v[24:25], v[24:25], v[66:67]
    v_pk_mul_f32 v[72:73], v[94:95], v[88:89] op_sel:[0,0] op_sel_hi:[1,0]
    v_pk_fma_f32 v[72:73], v[94:95], v[88:89], v[72:73] op_sel:[1,1,0] op_sel_hi:[0,1,1] neg_lo:[1,0,0]
    v_pk_mul_f32 v[74:75], v[72:73], v[88:89] op_sel:[0,0] op_sel_hi:[1,0]
    v_pk_fma_f32 v[74:75], v[72:73], v[88:89], v[74:75] op_sel:[1,1,0] op_sel_hi:[0,1,1] neg_lo:[1,0,0]
    v_pk_mul_f32 v[76:77], v[74:75], v[88:89] op_sel:[0,0] op_sel_hi:[1,0]
    v_pk_fma_f32 v[76:77], v[74:75], v[88:89], v[76:77] op_sel:[1,1,0] op_sel_hi:[0,1,1] neg_lo:[1,0,0]
    v_pk_mul_f32 v[78:79], v[76:77], v[88:89] op_sel:[0,0] op_sel_hi:[1,0]
    v_pk_fma_f32 v[78:79], v[76:77], v[88:89], v[78:79] op_sel:[1,1,0] op_sel_hi:[0,1,1] neg_lo:[1,0,0]
    v_pk_mul_f32 v[80:81], v[78:79], v[88:89] op_sel:[0,0] op_sel_hi:[1,0]
    v_pk_fma_f32 v[80:81], v[78:79], v[88:89], v[80:81] op_sel:[1,1,0] op_sel_hi:[0,1,1] neg_lo:[1,0,0]
    v_pk_mul_f32 v[82:83], v[80:81], v[88:89] op_sel:[0,0] op_sel_hi:[1,0]
    v_pk_fma_f32 v[82:83], v[80:81], v[88:89], v[82:83] op_sel:[1,1,0] op_sel_hi:[0,1,1] neg_lo:[1,0,0]
    v_pk_mul_f32 v[84:85], v[82:83], v[88:89] op_sel:[0,0] op_sel_hi:[1,0]
    v_pk_fma_f32 v[84:85], v[82:83], v[88:89], v[84:85] op_sel:[1,1,0] op_sel_hi:[0,1,1] neg_lo:[1,0,0]
    v_pk_mul_f32 v[86:87], v[84:85], v[88:89] op_sel:[0,0] op_sel_hi:[1,0]
    v_pk_fma_f32 v[86:87], v[84:85], v[88:89], v[86:87] op_sel:[1,1,0] op_sel_hi:[0,1,1] neg_lo:[1,0,0]
    s_cmp_lg_u32 s56, 0
    s_cbranch_scc1 L_x5
    s_mov_b32 s77, 3200000
cw_78:
    ds_read_b32 v106, v5 offset:64
    s_waitcnt lgkmcnt(0)
    v_cmp_gt_u32 vcc, 4, v106
    s_cbranch_vccz cwo_79
    s_sleep 1
    s_sub_u32 s77, s77, 1
    s_cmp_lg_u32 s77, 0
    s_cbranch_scc1 cw_78
cwo_79:
    ds_read_b128 a[0:3], v108 offset:0
    ds_read_b128 a[4:7], v108 offset:1024
    ds_read_b128 a[8:11], v108 offset:2048
    ds_read_b128 a[12:15], v108 offset:3072
    ds_read_b128 a[16:19], v109 offset:0
    ds_read_b128 a[20:23], v109 offset:1024
    ds_read_b128 a[24:27], v31 offset:0
    ds_read_b128 a[28:31], v31 offset:1024
    ds_read_b128 a[32:35], v31 offset:2048
    ds_read_b128 a[36:39], v31 offset:3072
    ds_read_b128 a[40:43], v31 offset:4096
    ds_read_b128 a[44:47], v31 offset:5120
    ds_read_b128 a[48:51], v31 offset:6144
    ds_read_b128 a[52:55], v31 offset:7168
    ds_read_b128 a[56:59], v110 offset:0
    ds_read_b128 a[60:63], v110 offset:1024
    ds_read_b128 a[64:67], v110 offset:2048
    ds_read_b128 a[68:71], v110 offset:3072
    ds_read_b128 a[72:75], v110 offset:4096
    ds_read_b128 a[76:79], v110 offset:5120
    ds_read_b128 a[80:83], v110 offset:6144
    ds_read_b128 a[84:87], v110 offset:7168
    v_mov_b32 v106, 1
    s_mov_b64 exec, 1
    ds_add_u32 v5, v106 offset:100
    s_mov_b64 exec, -1
L_x5:
    s_mov_b32 s77, 400000
    s_branch pchk_lb8_82
poll_lb8_80:
    buffer_load_dwordx4 v[48:51], v104, s[8:11], 0 offen offset:0 sc1
    buffer_load_dwordx4 v[52:55], v104, s[8:11], 0 offen offset:1152 sc1
    buffer_load_dwordx4 v[56:59], v104, s[8:11], 0 offen offset:2304 sc1
    buffer_load_dwordx4 v[60:63], v104, s[8:11], 0 offen offset:3456 sc1
pchk_lb8_82:
    s_waitcnt vmcnt(0)
    v_add_u32 v106, v49, v51
    v_add3_u32 v106, v53, v55, v106
    v_add3_u32 v106, v57, v59, v106
    v_add3_u32 v106, v61, v63, v106
    v_cmp_ne_u32 vcc, v106, v105
    s_cbranch_vccz pout_lb8_81
    s_mov_b64 exec, vcc
    s_sleep 3
    s_sub_u32 s77, s77, 1
    s_cmp_lg_u32 s77, 0
    s_cbranch_scc1 poll_lb8_80
pout_lb8_81:
    s_mov_b64 exec, -1
    v_mov_b32 v61, v62
    v_fmac_f32 v56, v60, v100
    v_fma_f32 v57, v61, v100, v58
    v_pk_fma_f32 v[56:57], v[60:61], v[100:101], v[56:57] op_sel:[1,1,0] op_sel_hi:[0,1,1] neg_lo:[1,0,0]
    v_fmac_f32 v52, v56, v100
    v_fma_f32 v53, v57, v100, v54
    v_pk_fma_f32 v[52:53], v[56:57], v[100:101], v[52:53] op_sel:[1,1,0] op_sel_hi:[0,1,1] neg_lo:[1,0,0]
    v_fmac_f32 v48, v52, v100
    v_fma_f32 v49, v53, v100, v50
    v_pk_fma_f32 v[48:49], v[52:53], v[100:101], v[48:49] op_sel:[1,1,0] op_sel_hi:[0,1,1] neg_lo:[1,0,0]
    v_pk_mul_f32 v[52:53], v[48:49], v[102:103] op_sel:[0,0] op_sel_hi:[1,0]
    v_pk_fma_f32 v[52:53], v[48:49], v[102:103], v[52:53] op_sel:[1,1,0] op_sel_hi:[0,1,1] neg_lo:[1,0,0]
    v_mov_b64 v[54:55], v[52:53]
    s_nop 1
    v_permlane32_swap_b32 v52, v54
    v_permlane32_swap_b32 v53, v55
    v_pk_add_f32 v[52:53], v[52:53], v[54:55]
    v_mov_b64 v[54:55], v[52:53]
    s_nop 1
    v_permlane16_swap_b32 v52, v54
    v_permlane16_swap_b32 v53, v55
    v_pk_add_f32 v[52:53], v[52:53], v[54:55]
    s_nop 1
    v_add_f32_dpp v52, v52, v52 row_ror:8 row_mask:0xf bank_mask:0xf
    v_add_f32_dpp v53, v53, v53 row_ror:8 row_mask:0xf bank_mask:0xf
    v_pk_fma_f32 v[28:29], v[52:53], v[98:99], v[28:29] op_sel:[0,0,0] op_sel_hi:[1,0,1]
    v_pk_fma_f32 v[28:29], v[52:53], v[98:99], v[28:29] op_sel:[1,1,0] op_sel_hi:[0,1,1] neg_lo:[1,0,0]
    v_pk_fma_f32 v[32:33], v[72:73], v[28:29], v[32:33] op_sel:[0,0,0] op_sel_hi:[1,0,1]
    v_pk_fma_f32 v[32:33], v[72:73], v[28:29], v[32:33] op_sel:[1,1,0] op_sel_hi:[0,1,1] neg_lo:[1,0,0]
    v_pk_fma_f32 v[34:35], v[74:75], v[28:29], v[34:35] op_sel:[0,0,0] op_sel_hi:[1,0,1]
    v_pk_fma_f32 v[34:35], v[74:75], v[28:29], v[34:35] op_sel:[1,1,0] op_sel_hi:[0,1,1] neg_lo:[1,0,0]
    v_pk_fma_f32 v[36:37], v[76:77], v[28:29], v[36:37] op_sel:[0,0,0] op_sel_hi:[1,0,1]
    v_pk_fma_f32 v[36:37], v[76:77], v[28:29], v[36:37] op_sel:[1,1,0] op_sel_hi:[0,1,1] neg_lo:[1,0,0]
    v_pk_fma_f32 v[38:39], v[78:79], v[28:29], v[38:39] op_sel:[0,0,0] op_sel_hi:[1,0,1]
    v_pk_fma_f32 v[38:39], v[78:79], v[28:29], v[38:39] op_sel:[1,1,0] op_sel_hi:[0,1,1] neg_lo:[1,0,0]
    v_pk_fma_f32 v[40:41], v[80:81], v[28:29], v[40:41] op_sel:[0,0,0] op_sel_hi:[1,0,1]
    v_pk_fma_f32 v[40:41], v[80:81], v[28:29], v[40:41] op_sel:[1,1,0] op_sel_hi:[0,1,1] neg_lo:[1,0,0]
    v_pk_fma_f32 v[42:43], v[82:83], v[28:29], v[42:43] op_sel:[0,0,0] op_sel_hi:[1,0,1]
    v_pk_fma_f32 v[42:43], v[82:83], v[28:29], v[42:43] op_sel:[1,1,0] op_sel_hi:[0,1,1] neg_lo:[1,0,0]
    v_pk_fma_f32 v[44:45], v[84:85], v[28:29], v[44:45] op_sel:[0,0,0] op_sel_hi:[1,0,1]
    v_pk_fma_f32 v[44:45], v[84:85], v[28:29], v[44:45] op_sel:[1,1,0] op_sel_hi:[0,1,1] neg_lo:[1,0,0]
    v_pk_fma_f32 v[46:47], v[86:87], v[28:29], v[46:47] op_sel:[0,0,0] op_sel_hi:[1,0,1]
    v_pk_fma_f32 v[46:47], v[86:87], v[28:29], v[46:47] op_sel:[1,1,0] op_sel_hi:[0,1,1] neg_lo:[1,0,0]
    v_cvt_pk_bf16_f32 v48, v32, v34
    v_cvt_pk_bf16_f32 v49, v36, v38
    v_cvt_pk_bf16_f32 v50, v40, v42
    v_cvt_pk_bf16_f32 v51, v44, v46
    v_cvt_pk_bf16_f32 v52, -v33, -v35
    v_cvt_pk_bf16_f32 v53, -v37, -v39
    v_cvt_pk_bf16_f32 v54, -v41, -v43
    v_cvt_pk_bf16_f32 v55, -v45, -v47
    buffer_store_dwordx4 v[48:51], v107, s[4:7], s62 offen sc1
    buffer_store_dwordx4 v[52:55], v107, s[4:7], s63 offen sc1
    s_waitcnt vmcnt(0)
    v_mov_b32 v64, 1
    s_mov_b64 exec, 1
    ds_add_rtn_u32 v64, v5, v64 offset:40
    v_mov_b32 v66, s55
    v_mov_b32 v67, 0
    s_waitcnt lgkmcnt(0)
    v_cmp_eq_u32 vcc, 4, v64
    s_cbranch_vccz nf_83
    s_cmp_eq_u32 s30, 0
    s_cbranch_scc1 ssl_84
    buffer_store_dword v66, v67, s[4:7], s1 offen
    s_branch ssj_85
ssl_84:
    buffer_store_dword v66, v67, s[4:7], s1 offen sc1
ssj_85:
nf_83:
    s_mov_b64 exec, -1
    s_setprio 1
    s_cmp_lg_u32 s56, 0
    s_cbranch_scc1 L_g2pre
    s_mov_b32 s77, 3200000
cw_86:
    ds_read_b32 v32, v5 offset:104
    s_waitcnt lgkmcnt(0)
    v_cmp_gt_u32 vcc, 4, v32
    s_cbranch_vccz cwo_87
    s_sleep 1
    s_sub_u32 s77, s77, 1
    s_cmp_lg_u32 s77, 0
    s_cbranch_scc1 cw_86
cwo_87:
    ds_read_b128 a[88:91], v31 offset:0
    ds_read_b128 a[92:95], v31 offset:1024
    ds_read_b128 a[96:99], v31 offset:2048
    ds_read_b128 a[100:103], v31 offset:3072
    ds_read_b128 a[104:107], v31 offset:4096
    ds_read_b128 a[108:111], v31 offset:5120
    ds_read_b128 a[112:115], v110 offset:0
    ds_read_b128 a[116:119], v110 offset:1024
    ds_read_b128 a[120:123], v110 offset:2048
    ds_read_b128 a[124:127], v110 offset:3072
    ds_read_b128 a[128:131], v110 offset:4096
    ds_read_b128 a[132:135], v110 offset:5120
    ds_read_b128 a[136:139], v110 offset:6144
    ds_read_b128 a[140:143], v110 offset:7168
    s_branch L_g2pre
L_xres:
    s_mov_b32 s68, s32
    s_mov_b32 s69, s33
    s_mov_b32 s70, 1152
    s_mov_b32 s71, 0x20000
    s_mul_i32 s61, s53, 144
    v_lshlrev_b32 v100, 3, v2
    s_xor_b32 s60, s37, 0
    s_mul_i32 s60, s60, 32
    s_add_u32 s60, s60, s61
    buffer_load_dwordx2 v[88:89], v100, s[68:71], s60 offen
    s_xor_b32 s60, s37, 1
    s_mul_i32 s60, s60, 32
    s_add_u32 s60, s60, s61
    buffer_load_dwordx2 v[90:91], v100, s[68:71], s60 offen
    s_xor_b32 s60, s37, 2
    s_mul_i32 s60, s60, 32
    s_add_u32 s60, s60, s61
    buffer_load_dwordx2 v[92:93], v100, s[68:71], s60 offen
    s_xor_b32 s60, s37, 3
    s_mul_i32 s60, s60, 32
    s_add_u32 s60, s60, s61
    buffer_load_dwordx2 v[94:95], v100, s[68:71], s60 offen
    s_mov_b32 s60, 128
    s_add_u32 s60, s60, s61
    buffer_load_dwordx2 v[96:97], v100, s[68:71], s60 offen
    s_lshl_b32 s60, s101, 7
    s_add_u32 s60, s60, 151808
    v_lshl_add_u32 v101, v1, 3, s60
    ds_read_b32 v29, v101
    s_lshl_b32 s60, s101, 6
    s_add_u32 s60, s60, 163456
    v_lshl_add_u32 v101, v1, 2, s60
    ds_read_b32 v28, v101
    s_waitcnt vmcnt(0)
    s_cmp_lg_u32 s56, 0
    s_cbranch_scc1 L_res3
    s_cmp_eq_u32 s66, 0
    s_cbranch_scc1 yfl_88
    s_mul_i32 s60, s49, 3
    s_add_u32 s60, s60, s54
    s_lshl_b32 s60, s60, 2
    s_lshl_b32 s61, s53, 9
    s_add_u32 s60, s60, s61
    s_add_u32 s60, s60, 22061056
    v_mov_b32 v32, s55
    v_mov_b32 v33, 0
    s_mov_b64 exec, 1
    buffer_store_dword v32, v33, s[4:7], s60 offen sc1
    s_mov_b64 exec, -1
yfl_88:
    ds_read_b32 v100, v5 offset:128
    s_waitcnt lgkmcnt(0)
    v_readfirstlane_b32 s30, v100
L_res3:
    s_waitcnt lgkmcnt(0)
    v_add_f32 v56, v26, v28
    s_cmp_eq_u32 s56, 0
    s_cselect_b64 vcc, -1, 0
    v_cndmask_b32 v26, v56, v28, vcc
    v_pk_add_f32 v[6:7], v[6:7], v[28:29] op_sel_hi:[1,0] neg_lo:[0,1] neg_hi:[0,1]
    v_pk_add_f32 v[8:9], v[8:9], v[28:29] op_sel_hi:[1,0] neg_lo:[0,1] neg_hi:[0,1]
    v_pk_add_f32 v[10:11], v[10:11], v[28:29] op_sel_hi:[1,0] neg_lo:[0,1] neg_hi:[0,1]
    v_pk_add_f32 v[12:13], v[12:13], v[28:29] op_sel_hi:[1,0] neg_lo:[0,1] neg_hi:[0,1]
    v_pk_add_f32 v[14:15], v[14:15], v[28:29] op_sel_hi:[1,0] neg_lo:[0,1] neg_hi:[0,1]
    v_pk_add_f32 v[16:17], v[16:17], v[28:29] op_sel_hi:[1,0] neg_lo:[0,1] neg_hi:[0,1]
    v_pk_add_f32 v[18:19], v[18:19], v[28:29] op_sel_hi:[1,0] neg_lo:[0,1] neg_hi:[0,1]
    v_pk_add_f32 v[20:21], v[20:21], v[28:29] op_sel_hi:[1,0] neg_lo:[0,1] neg_hi:[0,1]
    v_pk_add_f32 v[22:23], v[22:23], v[28:29] op_sel_hi:[1,0] neg_lo:[0,1] neg_hi:[0,1]
    v_pk_add_f32 v[24:25], v[24:25], v[28:29] op_sel_hi:[1,0] neg_lo:[0,1] neg_hi:[0,1]
    v_lshlrev_b32 v56, 16, v88
    v_and_b32 v57, 0xffff0000, v88
    v_lshlrev_b32 v58, 16, v89
    v_and_b32 v59, 0xffff0000, v89
    v_lshlrev_b32 v60, 16, v90
    v_and_b32 v61, 0xffff0000, v90
    v_lshlrev_b32 v62, 16, v91
    v_and_b32 v63, 0xffff0000, v91
    v_lshlrev_b32 v64, 16, v92
    v_and_b32 v65, 0xffff0000, v92
    v_lshlrev_b32 v66, 16, v93
    v_and_b32 v67, 0xffff0000, v93
    v_lshlrev_b32 v68, 16, v94
    v_and_b32 v69, 0xffff0000, v94
    v_lshlrev_b32 v70, 16, v95
    v_and_b32 v71, 0xffff0000, v95
    v_lshlrev_b32 v72, 16, v96
    v_and_b32 v73, 0xffff0000, v96
    v_lshlrev_b32 v74, 16, v97
    v_and_b32 v75, 0xffff0000, v97
    v_pk_fma_f32 v[56:57], v[28:29], v[56:57], 1.0 op_sel:[1,0,0] op_sel_hi:[1,1,0]
    v_pk_fma_f32 v[58:59], v[28:29], v[58:59], 1.0 op_sel:[1,0,0] op_sel_hi:[1,1,0]
    v_pk_fma_f32 v[60:61], v[28:29], v[60:61], 1.0 op_sel:[1,0,0] op_sel_hi:[1,1,0]
    v_pk_fma_f32 v[62:63], v[28:29], v[62:63], 1.0 op_sel:[1,0,0] op_sel_hi:[1,1,0]
    v_pk_fma_f32 v[64:65], v[28:29], v[64:65], 1.0 op_sel:[1,0,0] op_sel_hi:[1,1,0]
    v_pk_fma_f32 v[66:67], v[28:29], v[66:67], 1.0 op_sel:[1,0,0] op_sel_hi:[1,1,0]
    v_pk_fma_f32 v[68:69], v[28:29], v[68:69], 1.0 op_sel:[1,0,0] op_sel_hi:[1,1,0]
    v_pk_fma_f32 v[70:71], v[28:29], v[70:71], 1.0 op_sel:[1,0,0] op_sel_hi:[1,1,0]
    v_pk_fma_f32 v[72:73], v[28:29], v[72:73], 1.0 op_sel:[1,0,0] op_sel_hi:[1,1,0]
    v_pk_fma_f32 v[74:75], v[28:29], v[74:75], 1.0 op_sel:[1,0,0] op_sel_hi:[1,1,0]
    v_pk_mul_f32 v[6:7], v[6:7], v[56:57]
    v_pk_mul_f32 v[8:9], v[8:9], v[58:59]
    v_pk_mul_f32 v[10:11], v[10:11], v[60:61]
    v_pk_mul_f32 v[12:13], v[12:13], v[62:63]
    v_pk_mul_f32 v[14:15], v[14:15], v[64:65]
    v_pk_mul_f32 v[16:17], v[16:17], v[66:67]
    v_pk_mul_f32 v[18:19], v[18:19], v[68:69]
    v_pk_mul_f32 v[20:21], v[20:21], v[70:71]
    v_pk_mul_f32 v[22:23], v[22:23], v[72:73]
    v_pk_mul_f32 v[24:25], v[24:25], v[74:75]
    s_cmp_lg_u32 s56, 0
    s_cbranch_scc1 L_g2pre
    s_mov_b32 s77, 3200000
cw_89:
    ds_read_b32 v32, v5 offset:104
    s_waitcnt lgkmcnt(0)
    v_cmp_gt_u32 vcc, 4, v32
    s_cbranch_vccz cwo_90
    s_sleep 1
    s_sub_u32 s77, s77, 1
    s_cmp_lg_u32 s77, 0
    s_cbranch_scc1 cw_89
cwo_90:
    ds_read_b128 a[88:91], v31 offset:0
    ds_read_b128 a[92:95], v31 offset:1024
    ds_read_b128 a[96:99], v31 offset:2048
    ds_read_b128 a[100:103], v31 offset:3072
    ds_read_b128 a[104:107], v31 offset:4096
    ds_read_b128 a[108:111], v31 offset:5120
    ds_read_b128 a[112:115], v110 offset:0
    ds_read_b128 a[116:119], v110 offset:1024
    ds_read_b128 a[120:123], v110 offset:2048
    ds_read_b128 a[124:127], v110 offset:3072
    ds_read_b128 a[128:131], v110 offset:4096
    ds_read_b128 a[132:135], v110 offset:5120
    ds_read_b128 a[136:139], v110 offset:6144
    ds_read_b128 a[140:143], v110 offset:7168
L_g2pre:
    v_bfe_u32 v31, v1, 2, 1
    v_sub_u32 v31, 0, v31
    v_xor_b32 v31, v31, v2
    v_and_b32 v31, 3, v31
    v_and_b32 v30, 7, v1
    v_lshl_add_u32 v31, v30, 2, v31
    v_lshl_add_u32 v31, v31, 4, s0
    v_lshrrev_b32 v28, 2, v1
    v_and_b32 v29, 1, v2
    v_lshl_add_u32 v28, v29, 2, v28
    v_lshlrev_b32 v28, 4, v28
    v_lshl_add_u32 v28, v2, 8, v28
    v_bfe_u32 v29, v0, 1, 1
    v_lshl_add_u32 v28, v29, 7, v28
    v_and_b32 v29, 1, v0
    v_lshl_add_u32 v28, v29, 3, v28
    v_xor_b32 v29, 64, v28
    v_add_u32 v28, s59, v28
    v_add_u32 v29, s59, v29
    v_add_u32 v30, s59, v3
    s_add_u32 s60, s54, 3
    s_and_b32 s60, s60, 3
    s_mul_i32 s60, s60, 28672
    v_add_u32 v27, s60, v3
    s_add_u32 s60, s54, 2
    s_and_b32 s60, s60, 3
    s_mul_i32 s60, s60, 28672
    v_add_u32 v4, s60, v3
    s_add_u32 s60, s54, 1
    s_and_b32 s60, s60, 3
    s_mul_i32 s62, s60, 28672
    s_mul_i32 s76, s56, 524288
    s_add_u32 s76, s76, 262144
    s_add_u32 s76, s76, s58
    s_setprio 2
    s_waitcnt lgkmcnt(0)
    s_barrier
    ds_read_b128 v[104:107], v31 offset:0
    s_barrier
    ds_read_b64_tr_b16 v[92:93], v28 offset:0
    ds_read_b64_tr_b16 v[94:95], v29 offset:0
    ds_read_b64_tr_b16 v[96:97], v28 offset:1024
    ds_read_b64_tr_b16 v[98:99], v29 offset:1024
    s_waitcnt lgkmcnt(2)
    v_mfma_f32_16x16x32_bf16 v[32:35], a[0:3], v[92:95], 0
    ds_read_b64_tr_b16 v[100:101], v28 offset:2048
    v_mfma_f32_16x16x32_bf16 v[36:39], a[36:39], v[92:95], 0
    ds_read_b64_tr_b16 v[102:103], v29 offset:2048
    v_mfma_f32_16x16x32_bf16 v[40:43], a[72:75], v[92:95], 0
    ds_read_b128 v[108:111], v31 offset:512
    v_mfma_f32_16x16x32_bf16 v[44:47], a[108:111], v[92:95], 0
    s_waitcnt lgkmcnt(7)
    v_mfma_f32_16x16x32_bf16 v[48:51], v[104:107], v[92:95], 0
    s_waitcnt lgkmcnt(3)
    v_mfma_f32_16x16x32_bf16 v[32:35], a[4:7], v[96:99], v[32:35]
    s_barrier
    ds_read_b64_tr_b16 v[92:93], v28 offset:3072
    v_mfma_f32_16x16x32_bf16 v[36:39], a[40:43], v[96:99], v[36:39]
    ds_read_b64_tr_b16 v[94:95], v29 offset:3072
    v_mfma_f32_16x16x32_bf16 v[40:43], a[76:79], v[96:99], v[40:43]
    ds_read_b128 v[104:107], v31 offset:1024
    v_mfma_f32_16x16x32_bf16 v[44:47], a[112:115], v[96:99], v[44:47]
    s_waitcnt lgkmcnt(3)
    v_mfma_f32_16x16x32_bf16 v[48:51], v[108:111], v[96:99], v[48:51]
    s_waitcnt lgkmcnt(4)
    v_mfma_f32_16x16x32_bf16 v[32:35], a[8:11], v[100:103], v[32:35]
    ds_read_b64_tr_b16 v[96:97], v28 offset:4096
    v_mfma_f32_16x16x32_bf16 v[36:39], a[44:47], v[100:103], v[36:39]
    ds_read_b64_tr_b16 v[98:99], v29 offset:4096
    v_mfma_f32_16x16x32_bf16 v[40:43], a[80:83], v[100:103], v[40:43]
    ds_read_b128 v[108:111], v31 offset:1536
    v_mfma_f32_16x16x32_bf16 v[44:47], a[116:119], v[100:103], v[44:47]
    s_waitcnt lgkmcnt(3)
    v_mfma_f32_16x16x32_bf16 v[48:51], v[104:107], v[100:103], v[48:51]
    s_waitcnt lgkmcnt(4)
    v_mfma_f32_16x16x32_bf16 v[32:35], a[12:15], v[92:95], v[32:35]
    ds_read_b64_tr_b16 v[100:101], v28 offset:5120
    v_mfma_f32_16x16x32_bf16 v[36:39], a[48:51], v[92:95], v[36:39]
    ds_read_b64_tr_b16 v[102:103], v29 offset:5120
    v_mfma_f32_16x16x32_bf16 v[40:43], a[84:87], v[92:95], v[40:43]
    ds_read_b128 v[104:107], v31 offset:2048
    v_mfma_f32_16x16x32_bf16 v[44:47], a[120:123], v[92:95], v[44:47]
    s_waitcnt lgkmcnt(3)
    v_mfma_f32_16x16x32_bf16 v[48:51], v[108:111], v[92:95], v[48:51]
    s_waitcnt lgkmcnt(4)
    v_mfma_f32_16x16x32_bf16 v[32:35], a[16:19], v[96:99], v[32:35]
    ds_read_b64_tr_b16 v[92:93], v28 offset:6144
    v_mfma_f32_16x16x32_bf16 v[36:39], a[52:55], v[96:99], v[36:39]
    ds_read_b64_tr_b16 v[94:95], v29 offset:6144
    v_mfma_f32_16x16x32_bf16 v[40:43], a[88:91], v[96:99], v[40:43]
    ds_read_b128 v[108:111], v31 offset:2560
    v_mfma_f32_16x16x32_bf16 v[44:47], a[124:127], v[96:99], v[44:47]
    s_waitcnt lgkmcnt(3)
    v_mfma_f32_16x16x32_bf16 v[48:51], v[104:107], v[96:99], v[48:51]
    s_waitcnt lgkmcnt(4)
    v_mfma_f32_16x16x32_bf16 v[32:35], a[20:23], v[100:103], v[32:35]
    ds_read_b64_tr_b16 v[96:97], v28 offset:7168
    v_mfma_f32_16x16x32_bf16 v[36:39], a[56:59], v[100:103], v[36:39]
    ds_read_b64_tr_b16 v[98:99], v29 offset:7168
    v_mfma_f32_16x16x32_bf16 v[40:43], a[92:95], v[100:103], v[40:43]
    ds_read_b128 v[104:107], v31 offset:3072
    v_mfma_f32_16x16x32_bf16 v[44:47], a[128:131], v[100:103], v[44:47]
    s_waitcnt lgkmcnt(3)
    v_mfma_f32_16x16x32_bf16 v[48:51], v[108:111], v[100:103], v[48:51]
    s_waitcnt lgkmcnt(4)
    v_mfma_f32_16x16x32_bf16 v[32:35], a[24:27], v[92:95], v[32:35]
    ds_read_b64_tr_b16 v[100:101], v28 offset:8192
    v_mfma_f32_16x16x32_bf16 v[36:39], a[60:63], v[92:95], v[36:39]
    ds_read_b64_tr_b16 v[102:103], v29 offset:8192
    v_mfma_f32_16x16x32_bf16 v[40:43], a[96:99], v[92:95], v[40:43]
    ds_read_b128 v[108:111], v31 offset:3584
    v_mfma_f32_16x16x32_bf16 v[44:47], a[132:135], v[92:95], v[44:47]
    s_waitcnt lgkmcnt(3)
    v_mfma_f32_16x16x32_bf16 v[48:51], v[104:107], v[92:95], v[48:51]
    s_waitcnt lgkmcnt(4)
    v_mfma_f32_16x16x32_bf16 v[32:35], a[28:31], v[96:99], v[32:35]
    s_barrier
    ds_read_b64_tr_b16 v[92:93], v28 offset:18432
    v_mfma_f32_16x16x32_bf16 v[36:39], a[64:67], v[96:99], v[36:39]
    ds_read_b64_tr_b16 v[94:95], v29 offset:18432
    v_mfma_f32_16x16x32_bf16 v[40:43], a[100:103], v[96:99], v[40:43]
    ds_read_b128 v[104:107], v31 offset:4096
    v_mfma_f32_16x16x32_bf16 v[44:47], a[136:139], v[96:99], v[44:47]
    s_waitcnt lgkmcnt(3)
    v_mfma_f32_16x16x32_bf16 v[48:51], v[108:111], v[96:99], v[48:51]
    s_waitcnt lgkmcnt(4)
    v_mfma_f32_16x16x32_bf16 v[32:35], a[32:35], v[100:103], v[32:35]
    ds_read_b64_tr_b16 v[96:97], v28 offset:19456
    v_mfma_f32_16x16x32_bf16 v[36:39], a[68:71], v[100:103], v[36:39]
    ds_read_b64_tr_b16 v[98:99], v29 offset:19456
    v_mfma_f32_16x16x32_bf16 v[40:43], a[104:107], v[100:103], v[40:43]
    ds_read_b128 v[108:111], v31 offset:0
    v_mfma_f32_16x16x32_bf16 v[44:47], a[140:143], v[100:103], v[44:47]
    s_waitcnt lgkmcnt(3)
    v_mfma_f32_16x16x32_bf16 v[48:51], v[104:107], v[100:103], v[48:51]
    s_waitcnt lgkmcnt(4)
    v_mfma_f32_16x16x32_bf16 v[52:55], a[0:3], v[92:95], 0
    ds_read_b64_tr_b16 v[100:101], v28 offset:20480
    v_mfma_f32_16x16x32_bf16 v[56:59], a[36:39], v[92:95], 0
    ds_read_b64_tr_b16 v[102:103], v29 offset:20480
    v_mfma_f32_16x16x32_bf16 v[60:63], a[72:75], v[92:95], 0
    ds_read_b128 v[104:107], v31 offset:512
    v_mfma_f32_16x16x32_bf16 v[64:67], a[108:111], v[92:95], 0
    s_waitcnt lgkmcnt(3)
    v_mfma_f32_16x16x32_bf16 v[68:71], v[108:111], v[92:95], 0
    s_waitcnt lgkmcnt(4)
    v_mfma_f32_16x16x32_bf16 v[52:55], a[4:7], v[96:99], v[52:55]
    ds_read_b64_tr_b16 v[92:93], v28 offset:21504
    v_mfma_f32_16x16x32_bf16 v[56:59], a[40:43], v[96:99], v[56:59]
    ds_read_b64_tr_b16 v[94:95], v29 offset:21504
    v_mfma_f32_16x16x32_bf16 v[60:63], a[76:79], v[96:99], v[60:63]
    ds_read_b128 v[108:111], v31 offset:1024
    v_mfma_f32_16x16x32_bf16 v[64:67], a[112:115], v[96:99], v[64:67]
    s_waitcnt lgkmcnt(3)
    v_mfma_f32_16x16x32_bf16 v[68:71], v[104:107], v[96:99], v[68:71]
    s_waitcnt lgkmcnt(4)
    v_mfma_f32_16x16x32_bf16 v[52:55], a[8:11], v[100:103], v[52:55]
    ds_read_b64_tr_b16 v[96:97], v28 offset:22528
    v_mfma_f32_16x16x32_bf16 v[56:59], a[44:47], v[100:103], v[56:59]
    ds_read_b64_tr_b16 v[98:99], v29 offset:22528
    v_mfma_f32_16x16x32_bf16 v[60:63], a[80:83], v[100:103], v[60:63]
    ds_read_b128 v[104:107], v31 offset:1536
    v_mfma_f32_16x16x32_bf16 v[64:67], a[116:119], v[100:103], v[64:67]
    s_waitcnt lgkmcnt(3)
    v_mfma_f32_16x16x32_bf16 v[68:71], v[108:111], v[100:103], v[68:71]
    s_waitcnt lgkmcnt(4)
    v_mfma_f32_16x16x32_bf16 v[52:55], a[12:15], v[92:95], v[52:55]
    ds_read_b64_tr_b16 v[100:101], v28 offset:23552
    v_mfma_f32_16x16x32_bf16 v[56:59], a[48:51], v[92:95], v[56:59]
    ds_read_b64_tr_b16 v[102:103], v29 offset:23552
    v_mfma_f32_16x16x32_bf16 v[60:63], a[84:87], v[92:95], v[60:63]
    ds_read_b128 v[108:111], v31 offset:2048
    v_mfma_f32_16x16x32_bf16 v[64:67], a[120:123], v[92:95], v[64:67]
    s_waitcnt lgkmcnt(3)
    v_mfma_f32_16x16x32_bf16 v[68:71], v[104:107], v[92:95], v[68:71]
    s_waitcnt lgkmcnt(4)
    v_mfma_f32_16x16x32_bf16 v[52:55], a[16:19], v[96:99], v[52:55]
    ds_read_b64_tr_b16 v[92:93], v28 offset:24576
    v_mfma_f32_16x16x32_bf16 v[56:59], a[52:55], v[96:99], v[56:59]
    ds_read_b64_tr_b16 v[94:95], v29 offset:24576
    v_mfma_f32_16x16x32_bf16 v[60:63], a[88:91], v[96:99], v[60:63]
    ds_read_b128 v[104:107], v31 offset:2560
    v_mfma_f32_16x16x32_bf16 v[64:67], a[124:127], v[96:99], v[64:67]
    s_waitcnt lgkmcnt(3)
    v_mfma_f32_16x16x32_bf16 v[68:71], v[108:111], v[96:99], v[68:71]
    s_waitcnt lgkmcnt(4)
    v_mfma_f32_16x16x32_bf16 v[52:55], a[20:23], v[100:103], v[52:55]
    ds_read_b64_tr_b16 v[96:97], v28 offset:25600
    v_mfma_f32_16x16x32_bf16 v[56:59], a[56:59], v[100:103], v[56:59]
    ds_read_b64_tr_b16 v[98:99], v29 offset:25600
    v_mfma_f32_16x16x32_bf16 v[60:63], a[92:95], v[100:103], v[60:63]
    ds_read_b128 v[108:111], v31 offset:3072
    v_mfma_f32_16x16x32_bf16 v[64:67], a[128:131], v[100:103], v[64:67]
    s_waitcnt lgkmcnt(3)
    v_mfma_f32_16x16x32_bf16 v[68:71], v[104:107], v[100:103], v[68:71]
    s_waitcnt lgkmcnt(4)
    v_mfma_f32_16x16x32_bf16 v[52:55], a[24:27], v[92:95], v[52:55]
    ds_read_b64_tr_b16 v[100:101], v28 offset:26624
    v_mfma_f32_16x16x32_bf16 v[56:59], a[60:63], v[92:95], v[56:59]
    ds_read_b64_tr_b16 v[102:103], v29 offset:26624
    v_mfma_f32_16x16x32_bf16 v[60:63], a[96:99], v[92:95], v[60:63]
    ds_read_b128 v[104:107], v31 offset:3584
    v_mfma_f32_16x16x32_bf16 v[64:67], a[132:135], v[92:95], v[64:67]
    s_waitcnt lgkmcnt(3)
    v_mfma_f32_16x16x32_bf16 v[68:71], v[108:111], v[92:95], v[68:71]
    s_waitcnt lgkmcnt(4)
    v_mfma_f32_16x16x32_bf16 v[52:55], a[28:31], v[96:99], v[52:55]
    s_barrier
    ds_read_b64_tr_b16 v[92:93], v28 offset:9216
    v_mfma_f32_16x16x32_bf16 v[56:59], a[64:67], v[96:99], v[56:59]
    ds_read_b64_tr_b16 v[94:95], v29 offset:9216
    v_mfma_f32_16x16x32_bf16 v[60:63], a[100:103], v[96:99], v[60:63]
    ds_read_b128 v[108:111], v31 offset:4096
    v_mfma_f32_16x16x32_bf16 v[64:67], a[136:139], v[96:99], v[64:67]
    s_waitcnt lgkmcnt(3)
    v_mfma_f32_16x16x32_bf16 v[68:71], v[104:107], v[96:99], v[68:71]
    s_waitcnt lgkmcnt(4)
    v_mfma_f32_16x16x32_bf16 v[52:55], a[32:35], v[100:103], v[52:55]
    ds_read_b64_tr_b16 v[96:97], v28 offset:10240
    v_mfma_f32_16x16x32_bf16 v[56:59], a[68:71], v[100:103], v[56:59]
    ds_read_b64_tr_b16 v[98:99], v29 offset:10240
    v_mfma_f32_16x16x32_bf16 v[60:63], a[104:107], v[100:103], v[60:63]
    ds_read_b128 v[104:107], v31 offset:0
    v_mfma_f32_16x16x32_bf16 v[64:67], a[140:143], v[100:103], v[64:67]
    s_waitcnt lgkmcnt(3)
    v_mfma_f32_16x16x32_bf16 v[68:71], v[108:111], v[100:103], v[68:71]
    s_waitcnt lgkmcnt(4)
    v_mfma_f32_16x16x32_bf16 v[72:75], a[0:3], v[92:95], 0
    ds_read_b64_tr_b16 v[100:101], v28 offset:11264
    v_mfma_f32_16x16x32_bf16 v[76:79], a[36:39], v[92:95], 0
    ds_read_b64_tr_b16 v[102:103], v29 offset:11264
    v_mfma_f32_16x16x32_bf16 v[80:83], a[72:75], v[92:95], 0
    ds_read_b128 v[108:111], v31 offset:512
    v_mfma_f32_16x16x32_bf16 v[84:87], a[108:111], v[92:95], 0
    s_waitcnt lgkmcnt(3)
    v_mfma_f32_16x16x32_bf16 v[88:91], v[104:107], v[92:95], 0
    s_waitcnt lgkmcnt(4)
    v_mfma_f32_16x16x32_bf16 v[72:75], a[4:7], v[96:99], v[72:75]
    ds_read_b64_tr_b16 v[92:93], v28 offset:12288
    v_mfma_f32_16x16x32_bf16 v[76:79], a[40:43], v[96:99], v[76:79]
    ds_read_b64_tr_b16 v[94:95], v29 offset:12288
    v_mfma_f32_16x16x32_bf16 v[80:83], a[76:79], v[96:99], v[80:83]
    ds_read_b128 v[104:107], v31 offset:1024
    v_mfma_f32_16x16x32_bf16 v[84:87], a[112:115], v[96:99], v[84:87]
    ds_write_b128 v30, v[32:35] offset:18432
    s_waitcnt lgkmcnt(4)
    v_mfma_f32_16x16x32_bf16 v[88:91], v[108:111], v[96:99], v[88:91]
    s_waitcnt lgkmcnt(5)
    v_mfma_f32_16x16x32_bf16 v[72:75], a[8:11], v[100:103], v[72:75]
    ds_read_b64_tr_b16 v[96:97], v28 offset:13312
    v_mfma_f32_16x16x32_bf16 v[76:79], a[44:47], v[100:103], v[76:79]
    ds_read_b64_tr_b16 v[98:99], v29 offset:13312
    v_mfma_f32_16x16x32_bf16 v[80:83], a[80:83], v[100:103], v[80:83]
    ds_read_b128 v[108:111], v31 offset:1536
    v_mfma_f32_16x16x32_bf16 v[84:87], a[116:119], v[100:103], v[84:87]
    ds_write_b128 v30, v[36:39] offset:19456
    s_waitcnt lgkmcnt(5)
    v_mfma_f32_16x16x32_bf16 v[88:91], v[104:107], v[100:103], v[88:91]
    s_waitcnt lgkmcnt(6)
    v_mfma_f32_16x16x32_bf16 v[72:75], a[12:15], v[92:95], v[72:75]
    ds_read_b64_tr_b16 v[100:101], v28 offset:14336
    v_mfma_f32_16x16x32_bf16 v[76:79], a[48:51], v[92:95], v[76:79]
    ds_read_b64_tr_b16 v[102:103], v29 offset:14336
    v_mfma_f32_16x16x32_bf16 v[80:83], a[84:87], v[92:95], v[80:83]
    ds_read_b128 v[104:107], v31 offset:2048
    v_mfma_f32_16x16x32_bf16 v[84:87], a[120:123], v[92:95], v[84:87]
    ds_write_b128 v30, v[40:43] offset:20480
    s_waitcnt lgkmcnt(5)
    v_mfma_f32_16x16x32_bf16 v[88:91], v[108:111], v[92:95], v[88:91]
    s_waitcnt lgkmcnt(6)
    v_mfma_f32_16x16x32_bf16 v[72:75], a[16:19], v[96:99], v[72:75]
    ds_read_b64_tr_b16 v[92:93], v28 offset:15360
    v_mfma_f32_16x16x32_bf16 v[76:79], a[52:55], v[96:99], v[76:79]
    ds_read_b64_tr_b16 v[94:95], v29 offset:15360
    v_mfma_f32_16x16x32_bf16 v[80:83], a[88:91], v[96:99], v[80:83]
    ds_read_b128 v[108:111], v31 offset:2560
    v_mfma_f32_16x16x32_bf16 v[84:87], a[124:127], v[96:99], v[84:87]
    ds_write_b128 v30, v[44:47] offset:21504
    s_waitcnt lgkmcnt(5)
    v_mfma_f32_16x16x32_bf16 v[88:91], v[104:107], v[96:99], v[88:91]
    s_waitcnt lgkmcnt(6)
    v_mfma_f32_16x16x32_bf16 v[72:75], a[20:23], v[100:103], v[72:75]
    ds_read_b64_tr_b16 v[96:97], v28 offset:16384
    v_mfma_f32_16x16x32_bf16 v[76:79], a[56:59], v[100:103], v[76:79]
    ds_read_b64_tr_b16 v[98:99], v29 offset:16384
    v_mfma_f32_16x16x32_bf16 v[80:83], a[92:95], v[100:103], v[80:83]
    ds_read_b128 v[104:107], v31 offset:3072
    v_mfma_f32_16x16x32_bf16 v[84:87], a[128:131], v[100:103], v[84:87]
    ds_write_b128 v30, v[48:51] offset:22528
    s_waitcnt lgkmcnt(5)
    v_mfma_f32_16x16x32_bf16 v[88:91], v[108:111], v[100:103], v[88:91]
    s_waitcnt lgkmcnt(6)
    v_mfma_f32_16x16x32_bf16 v[72:75], a[24:27], v[92:95], v[72:75]
    ds_read_b64_tr_b16 v[100:101], v28 offset:17408
    v_mfma_f32_16x16x32_bf16 v[76:79], a[60:63], v[92:95], v[76:79]
    ds_read_b64_tr_b16 v[102:103], v29 offset:17408
    v_mfma_f32_16x16x32_bf16 v[80:83], a[96:99], v[92:95], v[80:83]
    ds_read_b128 v[108:111], v31 offset:3584
    v_mfma_f32_16x16x32_bf16 v[84:87], a[132:135], v[92:95], v[84:87]
    ds_write_b128 v30, v[52:55] offset:23552
    s_waitcnt lgkmcnt(5)
    v_mfma_f32_16x16x32_bf16 v[88:91], v[104:107], v[92:95], v[88:91]
    ds_write_b128 v30, v[56:59] offset:24576
    s_waitcnt lgkmcnt(7)
    v_mfma_f32_16x16x32_bf16 v[72:75], a[28:31], v[96:99], v[72:75]
    s_barrier
    ds_read_b64_tr_b16 v[92:93], v28 offset:0
    v_mfma_f32_16x16x32_bf16 v[76:79], a[64:67], v[96:99], v[76:79]
    ds_read_b64_tr_b16 v[94:95], v29 offset:0
    v_mfma_f32_16x16x32_bf16 v[80:83], a[100:103], v[96:99], v[80:83]
    ds_read_b128 v[104:107], v31 offset:4096
    v_mfma_f32_16x16x32_bf16 v[84:87], a[136:139], v[96:99], v[84:87]
    ds_write_b128 v30, v[60:63] offset:25600
    s_waitcnt lgkmcnt(6)
    v_mfma_f32_16x16x32_bf16 v[88:91], v[108:111], v[96:99], v[88:91]
    ds_write_b128 v30, v[64:67] offset:26624
    s_waitcnt lgkmcnt(8)
    v_mfma_f32_16x16x32_bf16 v[72:75], a[32:35], v[100:103], v[72:75]
    ds_read_b64_tr_b16 v[96:97], v28 offset:1024
    v_mfma_f32_16x16x32_bf16 v[76:79], a[68:71], v[100:103], v[76:79]
    ds_read_b64_tr_b16 v[98:99], v29 offset:1024
    v_mfma_f32_16x16x32_bf16 v[80:83], a[104:107], v[100:103], v[80:83]
    ds_read_b128 v[108:111], v31 offset:0
    v_mfma_f32_16x16x32_bf16 v[84:87], a[140:143], v[100:103], v[84:87]
    ds_write_b128 v30, v[68:71] offset:27648
    s_waitcnt lgkmcnt(6)
    v_mfma_f32_16x16x32_bf16 v[88:91], v[104:107], v[100:103], v[88:91]
    s_waitcnt lgkmcnt(7)
    v_mfma_f32_16x16x32_bf16 v[32:35], a[0:3], v[92:95], v[6:9]
    ds_read_b64_tr_b16 v[100:101], v28 offset:2048
    v_mfma_f32_16x16x32_bf16 v[36:39], a[36:39], v[92:95], v[10:13]
    ds_read_b64_tr_b16 v[102:103], v29 offset:2048
    v_mfma_f32_16x16x32_bf16 v[40:43], a[72:75], v[92:95], v[14:17]
    ds_read_b128 v[104:107], v31 offset:512
    v_mfma_f32_16x16x32_bf16 v[44:47], a[108:111], v[92:95], v[18:21]
    s_waitcnt lgkmcnt(4)
    v_mfma_f32_16x16x32_bf16 v[48:51], v[108:111], v[92:95], v[22:25]
    s_waitcnt lgkmcnt(5)
    v_mfma_f32_16x16x32_bf16 v[32:35], a[4:7], v[96:99], v[32:35]
    ds_read_b64_tr_b16 v[92:93], v28 offset:3072
    v_mfma_f32_16x16x32_bf16 v[36:39], a[40:43], v[96:99], v[36:39]
    ds_read_b64_tr_b16 v[94:95], v29 offset:3072
    v_mfma_f32_16x16x32_bf16 v[40:43], a[76:79], v[96:99], v[40:43]
    ds_read_b128 v[108:111], v31 offset:1024
    v_mfma_f32_16x16x32_bf16 v[44:47], a[112:115], v[96:99], v[44:47]
    ds_write_b128 v30, v[72:75] offset:9216
    s_waitcnt lgkmcnt(4)
    v_mfma_f32_16x16x32_bf16 v[48:51], v[104:107], v[96:99], v[48:51]
    ds_write_b128 v30, v[76:79] offset:10240
    s_waitcnt lgkmcnt(6)
    v_mfma_f32_16x16x32_bf16 v[32:35], a[8:11], v[100:103], v[32:35]
    ds_read_b64_tr_b16 v[96:97], v28 offset:4096
    v_mfma_f32_16x16x32_bf16 v[36:39], a[44:47], v[100:103], v[36:39]
    ds_read_b64_tr_b16 v[98:99], v29 offset:4096
    v_mfma_f32_16x16x32_bf16 v[40:43], a[80:83], v[100:103], v[40:43]
    ds_read_b128 v[104:107], v31 offset:1536
    v_mfma_f32_16x16x32_bf16 v[44:47], a[116:119], v[100:103], v[44:47]
    ds_write_b128 v30, v[80:83] offset:11264
    s_waitcnt lgkmcnt(6)
    v_mfma_f32_16x16x32_bf16 v[48:51], v[108:111], v[100:103], v[48:51]
    ds_write_b128 v30, v[84:87] offset:12288
    s_waitcnt lgkmcnt(8)
    v_mfma_f32_16x16x32_bf16 v[32:35], a[12:15], v[92:95], v[32:35]
    ds_read_b64_tr_b16 v[100:101], v28 offset:5120
    v_mfma_f32_16x16x32_bf16 v[36:39], a[48:51], v[92:95], v[36:39]
    ds_read_b64_tr_b16 v[102:103], v29 offset:5120
    v_mfma_f32_16x16x32_bf16 v[40:43], a[84:87], v[92:95], v[40:43]
    ds_read_b128 v[108:111], v31 offset:2048
    v_mfma_f32_16x16x32_bf16 v[44:47], a[120:123], v[92:95], v[44:47]
    ds_write_b128 v30, v[88:91] offset:13312
    s_waitcnt lgkmcnt(6)
    v_mfma_f32_16x16x32_bf16 v[48:51], v[104:107], v[92:95], v[48:51]
    s_waitcnt lgkmcnt(0)
    s_barrier
    v_add_u32 v30, s62, v3
    s_waitcnt lgkmcnt(7)
    v_mfma_f32_16x16x32_bf16 v[32:35], a[16:19], v[96:99], v[32:35]
    ds_read_b64_tr_b16 v[92:93], v28 offset:6144
    ds_read_b128 v[52:55], v27 offset:18432
    v_mfma_f32_16x16x32_bf16 v[36:39], a[52:55], v[96:99], v[36:39]
    ds_read_b64_tr_b16 v[94:95], v29 offset:6144
    ds_read_b128 v[56:59], v27 offset:19456
    v_mfma_f32_16x16x32_bf16 v[40:43], a[88:91], v[96:99], v[40:43]
    ds_read_b128 v[104:107], v31 offset:2560
    ds_read_b128 v[60:63], v27 offset:20480
    v_mfma_f32_16x16x32_bf16 v[44:47], a[124:127], v[96:99], v[44:47]
    ds_read_b128 v[64:67], v27 offset:21504
    ds_read_b128 v[68:71], v27 offset:22528
    s_waitcnt lgkmcnt(9)
    v_mfma_f32_16x16x32_bf16 v[48:51], v[108:111], v[96:99], v[48:51]
    ds_read_b128 v[72:75], v4 offset:23552
    ds_read_b128 v[76:79], v4 offset:24576
    s_waitcnt lgkmcnt(12)
    v_mfma_f32_16x16x32_bf16 v[32:35], a[20:23], v[100:103], v[32:35]
    ds_read_b64_tr_b16 v[96:97], v28 offset:7168
    ds_read_b128 v[80:83], v4 offset:25600
    v_mfma_f32_16x16x32_bf16 v[36:39], a[56:59], v[100:103], v[36:39]
    ds_read_b64_tr_b16 v[98:99], v29 offset:7168
    ds_read_b128 v[84:87], v4 offset:26624
    v_mfma_f32_16x16x32_bf16 v[40:43], a[92:95], v[100:103], v[40:43]
    ds_read_b128 v[108:111], v31 offset:3072
    ds_read_b128 v[88:91], v4 offset:27648
    v_mfma_f32_16x16x32_bf16 v[44:47], a[128:131], v[100:103], v[44:47]
    ds_read_b128 v[6:9], v30 offset:9216
    ds_read_b128 v[10:13], v30 offset:10240
    s_waitcnt lgkmcnt(13)
    v_mfma_f32_16x16x32_bf16 v[48:51], v[104:107], v[100:103], v[48:51]
    ds_read_b128 v[14:17], v30 offset:11264
    ds_read_b128 v[18:21], v30 offset:12288
    s_waitcnt lgkmcnt(15)
    v_mfma_f32_16x16x32_bf16 v[32:35], a[24:27], v[92:95], v[32:35]
    ds_read_b64_tr_b16 v[100:101], v28 offset:8192
    ds_read_b128 v[22:25], v30 offset:13312
    v_mfma_f32_16x16x32_bf16 v[36:39], a[60:63], v[92:95], v[36:39]
    ds_read_b64_tr_b16 v[102:103], v29 offset:8192
    v_mfma_f32_16x16x32_bf16 v[40:43], a[96:99], v[92:95], v[40:43]
    ds_read_b128 v[104:107], v31 offset:3584
    v_mfma_f32_16x16x32_bf16 v[44:47], a[132:135], v[92:95], v[44:47]
    s_waitcnt lgkmcnt(9)
    v_mfma_f32_16x16x32_bf16 v[48:51], v[108:111], v[92:95], v[48:51]
    s_waitcnt lgkmcnt(11)
    v_mfma_f32_16x16x32_bf16 v[32:35], a[28:31], v[96:99], v[32:35]
    v_mfma_f32_16x16x32_bf16 v[36:39], a[64:67], v[96:99], v[36:39]
    v_mfma_f32_16x16x32_bf16 v[40:43], a[100:103], v[96:99], v[40:43]
    ds_read_b128 v[108:111], v31 offset:4096
    v_mfma_f32_16x16x32_bf16 v[44:47], a[136:139], v[96:99], v[44:47]
    s_waitcnt lgkmcnt(1)
    v_mfma_f32_16x16x32_bf16 v[48:51], v[104:107], v[96:99], v[48:51]
    s_waitcnt lgkmcnt(2)
    v_mfma_f32_16x16x32_bf16 v[32:35], a[32:35], v[100:103], v[32:35]
    v_mfma_f32_16x16x32_bf16 v[36:39], a[68:71], v[100:103], v[36:39]
    v_mfma_f32_16x16x32_bf16 v[40:43], a[104:107], v[100:103], v[40:43]
    v_mfma_f32_16x16x32_bf16 v[44:47], a[140:143], v[100:103], v[44:47]
    s_waitcnt lgkmcnt(0)
    v_mfma_f32_16x16x32_bf16 v[48:51], v[108:111], v[100:103], v[48:51]
    s_waitcnt lgkmcnt(9)
    v_pk_add_f32 v[52:53], v[52:53], v[72:73]
    v_pk_add_f32 v[54:55], v[54:55], v[74:75]
    v_pk_add_f32 v[56:57], v[56:57], v[76:77]
    v_pk_add_f32 v[58:59], v[58:59], v[78:79]
    v_pk_add_f32 v[60:61], v[60:61], v[80:81]
    v_pk_add_f32 v[62:63], v[62:63], v[82:83]
    v_pk_add_f32 v[64:65], v[64:65], v[84:85]
    v_pk_add_f32 v[66:67], v[66:67], v[86:87]
    v_pk_add_f32 v[68:69], v[68:69], v[88:89]
    v_pk_add_f32 v[70:71], v[70:71], v[90:91]
    s_waitcnt lgkmcnt(0)
    v_pk_add_f32 v[6:7], v[6:7], v[52:53]
    v_pk_add_f32 v[8:9], v[8:9], v[54:55]
    v_pk_add_f32 v[10:11], v[10:11], v[56:57]
    v_pk_add_f32 v[12:13], v[12:13], v[58:59]
    v_pk_add_f32 v[14:15], v[14:15], v[60:61]
    v_pk_add_f32 v[16:17], v[16:17], v[62:63]
    v_pk_add_f32 v[18:19], v[18:19], v[64:65]
    v_pk_add_f32 v[20:21], v[20:21], v[66:67]
    v_pk_add_f32 v[22:23], v[22:23], v[68:69]
    v_pk_add_f32 v[24:25], v[24:25], v[70:71]
    v_pk_add_f32 v[6:7], v[6:7], v[32:33]
    v_pk_add_f32 v[8:9], v[8:9], v[34:35]
    v_pk_add_f32 v[10:11], v[10:11], v[36:37]
    v_pk_add_f32 v[12:13], v[12:13], v[38:39]
    v_pk_add_f32 v[14:15], v[14:15], v[40:41]
    v_pk_add_f32 v[16:17], v[16:17], v[42:43]
    v_pk_add_f32 v[18:19], v[18:19], v[44:45]
    v_pk_add_f32 v[20:21], v[20:21], v[46:47]
    v_pk_add_f32 v[22:23], v[22:23], v[48:49]
    v_pk_add_f32 v[24:25], v[24:25], v[50:51]
    s_mov_b32 exec_lo, 0x0
    s_mov_b32 exec_hi, 0xffffffff
    v_mov_b32 v22, 0
    v_mov_b32 v23, 0
    v_mov_b32 v24, 0
    v_mov_b32 v25, 0
    s_mov_b64 exec, -1
    v_pk_add_f32 v[32:33], v[6:7], v[8:9]
    v_pk_mul_f32 v[34:35], v[6:7], v[6:7]
    v_pk_fma_f32 v[34:35], v[8:9], v[8:9], v[34:35]
    v_pk_add_f32 v[32:33], v[32:33], v[10:11]
    v_pk_fma_f32 v[34:35], v[10:11], v[10:11], v[34:35]
    v_pk_add_f32 v[32:33], v[32:33], v[12:13]
    v_pk_fma_f32 v[34:35], v[12:13], v[12:13], v[34:35]
    v_pk_add_f32 v[32:33], v[32:33], v[14:15]
    v_pk_fma_f32 v[34:35], v[14:15], v[14:15], v[34:35]
    v_pk_add_f32 v[32:33], v[32:33], v[16:17]
    v_pk_fma_f32 v[34:35], v[16:17], v[16:17], v[34:35]
    v_pk_add_f32 v[32:33], v[32:33], v[18:19]
    v_pk_fma_f32 v[34:35], v[18:19], v[18:19], v[34:35]
    v_pk_add_f32 v[32:33], v[32:33], v[20:21]
    v_pk_fma_f32 v[34:35], v[20:21], v[20:21], v[34:35]
    v_pk_add_f32 v[32:33], v[32:33], v[22:23]
    v_pk_fma_f32 v[34:35], v[22:23], v[22:23], v[34:35]
    v_pk_add_f32 v[32:33], v[32:33], v[24:25]
    v_pk_fma_f32 v[34:35], v[24:25], v[24:25], v[34:35]
    v_add_f32 v32, v32, v33
    v_add_f32 v33, v34, v35
    v_mov_b32 v37, s55
    v_mov_b32 v39, s55
    v_mov_b64 v[34:35], v[32:33]
    s_nop 1
    v_permlane32_swap_b32 v32, v34
    v_permlane32_swap_b32 v33, v35
    v_pk_add_f32 v[32:33], v[32:33], v[34:35]
    v_mov_b64 v[34:35], v[32:33]
    s_lshl_b32 s61, s53, 8
    s_add_u32 s61, s61, s76
    v_permlane16_swap_b32 v32, v34
    v_permlane16_swap_b32 v33, v35
    v_add_f32 v36, v32, v34
    v_add_f32 v38, v33, v35
    s_mov_b64 exec, 0xffff
    s_cmp_eq_u32 s30, 0
    s_cbranch_scc1 ssl_91
    buffer_store_dwordx4 v[36:39], v3, s[4:7], s61 offen
    s_branch ssj_92
ssl_91:
    buffer_store_dwordx4 v[36:39], v3, s[4:7], s61 offen sc1
ssj_92:
    s_mov_b64 exec, -1
    s_cmp_lg_u32 s56, 0
    s_cbranch_scc1 L_gskip
    s_lshl_b32 s60, s53, 9
    s_add_u32 s60, s60, 22061056
    v_min_u32 v40, 35, v0
    v_lshlrev_b32 v40, 3, v40
    v_xor_b32 v46, s37, v2
    v_and_b32 v46, 1, v46
    v_lshrrev_b32 v47, 1, v2
    v_lshl_add_u32 v46, v46, 1, v47
    v_lshlrev_b32 v46, 10, v46
    s_lshl_b32 s61, s54, 2
    v_xor_b32 v47, s61, v1
    v_lshl_add_u32 v46, v47, 4, v46
    v_lshlrev_b32 v47, 4, v47
    s_mul_i32 s60, s52, 73728
    s_mul_i32 s61, s53, 9216
    s_add_u32 s60, s60, s61
    s_lshl_b32 s61, s54, 8
    s_add_u32 s60, s60, s61
    s_add_u32 s60, s60, 10485760
    s_add_u32 s70, s60, 8192
    s_lshr_b32 s61, s37, 1
    s_lshl_b32 s61, s61, 12
    s_add_u32 s68, s60, s61
    s_xor_b32 s61, s61, 4096
    s_add_u32 s69, s60, s61
    s_branch L_gj
L_gskip:
    s_mov_b32 s8, s46
    s_mov_b32 s9, s47
    s_mov_b32 s10, 4718592
    s_mov_b32 s11, 0x20000
    v_mul_u32_u24 v46, 2304, v1
    v_lshl_add_u32 v46, v2, 4, v46
    s_lshl_b32 s60, s52, 6
    s_lshl_b32 s61, s54, 4
    s_add_u32 s60, s60, s61
    s_mul_i32 s60, s60, 2304
    s_mul_i32 s61, s53, 288
    s_add_u32 s68, s60, s61
L_gj:
    v_mov_b32 v48, 1.0
    s_add_u32 s62, s59, 14336
    s_xor_b32 s60, s37, 0
    s_mul_i32 s60, s60, 512
    s_add_u32 s60, s60, s62
    v_lshl_add_u32 v44, v0, 3, s60
    s_xor_b32 s60, s37, 1
    s_mul_i32 s60, s60, 512
    s_add_u32 s60, s60, s62
    v_lshl_add_u32 v45, v0, 3, s60
    s_xor_b32 s60, s37, 2
    s_mul_i32 s60, s60, 512
    s_add_u32 s60, s60, s62
    v_lshl_add_u32 v49, v0, 3, s60
    s_xor_b32 s60, s37, 3
    s_mul_i32 s60, s60, 512
    s_add_u32 s60, s60, s62
    v_lshl_add_u32 v50, v0, 3, s60
    s_mov_b32 s60, 2048
    s_add_u32 s60, s60, s62
    v_lshl_add_u32 v51, v0, 3, s60
    buffer_load_dwordx4 v[36:39], v3, s[4:7], s76 offen sc1
    buffer_load_dwordx4 v[40:43], v3, s[4:7], s76 offen offset:1024 sc1
    s_cmp_eq_u32 s56, 0
    s_cbranch_scc1 L_noo
    v_mul_u32_u24 v46, 288, v1
    v_lshl_add_u32 v46, v2, 4, v46
    v_add_u32 v47, s59, v3
    s_xor_b32 s60, s37, 0
    s_mul_i32 s60, s60, 64
    s_add_u32 s60, s60, s59
    v_add_u32 v104, s60, v46
    v_add_u32 v109, 0, v0
    v_mul_u32_u24 v52, 3641, v109
    v_lshrrev_b32 v52, 16, v52
    v_mul_u32_u24 v52, 2016, v52
    v_lshl_add_u32 v109, v109, 4, v52
    s_xor_b32 s60, s37, 1
    s_mul_i32 s60, s60, 64
    s_add_u32 s60, s60, s59
    v_add_u32 v105, s60, v46
    v_add_u32 v110, 64, v0
    v_mul_u32_u24 v52, 3641, v110
    v_lshrrev_b32 v52, 16, v52
    v_mul_u32_u24 v52, 2016, v52
    v_lshl_add_u32 v110, v110, 4, v52
    s_xor_b32 s60, s37, 2
    s_mul_i32 s60, s60, 64
    s_add_u32 s60, s60, s59
    v_add_u32 v106, s60, v46
    v_add_u32 v111, 128, v0
    v_mul_u32_u24 v52, 3641, v111
    v_lshrrev_b32 v52, 16, v52
    v_mul_u32_u24 v52, 2016, v52
    v_lshl_add_u32 v111, v111, 4, v52
    s_xor_b32 s60, s37, 3
    s_mul_i32 s60, s60, 64
    s_add_u32 s60, s60, s59
    v_add_u32 v107, s60, v46
    v_add_u32 v27, 192, v0
    v_mul_u32_u24 v52, 3641, v27
    v_lshrrev_b32 v52, 16, v52
    v_mul_u32_u24 v52, 2016, v52
    v_lshl_add_u32 v27, v27, 4, v52
    s_mov_b32 s60, 256
    s_add_u32 s60, s60, s59
    v_add_u32 v108, s60, v46
    v_add_u32 v31, 256, v0
    v_mul_u32_u24 v52, 3641, v31
    v_lshrrev_b32 v52, 16, v52
    v_mul_u32_u24 v52, 2016, v52
    v_lshl_add_u32 v31, v31, 4, v52
L_noo:
    s_barrier
    ds_read_b64_tr_b16 v[92:93], v44
    ds_read_b64_tr_b16 v[94:95], v45
    ds_read_b64_tr_b16 v[96:97], v49
    ds_read_b64_tr_b16 v[98:99], v50
    ds_read_b64_tr_b16 v[100:101], v51
    s_waitcnt lgkmcnt(0)
    v_lshlrev_b32 v72, 16, v92
    v_and_b32 v73, 0xffff0000, v92
    v_lshlrev_b32 v74, 16, v93
    v_and_b32 v75, 0xffff0000, v93
    v_lshlrev_b32 v76, 16, v94
    v_and_b32 v77, 0xffff0000, v94
    v_lshlrev_b32 v78, 16, v95
    v_and_b32 v79, 0xffff0000, v95
    v_lshlrev_b32 v80, 16, v96
    v_and_b32 v81, 0xffff0000, v96
    v_lshlrev_b32 v82, 16, v97
    v_and_b32 v83, 0xffff0000, v97
    v_lshlrev_b32 v84, 16, v98
    v_and_b32 v85, 0xffff0000, v98
    v_lshlrev_b32 v86, 16, v99
    v_and_b32 v87, 0xffff0000, v99
    v_lshlrev_b32 v88, 16, v100
    v_and_b32 v89, 0xffff0000, v100
    v_lshlrev_b32 v90, 16, v101
    v_and_b32 v91, 0xffff0000, v101
    s_mov_b32 s77, 400000
    s_branch pchk_st24_95
poll_st24_93:
    buffer_load_dwordx4 v[36:39], v3, s[4:7], s76 offen sc1
    buffer_load_dwordx4 v[40:43], v3, s[4:7], s76 offen offset:1024 sc1
pchk_st24_95:
    s_waitcnt vmcnt(0)
    v_bitop3_b32 v32, v37, v39, s55 bitop3:0x7e
    v_bitop3_b32 v33, v41, v43, s55 bitop3:0x7e
    v_or_b32 v32, v32, v33
    v_cmp_ne_u32 vcc, 0, v32
    s_cbranch_vccz pout_st24_94
    s_sub_u32 s77, s77, 1
    s_cmp_lg_u32 s77, 0
    s_cbranch_scc1 poll_st24_93
pout_st24_94:
    v_add_f32 v32, v36, v40
    v_add_f32 v33, v38, v42
    v_mov_b64 v[34:35], v[32:33]
    s_nop 1
    v_permlane32_swap_b32 v32, v34
    v_permlane32_swap_b32 v33, v35
    v_pk_add_f32 v[32:33], v[32:33], v[34:35]
    v_mov_b64 v[34:35], v[32:33]
    s_nop 1
    v_permlane16_swap_b32 v32, v34
    v_permlane16_swap_b32 v33, v35
    v_pk_add_f32 v[32:33], v[32:33], v[34:35]
    v_mul_f32 v32, 0x3ae38e39, v32
    v_mul_f32 v33, 0x3ae38e39, v33
    v_fma_f32 v33, -v32, v32, v33
    v_max_f32 v33, 0, v33
    v_add_f32 v33, 0x3727c5ac, v33
    v_rsq_f32 v33, v33
    v_add_f32 v26, v26, v32
    v_pk_add_f32 v[6:7], v[6:7], v[32:33] op_sel_hi:[1,0] neg_lo:[0,1] neg_hi:[0,1]
    v_pk_add_f32 v[8:9], v[8:9], v[32:33] op_sel_hi:[1,0] neg_lo:[0,1] neg_hi:[0,1]
    v_pk_add_f32 v[10:11], v[10:11], v[32:33] op_sel_hi:[1,0] neg_lo:[0,1] neg_hi:[0,1]
    v_pk_add_f32 v[12:13], v[12:13], v[32:33] op_sel_hi:[1,0] neg_lo:[0,1] neg_hi:[0,1]
    v_pk_add_f32 v[14:15], v[14:15], v[32:33] op_sel_hi:[1,0] neg_lo:[0,1] neg_hi:[0,1]
    v_pk_add_f32 v[16:17], v[16:17], v[32:33] op_sel_hi:[1,0] neg_lo:[0,1] neg_hi:[0,1]
    v_pk_add_f32 v[18:19], v[18:19], v[32:33] op_sel_hi:[1,0] neg_lo:[0,1] neg_hi:[0,1]
    v_pk_add_f32 v[20:21], v[20:21], v[32:33] op_sel_hi:[1,0] neg_lo:[0,1] neg_hi:[0,1]
    v_pk_add_f32 v[22:23], v[22:23], v[32:33] op_sel_hi:[1,0] neg_lo:[0,1] neg_hi:[0,1]
    v_pk_add_f32 v[24:25], v[24:25], v[32:33] op_sel_hi:[1,0] neg_lo:[0,1] neg_hi:[0,1]
    v_pk_fma_f32 v[52:53], v[32:33], v[72:73], v[48:49] op_sel:[1,0,0] op_sel_hi:[1,1,0]
    v_pk_fma_f32 v[54:55], v[32:33], v[74:75], v[48:49] op_sel:[1,0,0] op_sel_hi:[1,1,0]
    v_pk_fma_f32 v[56:57], v[32:33], v[76:77], v[48:49] op_sel:[1,0,0] op_sel_hi:[1,1,0]
    v_pk_fma_f32 v[58:59], v[32:33], v[78:79], v[48:49] op_sel:[1,0,0] op_sel_hi:[1,1,0]
    v_pk_fma_f32 v[60:61], v[32:33], v[80:81], v[48:49] op_sel:[1,0,0] op_sel_hi:[1,1,0]
    v_pk_fma_f32 v[62:63], v[32:33], v[82:83], v[48:49] op_sel:[1,0,0] op_sel_hi:[1,1,0]
    v_pk_fma_f32 v[64:65], v[32:33], v[84:85], v[48:49] op_sel:[1,0,0] op_sel_hi:[1,1,0]
    v_pk_fma_f32 v[66:67], v[32:33], v[86:87], v[48:49] op_sel:[1,0,0] op_sel_hi:[1,1,0]
    v_pk_fma_f32 v[68:69], v[32:33], v[88:89], v[48:49] op_sel:[1,0,0] op_sel_hi:[1,1,0]
    v_pk_fma_f32 v[70:71], v[32:33], v[90:91], v[48:49] op_sel:[1,0,0] op_sel_hi:[1,1,0]
    s_cmp_lg_u32 s56, 0
    s_cbranch_scc1 L_out
    v_pk_mul_f32 v[6:7], v[6:7], v[52:53]
    v_pk_mul_f32 v[8:9], v[8:9], v[54:55]
    v_pk_mul_f32 v[10:11], v[10:11], v[56:57]
    v_pk_mul_f32 v[12:13], v[12:13], v[58:59]
    v_pk_mul_f32 v[14:15], v[14:15], v[60:61]
    v_pk_mul_f32 v[16:17], v[16:17], v[62:63]
    v_pk_mul_f32 v[18:19], v[18:19], v[64:65]
    v_pk_mul_f32 v[20:21], v[20:21], v[66:67]
    v_pk_mul_f32 v[22:23], v[22:23], v[68:69]
    v_pk_mul_f32 v[24:25], v[24:25], v[70:71]
    v_cvt_pk_bf16_f32 v92, v6, v7
    v_cvt_pk_bf16_f32 v93, v8, v9
    v_cvt_pk_bf16_f32 v94, v10, v11
    v_cvt_pk_bf16_f32 v95, v12, v13
    v_cvt_pk_bf16_f32 v96, v14, v15
    v_cvt_pk_bf16_f32 v97, v16, v17
    v_cvt_pk_bf16_f32 v98, v18, v19
    v_cvt_pk_bf16_f32 v99, v20, v21
    v_cvt_pk_bf16_f32 v100, v22, v23
    v_cvt_pk_bf16_f32 v101, v24, v25
    v_permlane16_swap_b32 v92, v94
    v_permlane16_swap_b32 v93, v95
    v_permlane16_swap_b32 v96, v98
    v_permlane16_swap_b32 v97, v99
    v_permlane16_swap_b32 v100, v102
    v_permlane16_swap_b32 v101, v103
    buffer_store_dwordx4 v[92:95], v46, s[4:7], s68 offen sc1
    buffer_store_dwordx4 v[96:99], v46, s[4:7], s69 offen sc1
    s_mov_b64 exec, 0xffff
    buffer_store_dwordx4 v[100:103], v47, s[4:7], s70 offen sc1
    s_mov_b64 exec, -1
    s_mov_b32 exec_lo, 0x0
    s_mov_b32 exec_hi, 0xffffffff
    v_mov_b32 v22, 0
    v_mov_b32 v23, 0
    v_mov_b32 v24, 0
    v_mov_b32 v25, 0
    s_mov_b64 exec, -1
    s_add_u32 s64, s58, 524288
    v_pk_add_f32 v[52:53], v[6:7], v[8:9]
    v_pk_mul_f32 v[54:55], v[6:7], v[6:7]
    v_pk_fma_f32 v[54:55], v[8:9], v[8:9], v[54:55]
    v_pk_add_f32 v[52:53], v[52:53], v[10:11]
    v_pk_fma_f32 v[54:55], v[10:11], v[10:11], v[54:55]
    v_pk_add_f32 v[52:53], v[52:53], v[12:13]
    v_pk_fma_f32 v[54:55], v[12:13], v[12:13], v[54:55]
    v_pk_add_f32 v[52:53], v[52:53], v[14:15]
    v_pk_fma_f32 v[54:55], v[14:15], v[14:15], v[54:55]
    v_pk_add_f32 v[52:53], v[52:53], v[16:17]
    v_pk_fma_f32 v[54:55], v[16:17], v[16:17], v[54:55]
    v_pk_add_f32 v[52:53], v[52:53], v[18:19]
    v_pk_fma_f32 v[54:55], v[18:19], v[18:19], v[54:55]
    v_pk_add_f32 v[52:53], v[52:53], v[20:21]
    v_pk_fma_f32 v[54:55], v[20:21], v[20:21], v[54:55]
    v_pk_add_f32 v[52:53], v[52:53], v[22:23]
    v_pk_fma_f32 v[54:55], v[22:23], v[22:23], v[54:55]
    v_pk_add_f32 v[52:53], v[52:53], v[24:25]
    v_pk_fma_f32 v[54:55], v[24:25], v[24:25], v[54:55]
    v_add_f32 v52, v52, v53
    v_add_f32 v53, v54, v55
    v_mov_b32 v57, s55
    v_mov_b32 v59, s55
    v_mov_b64 v[54:55], v[52:53]
    s_nop 1
    v_permlane32_swap_b32 v52, v54
    v_permlane32_swap_b32 v53, v55
    v_pk_add_f32 v[52:53], v[52:53], v[54:55]
    v_mov_b64 v[54:55], v[52:53]
    s_lshl_b32 s61, s53, 8
    s_add_u32 s61, s61, s64
    v_permlane16_swap_b32 v52, v54
    v_permlane16_swap_b32 v53, v55
    v_add_f32 v56, v52, v54
    v_add_f32 v58, v53, v55
    s_mov_b64 exec, 0xffff
    buffer_store_dwordx4 v[56:59], v3, s[4:7], s61 offen sc1
    s_mov_b64 exec, -1
    s_lshl_b32 s62, s52, 7
    s_lshl_b32 s61, s53, 2
    s_add_u32 s62, s62, s61
    s_add_u32 s62, s62, 22036480
    v_lshrrev_b32 v30, 3, v0
    s_waitcnt vmcnt(1)
    v_mov_b32 v32, 1
    s_mov_b64 exec, 1
    ds_add_rtn_u32 v32, v5, v32 offset:48
    v_mov_b32 v34, s55
    v_mov_b32 v35, 0
    s_waitcnt lgkmcnt(0)
    v_cmp_eq_u32 vcc, 3, v32
    s_cbranch_vccz nf_96
    s_cmp_eq_u32 s30, 0
    s_cbranch_scc1 ssl_97
    buffer_store_dword v34, v35, s[4:7], s62 offen
    s_branch ssj_98
ssl_97:
    buffer_store_dword v34, v35, s[4:7], s62 offen sc1
ssj_98:
nf_96:
    s_mov_b64 exec, -1
    s_mov_b32 s56, 1
    v_add_u32 v5, 4, v5
    s_setprio 0
    s_cmp_eq_u32 s54, 3
    s_cbranch_scc1 L_t8
    s_barrier
    s_barrier
    s_barrier
    s_barrier
    s_mov_b32 s77, 3200000
cw_99:
    ds_read_b32 v32, v5 offset:32
    s_waitcnt lgkmcnt(0)
    v_cmp_gt_u32 vcc, 4, v32
    s_cbranch_vccz cwo_100
    s_sleep 4
    s_sub_u32 s77, s77, 1
    s_cmp_lg_u32 s77, 0
    s_cbranch_scc1 cw_99
cwo_100:
    s_branch L_xres
L_out:
    v_pk_fma_f32 v[6:7], v[6:7], v[52:53], v[26:27] op_sel_hi:[1,1,0]
    v_pk_fma_f32 v[8:9], v[8:9], v[54:55], v[26:27] op_sel_hi:[1,1,0]
    ds_write_b128 v104, v[6:9]
    v_pk_fma_f32 v[10:11], v[10:11], v[56:57], v[26:27] op_sel_hi:[1,1,0]
    v_pk_fma_f32 v[12:13], v[12:13], v[58:59], v[26:27] op_sel_hi:[1,1,0]
    ds_write_b128 v105, v[10:13]
    v_pk_fma_f32 v[14:15], v[14:15], v[60:61], v[26:27] op_sel_hi:[1,1,0]
    v_pk_fma_f32 v[16:17], v[16:17], v[62:63], v[26:27] op_sel_hi:[1,1,0]
    ds_write_b128 v106, v[14:17]
    v_pk_fma_f32 v[18:19], v[18:19], v[64:65], v[26:27] op_sel_hi:[1,1,0]
    v_pk_fma_f32 v[20:21], v[20:21], v[66:67], v[26:27] op_sel_hi:[1,1,0]
    ds_write_b128 v107, v[18:21]
    v_pk_fma_f32 v[22:23], v[22:23], v[68:69], v[26:27] op_sel_hi:[1,1,0]
    v_pk_fma_f32 v[24:25], v[24:25], v[70:71], v[26:27] op_sel_hi:[1,1,0]
    s_mov_b32 exec_lo, 0xffffffff
    s_mov_b32 exec_hi, 0x0
    ds_write_b128 v108, v[22:25]
    s_mov_b64 exec, -1
    ds_read_b128 v[72:75], v47 offset:0
    ds_read_b128 v[76:79], v47 offset:1024
    ds_read_b128 v[80:83], v47 offset:2048
    ds_read_b128 v[84:87], v47 offset:3072
    ds_read_b128 v[88:91], v47 offset:4096
    s_waitcnt lgkmcnt(4)
    buffer_store_dwordx4 v[72:75], v109, s[8:11], s68 offen nt
    s_waitcnt lgkmcnt(3)
    buffer_store_dwordx4 v[76:79], v110, s[8:11], s68 offen nt
    s_waitcnt lgkmcnt(2)
    buffer_store_dwordx4 v[80:83], v111, s[8:11], s68 offen nt
    s_waitcnt lgkmcnt(1)
    buffer_store_dwordx4 v[84:87], v27, s[8:11], s68 offen nt
    s_waitcnt lgkmcnt(0)
    s_mov_b32 exec_lo, 0xffffffff
    s_mov_b32 exec_hi, 0x0
    buffer_store_dwordx4 v[88:91], v31, s[8:11], s68 offen nt
    s_mov_b64 exec, -1
L_fin:
L_end:
    s_endpgm
.section .rodata,"a"
.p2align 6
.amdhsa_kernel interleave_layers__ssm_conv_s5__ssm_conv_h3__prompt_kernel
  .amdhsa_next_free_vgpr 256
  .amdhsa_next_free_sgpr 102
  .amdhsa_accum_offset 112
  .amdhsa_group_segment_fixed_size 0
  .amdhsa_kernarg_size 144
  .amdhsa_user_sgpr_count 2
  .amdhsa_user_sgpr_kernarg_segment_ptr 1
  .amdhsa_system_sgpr_workgroup_id_x 1
.end_amdhsa_kernel
```
